```python
import torch

def _softmax(x, axis=-1):
    return torch.softmax(x, dim=axis)
def _gelu(x):
    return torch.nn.functional.gelu(x, approximate="tanh")
def _silu(x):
    return torch.nn.functional.silu(x)
def _sigmoid(x):
    return torch.sigmoid(x)
def _layernorm(x, axis=-1, eps=1e-5):
    m = x.mean(dim=axis, keepdim=True)
    v = x.var(dim=axis, keepdim=True, unbiased=False)
    return (x - m) / torch.sqrt(v + eps)
def _scatter_add(tgt, idx, src, axis=0):
    return tgt.clone().index_add_(axis, idx, src)
def _segment_sum(src, seg, n):
    out = torch.zeros((n,) + src.shape[1:], dtype=src.dtype)
    return out.index_add_(0, seg, src)
def _pad(x, pw):
    flat = tuple(v for pair in reversed(pw) for v in pair)
    return torch.nn.functional.pad(x, flat)

kernel_name = 'parallel_sum__softmax_full_mha__glu_gated_swiglu__prompt'

def setup_inputs():

    _w = (lambda a: (lambda t: t.to(torch.bfloat16) if t.is_floating_point() else t)(torch.as_tensor(a)))
    def _A_setup():
        B, S, D = 1, 2048, 448
        return {
            "x": _w((lambda *s: torch.randn(*s, dtype=torch.bfloat16) * 0.05)(B, S, D)),
            "wqkv": _w((lambda *s: torch.randn(*s, dtype=torch.bfloat16) * 0.05)(D, 3 * D)),
            "wo": _w((lambda *s: torch.randn(*s, dtype=torch.bfloat16) * 0.05)(D, D)),
        }
    _A_in = _A_setup()

    def _B_setup():
        B, S, D, F = 1, 2048, 448, 1792
        return {
            "x": _w((lambda *s: torch.randn(*s, dtype=torch.bfloat16) * 0.05)(B, S, D)),
            "w1": _w((lambda *s: torch.randn(*s, dtype=torch.bfloat16) * 0.4)(D, F) * (2.0 / D) ** 0.5),
            "w3": _w((lambda *s: torch.randn(*s, dtype=torch.bfloat16) * 0.4)(D, F) * (2.0 / D) ** 0.5),
            "w2": _w((lambda *s: torch.randn(*s, dtype=torch.bfloat16) * 0.4)(F, D) * (2.0 / F) ** 0.5),
        }
    _B_in = _B_setup()

    return {
        "A_x": _A_in["x"],
        "A_wqkv": _A_in["wqkv"],
        "A_wo": _A_in["wo"],
        "B_x": _B_in["x"],
        "B_w1": _B_in["w1"],
        "B_w3": _B_in["w3"],
        "B_w2": _B_in["w2"],
    }

def reference(A_x, A_wqkv, A_wo, B_x, B_w1, B_w3, B_w2):
    def _A_ref(x, wqkv, wo):
        B, S, D = x.shape
        H = 16; Dh = D // H
        qkv = (lambda x, *d: x.permute(*d))((x @ wqkv).reshape(B, S, 3, H, Dh), 2, 0, 3, 1, 4)
        q, k, v = qkv[0], qkv[1], qkv[2]
        scale = Dh ** -0.5
        scores = torch.einsum("bhqd,bhkd->bhqk", q, k) * scale
        p = _softmax(scores, axis=-1)
        o = torch.einsum("bhqk,bhkd->bhqd", p, v)
        return (lambda x, *d: x.permute(*d))(o, 0, 2, 1, 3).reshape(B, S, D) @ wo

    def _B_ref(x, w1, w3, w2):
        gate = torch.einsum("bsd,df->bsf", x, w1)
        up = torch.einsum("bsd,df->bsf", x, w3)
        h = _silu(gate) * up
        out = torch.einsum("bsf,fd->bsd", h, w2)
        return out

    x = A_x
    xn = _layernorm(x, axis=-1)
    return x + _A_ref(xn, A_wqkv, A_wo) + _B_ref(xn, B_w1, B_w3, B_w2)
```

```asm
; @launch grid=(256,1,1) block=(256,1,1) lds=163840
.amdgcn_target "amdgcn-amd-amdhsa--gfx950"
.text
.globl parallel_sum__softmax_full_mha__glu_gated_swiglu__prompt_kernel
.p2align 8
.type parallel_sum__softmax_full_mha__glu_gated_swiglu__prompt_kernel,@function
parallel_sum__softmax_full_mha__glu_gated_swiglu__prompt_kernel:
    s_cmp_ge_u32 s2, 256
    s_cbranch_scc1 k_exit
    s_load_dwordx16 s[16:31], s[0:1], 0
    s_load_dwordx4 s[32:35], s[0:1], 64
    s_cmp_ge_u32 s2, 32
    s_cbranch_scc1 nocp_1
    s_getpc_b64 s[96:97]
here_2:
    s_bfe_u32 s6, s2, 0x10003
    s_lshl_b32 s6, s6, 15
    v_lshlrev_b32 v230, 7, v0
    v_add_u32 v230, s6, v230
    v_min_u32 v230, k_exit-here_2, v230
    v_mov_b32 v231, s97
    v_add_co_u32 v230, vcc, s96, v230
    s_nop 1
    v_addc_co_u32 v231, vcc, 0, v231, vcc
    global_load_dword v255, v[230:231], off
nocp_1:
    v_and_b32 v1, 63, v0
    v_lshrrev_b32 v220, 6, v0
    s_and_b32 s3, s2, 7
    v_readfirstlane_b32 s36, v220
    s_lshr_b32 s9, s2, 3
    s_and_b32 s5, s3, 3
    s_lshl_b32 s5, s5, 2
    s_and_b32 s6, s9, 3
    s_add_u32 s37, s5, s6
    s_lshr_b32 s6, s3, 2
    s_xor_b32 s6, s6, 0
    s_lshl_b32 s6, s6, 3
    s_lshr_b32 s7, s9, 2
    s_add_u32 s38, s6, s7
    s_lshl_b32 s15, s37, 2
    s_add_u32 s15, s15, s36
    s_mul_i32 s4, s15, 28672
    s_add_u32 s5, s36, 1
    s_mul_i32 s5, s5, 28672
    v_lshrrev_b32 v220, 3, v1
    v_and_b32 v221, 7, v1
    v_lshrrev_b32 v222, 4, v1
    v_mul_u32_u24 v223, 896, v220
    v_bfe_u32 v224, v1, 4, 1
    v_lshlrev_b32 v224, 2, v224
    v_lshrrev_b32 v225, 5, v1
    v_or_b32 v224, v224, v225
    v_xor_b32 v224, v221, v224
    v_lshl_add_u32 v2, v224, 4, v223
    v_xor_b32 v224, 2, v224
    v_lshl_add_u32 v3, v224, 4, v223
    v_min_u32 v229, 27, v1
    v_lshlrev_b32 v229, 7, v229
    s_and_b32 s6, s38, 7
    s_mul_i32 s6, s6, 3584
    s_add_u32 s6, s6, s4
    s_waitcnt lgkmcnt(0)
    s_mov_b32 s40, s16
    s_and_b32 s41, s17, 0xffff
    s_mov_b32 s42, 1835008
    s_mov_b32 s43, 0x20000
    buffer_load_dword v255, v229, s[40:43], s6 offen
    s_add_u32 m0, s5, 0
    s_add_u32 s55, s4, 0
    buffer_load_dwordx4 v2, s[40:43], s55 offen lds
    v_and_b32 v224, 1, v222
    v_lshlrev_b32 v224, 2, v224
    v_xor_b32 v224, v221, v224
    v_mul_u32_u24 v225, 3584, v220
    v_lshl_add_u32 v9, v224, 4, v225
    v_min_u32 v224, 6, v224
    v_mul_u32_u24 v225, 2688, v220
    v_lshl_add_u32 v8, v224, 4, v225
    s_mov_b32 s44, s18
    s_and_b32 s45, s19, 0xffff
    s_mov_b32 s46, 1204224
    s_mov_b32 s47, 0x20000
    s_mul_i32 s52, s36, 7168
    s_add_u32 m0, s5, 1024
    s_add_u32 s55, s4, 7168
    buffer_load_dwordx4 v3, s[40:43], s55 offen lds
    s_mul_i32 s53, s36, 150528
    s_and_b32 s54, s36, 1
    s_mul_i32 s54, s54, 200704
    s_lshr_b32 s6, s38, 3
    s_mul_i32 s6, s6, 896
    s_and_b32 s7, s38, 7
    s_mul_i32 s7, s7, 112
    s_add_u32 s62, s53, s6
    s_add_u32 s62, s62, s7
    s_sub_u32 s6, s38, 12
    s_mul_i32 s7, s6, 224
    s_add_u32 s63, s53, s7
    s_add_u32 s63, s63, 1792
    s_add_u32 m0, s5, 2048
    s_add_u32 s55, s4, 14336
    buffer_load_dwordx4 v2, s[40:43], s55 offen lds
    s_add_u32 s64, s63, 112
    s_lshl_b32 s67, s38, 1
    s_add_u32 s7, s67, 1
    s_add_u32 s8, s38, 12
    s_cmp_ge_u32 s38, 12
    s_cselect_b32 s68, s8, s7
    s_lshl_b32 s8, s67, 7
    s_add_u32 s65, s54, s8
    s_lshl_b32 s8, s68, 7
    s_add_u32 s66, s54, s8
    s_cmp_ge_u32 s36, 2
    s_cselect_b32 s48, s26, s24
    s_cselect_b32 s49, s27, s25
    s_and_b32 s49, s49, 0xffff
    s_mov_b32 s50, 1605632
    s_mov_b32 s51, 0x20000
    s_add_u32 m0, s5, 3072
    s_add_u32 s55, s4, 21504
    buffer_load_dwordx4 v3, s[40:43], s55 offen lds
    s_lshl_b32 s6, s3, 1
    s_and_b32 s7, s9, 1
    s_add_u32 s10, s6, s7
    s_lshr_b32 s11, s9, 1
    s_lshl_b32 s6, s3, 2
    s_and_b32 s7, s9, 3
    s_add_u32 s12, s6, s7
    s_lshr_b32 s13, s9, 2
    s_cmp_lt_u32 s9, 28
    s_cselect_b32 s14, 1, 0
    s_min_u32 s13, s13, 6
    s_mov_b32 s56, 0
    s_mov_b32 s57, -1
    s_mov_b32 s58, 0xf0000000
    s_mov_b32 s59, 0xf0000000
    s_mov_b32 s60, 0x3f80
    s_mov_b32 s61, 0x3f800000
    v_and_b32 v220, 31, v1
    v_lshrrev_b32 v221, 5, v1
    v_lshrrev_b32 v222, 3, v220
    v_and_b32 v223, 7, v220
    s_add_u32 m0, s5, 4096
    s_add_u32 s55, s4, 128
    buffer_load_dwordx4 v2, s[40:43], s55 offen lds
    v_lshlrev_b32 v222, 10, v222
    v_lshl_add_u32 v222, v223, 7, v222
    v_add_u32 v222, s5, v222
    v_bfe_u32 v223, v220, 1, 1
    v_lshlrev_b32 v223, 2, v223
    v_bfe_u32 v224, v220, 3, 1
    v_lshl_or_b32 v223, v224, 1, v223
    v_bfe_u32 v224, v220, 2, 1
    v_or_b32 v223, v223, v224
    v_xor_b32 v223, v223, v221
    v_xor_b32 v224, 0, v223
    v_lshl_add_u32 v140, v224, 4, v222
    v_xor_b32 v224, 2, v223
    v_lshl_add_u32 v141, v224, 4, v222
    v_xor_b32 v224, 4, v223
    v_lshl_add_u32 v142, v224, 4, v222
    v_xor_b32 v224, 6, v223
    v_lshl_add_u32 v143, v224, 4, v222
    v_bfe_u32 v222, v1, 2, 2
    v_lshl_add_u32 v223, v221, 2, v222
    v_lshlrev_b32 v223, 7, v223
    s_add_u32 m0, s5, 5120
    s_add_u32 s55, s4, 7296
    buffer_load_dwordx4 v3, s[40:43], s55 offen lds
    v_bfe_u32 v224, v1, 4, 1
    v_and_b32 v225, 3, v1
    v_lshlrev_b32 v224, 5, v224
    v_lshl_add_u32 v224, v225, 3, v224
    v_lshrrev_b32 v225, 1, v222
    v_lshlrev_b32 v225, 6, v225
    v_add_u32 v226, 0, v224
    v_xor_b32 v226, v226, v225
    v_add_u32 v10, v226, v223
    v_add_u32 v226, 0, v224
    v_xor_b32 v226, v226, v225
    v_add_u32 v12, v226, v223
    v_add_u32 v226, 56, v224
    v_xor_b32 v226, v226, v225
    v_add_u32 v11, v226, v223
    v_add_u32 v226, 64, v224
    v_xor_b32 v226, v226, v225
    v_add_u32 v13, v226, v223
    v_lshlrev_b32 v227, 4, v1
    s_and_b32 s6, s38, 7
    s_add_u32 m0, s5, 6144
    s_add_u32 s55, s4, 14464
    buffer_load_dwordx4 v2, s[40:43], s55 offen lds
    s_lshl_b32 s6, s6, 7
    s_add_u32 s6, s6, s15
    s_lshl_b32 s7, s6, 11
    s_lshl_b32 s8, s6, 12
    s_add_u32 s7, s7, 0
    s_add_u32 s8, s8, 2097152
    s_mov_b32 s6, 131072
    s_cmp_ge_u32 s38, 8
    s_cselect_b32 s7, s8, s7
    s_cselect_b32 s8, 262144, s6
    v_add_u32 v198, s7, v227
    v_add_u32 v199, s8, v198
    s_sub_u32 s6, s38, 12
    s_lshl_b32 s6, s6, 8
    s_add_u32 s6, s6, s15
    s_lshl_b32 s6, s6, 12
    s_add_u32 s6, s6, 2099200
    v_mul_u32_u24 v222, 37, v220
    v_lshrrev_b32 v222, 8, v222
    v_mul_u32_u24 v223, 7, v222
    v_sub_u32 v223, v220, v223
    v_lshrrev_b32 v224, 1, v222
    v_lshl_add_u32 v223, v224, 3, v223
    s_add_u32 m0, s5, 7168
    s_add_u32 s55, s4, 21632
    buffer_load_dwordx4 v3, s[40:43], s55 offen lds
    v_and_b32 v224, 3, v223
    v_lshrrev_b32 v223, 2, v223
    v_lshl_add_u32 v224, v223, 3, v224
    v_and_b32 v222, 1, v222
    v_lshl_add_u32 v224, v222, 2, v224
    v_and_b32 v222, 1, v220
    v_lshlrev_b32 v222, 2, v222
    v_bfe_u32 v223, v220, 1, 1
    v_lshl_add_u32 v222, v223, 4, v222
    v_add_u32 v222, 11, v222
    v_cmp_le_u32 vcc, 28, v220
    v_mov_b32 v228, 0
    s_nop 0
    v_cndmask_b32 v224, v224, v222, vcc
    v_lshl_add_u32 v224, v221, 5, v224
    v_lshlrev_b32 v224, 4, v224
    v_add_u32 v201, s6, v224
    s_mul_i32 s6, s15, 114688
    s_add_u32 s6, s6, 8388608
    v_add_u32 v200, s6, v227
    v_cmp_eq_u32 vcc, 31, v220
    v_mov_b32 v228, 0x3f803f80
    s_nop 0
    v_cndmask_b32 v197, 0, v228, vcc
    v_mov_b32 v232, 0
    v_mov_b32 v233, 0
    s_add_u32 m0, s5, 8192
    s_add_u32 s55, s4, 256
    buffer_load_dwordx4 v2, s[40:43], s55 offen lds
    v_mov_b32 v234, 0
    v_mov_b32 v235, 0
    v_mov_b32 v236, 0
    v_mov_b32 v237, 0
    v_mov_b32 v238, 0
    v_mov_b32 v239, 0
    v_mov_b32 v128, 0
    v_mov_b32 v129, 0
    v_mov_b32 v130, 0
    v_mov_b32 v131, 0
    v_mov_b32 v132, 0
    v_mov_b32 v133, 0
    v_mov_b32 v134, 0
    v_mov_b32 v135, 0
    v_and_b32 v220, 31, v1
    v_lshrrev_b32 v221, 5, v1
    v_lshlrev_b32 v222, 3, v221
    v_sub_u32 v222, v220, v222
    v_cmp_eq_u32 vcc, 0, v222
    v_mov_b32 v223, 0x3f80
    s_nop 0
    v_cndmask_b32 v160, 0, v223, vcc
    v_cmp_eq_u32 vcc, 1, v222
    v_mov_b32 v223, 0x3f800000
    s_add_u32 m0, s5, 9216
    s_add_u32 s55, s4, 7424
    buffer_load_dwordx4 v3, s[40:43], s55 offen lds
    s_nop 0
    v_cndmask_b32 v160, v160, v223, vcc
    v_cmp_eq_u32 vcc, 2, v222
    v_mov_b32 v223, 0x3f80
    s_nop 0
    v_cndmask_b32 v161, 0, v223, vcc
    v_cmp_eq_u32 vcc, 3, v222
    v_mov_b32 v223, 0x3f800000
    s_nop 0
    v_cndmask_b32 v161, v161, v223, vcc
    v_cmp_eq_u32 vcc, 4, v222
    v_mov_b32 v223, 0x3f80
    s_nop 0
    v_cndmask_b32 v162, 0, v223, vcc
    v_cmp_eq_u32 vcc, 5, v222
    v_mov_b32 v223, 0x3f800000
    s_nop 0
    v_cndmask_b32 v162, v162, v223, vcc
    v_cmp_eq_u32 vcc, 6, v222
    v_mov_b32 v223, 0x3f80
    s_nop 0
    v_cndmask_b32 v163, 0, v223, vcc
    v_cmp_eq_u32 vcc, 7, v222
    v_mov_b32 v223, 0x3f800000
    s_nop 0
    v_cndmask_b32 v163, v163, v223, vcc
    v_cmp_eq_u32 vcc, 16, v222
    v_mov_b32 v223, 0x3f80
    s_nop 0
    v_cndmask_b32 v164, 0, v223, vcc
    v_cmp_eq_u32 vcc, 17, v222
    v_mov_b32 v223, 0x3f800000
    s_nop 0
    v_cndmask_b32 v164, v164, v223, vcc
    v_cmp_eq_u32 vcc, 18, v222
    v_mov_b32 v223, 0x3f80
    s_nop 0
    v_cndmask_b32 v165, 0, v223, vcc
    v_cmp_eq_u32 vcc, 19, v222
    v_mov_b32 v223, 0x3f800000
    s_add_u32 m0, s5, 10240
    s_add_u32 s55, s4, 14592
    buffer_load_dwordx4 v2, s[40:43], s55 offen lds
    s_nop 0
    v_cndmask_b32 v165, v165, v223, vcc
    v_cmp_eq_u32 vcc, 20, v222
    v_mov_b32 v223, 0x3f80
    s_nop 0
    v_cndmask_b32 v166, 0, v223, vcc
    v_cmp_eq_u32 vcc, 21, v222
    v_mov_b32 v223, 0x3f800000
    s_nop 0
    v_cndmask_b32 v166, v166, v223, vcc
    v_cmp_eq_u32 vcc, 22, v222
    v_mov_b32 v223, 0x3f80
    s_nop 0
    v_cndmask_b32 v167, 0, v223, vcc
    v_cmp_eq_u32 vcc, 23, v222
    v_mov_b32 v223, 0x3f800000
    s_nop 0
    v_cndmask_b32 v167, v167, v223, vcc
    v_bfe_u32 v222, v1, 2, 2
    v_bfe_u32 v223, v1, 4, 1
    v_and_b32 v224, 3, v1
    v_lshrrev_b32 v225, 1, v224
    v_lshl_add_u32 v225, v223, 1, v225
    v_lshrrev_b32 v226, 1, v222
    v_lshlrev_b32 v226, 2, v226
    v_lshl_or_b32 v226, v221, 1, v226
    v_and_b32 v224, 1, v224
    v_lshlrev_b32 v224, 3, v224
    v_lshl_add_u32 v224, v222, 7, v224
    v_lshl_add_u32 v224, v221, 10, v224
    s_add_u32 m0, s5, 11264
    s_add_u32 s55, s4, 21760
    buffer_load_dwordx4 v3, s[40:43], s55 offen lds
    s_add_u32 s6, s36, 1
    s_mul_i32 s6, s6, 28672
    v_add_u32 v224, s6, v224
    v_xor_b32 v227, 0, v225
    v_xor_b32 v227, v227, v226
    v_lshlrev_b32 v227, 4, v227
    v_add_u32 v136, v227, v224
    v_xor_b32 v227, 1, v225
    v_xor_b32 v227, v227, v226
    v_lshlrev_b32 v227, 4, v227
    v_add_u32 v137, v227, v224
    v_add_u32 v137, 512, v137
    v_xor_b32 v227, 4, v225
    v_xor_b32 v227, v227, v226
    v_lshlrev_b32 v227, 4, v227
    v_add_u32 v138, v227, v224
    v_xor_b32 v227, 5, v225
    v_xor_b32 v227, v227, v226
    v_lshlrev_b32 v227, 4, v227
    v_add_u32 v139, v227, v224
    v_add_u32 v139, 512, v139
    s_add_u32 m0, s5, 12288
    s_add_u32 s55, s4, 384
    buffer_load_dwordx4 v2, s[40:43], s55 offen lds
    s_add_u32 m0, s5, 13312
    s_add_u32 s55, s4, 7552
    buffer_load_dwordx4 v3, s[40:43], s55 offen lds
    s_add_u32 m0, s5, 14336
    s_add_u32 s55, s4, 14720
    buffer_load_dwordx4 v2, s[40:43], s55 offen lds
    s_add_u32 m0, s5, 15360
    s_add_u32 s55, s4, 21888
    buffer_load_dwordx4 v3, s[40:43], s55 offen lds
    s_waitcnt vmcnt(12)
    ds_read_b128 v[16:19], v140 offset:0
    ds_read_b128 v[20:23], v141 offset:0
    ds_read_b128 v[24:27], v142 offset:0
    ds_read_b128 v[28:31], v143 offset:0
    ds_read_b64_tr_b16 a[32:33], v136 offset:0
    ds_read_b64_tr_b16 a[34:35], v137 offset:0
    ds_read_b64_tr_b16 a[36:37], v136 offset:2048
    ds_read_b64_tr_b16 a[38:39], v137 offset:2048
    ds_read_b64_tr_b16 a[40:41], v138 offset:0
    ds_read_b64_tr_b16 a[42:43], v139 offset:0
    ds_read_b64_tr_b16 a[44:45], v138 offset:2048
    ds_read_b64_tr_b16 a[46:47], v139 offset:2048
    s_add_u32 m0, s5, 16384
    s_add_u32 s55, s4, 512
    buffer_load_dwordx4 v2, s[40:43], s55 offen lds
    s_add_u32 m0, s5, 17408
    s_add_u32 s55, s4, 7680
    buffer_load_dwordx4 v3, s[40:43], s55 offen lds
    s_add_u32 m0, s5, 18432
    s_add_u32 s55, s4, 14848
    buffer_load_dwordx4 v2, s[40:43], s55 offen lds
    s_add_u32 m0, s5, 19456
    s_add_u32 s55, s4, 22016
    buffer_load_dwordx4 v3, s[40:43], s55 offen lds
    s_waitcnt vmcnt(12)
    s_waitcnt lgkmcnt(0)
    ds_read_b128 v[32:35], v140 offset:4096
    ds_read_b128 v[36:39], v141 offset:4096
    ds_read_b128 v[40:43], v142 offset:4096
    ds_read_b128 v[44:47], v143 offset:4096
    ds_read_b64_tr_b16 a[48:49], v136 offset:4096
    ds_read_b64_tr_b16 a[50:51], v137 offset:4096
    ds_read_b64_tr_b16 a[52:53], v136 offset:6144
    ds_read_b64_tr_b16 a[54:55], v137 offset:6144
    ds_read_b64_tr_b16 a[56:57], v138 offset:4096
    ds_read_b64_tr_b16 a[58:59], v139 offset:4096
    ds_read_b64_tr_b16 a[60:61], v138 offset:6144
    ds_read_b64_tr_b16 a[62:63], v139 offset:6144
    v_dot2c_f32_bf16 v232, 0x3f803f80, v16
    v_dot2c_f32_bf16 v128, v16, v16
    v_dot2c_f32_bf16 v233, 0x3f803f80, v17
    v_dot2c_f32_bf16 v129, v17, v17
    v_dot2c_f32_bf16 v234, 0x3f803f80, v18
    v_dot2c_f32_bf16 v130, v18, v18
    v_dot2c_f32_bf16 v235, 0x3f803f80, v19
    v_dot2c_f32_bf16 v131, v19, v19
    v_dot2c_f32_bf16 v236, 0x3f803f80, v20
    v_dot2c_f32_bf16 v132, v20, v20
    v_dot2c_f32_bf16 v237, 0x3f803f80, v21
    v_dot2c_f32_bf16 v133, v21, v21
    v_dot2c_f32_bf16 v238, 0x3f803f80, v22
    v_dot2c_f32_bf16 v134, v22, v22
    v_dot2c_f32_bf16 v239, 0x3f803f80, v23
    v_dot2c_f32_bf16 v135, v23, v23
    v_dot2c_f32_bf16 v232, 0x3f803f80, v24
    v_dot2c_f32_bf16 v128, v24, v24
    v_dot2c_f32_bf16 v233, 0x3f803f80, v25
    v_dot2c_f32_bf16 v129, v25, v25
    v_dot2c_f32_bf16 v234, 0x3f803f80, v26
    v_dot2c_f32_bf16 v130, v26, v26
    v_dot2c_f32_bf16 v235, 0x3f803f80, v27
    v_dot2c_f32_bf16 v131, v27, v27
    v_dot2c_f32_bf16 v236, 0x3f803f80, v28
    v_dot2c_f32_bf16 v132, v28, v28
    v_dot2c_f32_bf16 v237, 0x3f803f80, v29
    v_dot2c_f32_bf16 v133, v29, v29
    v_dot2c_f32_bf16 v238, 0x3f803f80, v30
    v_dot2c_f32_bf16 v134, v30, v30
    v_dot2c_f32_bf16 v239, 0x3f803f80, v31
    v_dot2c_f32_bf16 v135, v31, v31
    s_add_u32 m0, s5, 20480
    s_add_u32 s55, s4, 640
    buffer_load_dwordx4 v2, s[40:43], s55 offen lds
    s_add_u32 m0, s5, 21504
    s_add_u32 s55, s4, 7808
    buffer_load_dwordx4 v3, s[40:43], s55 offen lds
    s_add_u32 m0, s5, 22528
    s_add_u32 s55, s4, 14976
    buffer_load_dwordx4 v2, s[40:43], s55 offen lds
    s_add_u32 m0, s5, 23552
    s_add_u32 s55, s4, 22144
    buffer_load_dwordx4 v3, s[40:43], s55 offen lds
    s_waitcnt vmcnt(12)
    s_waitcnt lgkmcnt(0)
    ds_read_b128 v[48:51], v140 offset:8192
    ds_read_b128 v[52:55], v141 offset:8192
    ds_read_b128 v[56:59], v142 offset:8192
    ds_read_b128 v[60:63], v143 offset:8192
    ds_read_b64_tr_b16 a[64:65], v136 offset:8192
    ds_read_b64_tr_b16 a[66:67], v137 offset:8192
    ds_read_b64_tr_b16 a[68:69], v136 offset:10240
    ds_read_b64_tr_b16 a[70:71], v137 offset:10240
    ds_read_b64_tr_b16 a[72:73], v138 offset:8192
    ds_read_b64_tr_b16 a[74:75], v139 offset:8192
    ds_read_b64_tr_b16 a[76:77], v138 offset:10240
    ds_read_b64_tr_b16 a[78:79], v139 offset:10240
    v_dot2c_f32_bf16 v232, 0x3f803f80, v32
    v_dot2c_f32_bf16 v128, v32, v32
    v_dot2c_f32_bf16 v233, 0x3f803f80, v33
    v_dot2c_f32_bf16 v129, v33, v33
    v_dot2c_f32_bf16 v234, 0x3f803f80, v34
    v_dot2c_f32_bf16 v130, v34, v34
    v_dot2c_f32_bf16 v235, 0x3f803f80, v35
    v_dot2c_f32_bf16 v131, v35, v35
    v_dot2c_f32_bf16 v236, 0x3f803f80, v36
    v_dot2c_f32_bf16 v132, v36, v36
    v_dot2c_f32_bf16 v237, 0x3f803f80, v37
    v_dot2c_f32_bf16 v133, v37, v37
    v_dot2c_f32_bf16 v238, 0x3f803f80, v38
    v_dot2c_f32_bf16 v134, v38, v38
    v_dot2c_f32_bf16 v239, 0x3f803f80, v39
    v_dot2c_f32_bf16 v135, v39, v39
    v_dot2c_f32_bf16 v232, 0x3f803f80, v40
    v_dot2c_f32_bf16 v128, v40, v40
    v_dot2c_f32_bf16 v233, 0x3f803f80, v41
    v_dot2c_f32_bf16 v129, v41, v41
    v_dot2c_f32_bf16 v234, 0x3f803f80, v42
    v_dot2c_f32_bf16 v130, v42, v42
    v_dot2c_f32_bf16 v235, 0x3f803f80, v43
    v_dot2c_f32_bf16 v131, v43, v43
    v_dot2c_f32_bf16 v236, 0x3f803f80, v44
    v_dot2c_f32_bf16 v132, v44, v44
    v_dot2c_f32_bf16 v237, 0x3f803f80, v45
    v_dot2c_f32_bf16 v133, v45, v45
    v_dot2c_f32_bf16 v238, 0x3f803f80, v46
    v_dot2c_f32_bf16 v134, v46, v46
    v_dot2c_f32_bf16 v239, 0x3f803f80, v47
    v_dot2c_f32_bf16 v135, v47, v47
    s_add_u32 m0, s5, 24576
    s_add_u32 s55, s4, 768
    buffer_load_dwordx4 v2, s[40:43], s55 offen lds
    s_add_u32 m0, s5, 25600
    s_add_u32 s55, s4, 7936
    buffer_load_dwordx4 v3, s[40:43], s55 offen lds
    s_add_u32 m0, s5, 26624
    s_add_u32 s55, s4, 15104
    buffer_load_dwordx4 v2, s[40:43], s55 offen lds
    s_add_u32 m0, s5, 27648
    s_add_u32 s55, s4, 22272
    buffer_load_dwordx4 v3, s[40:43], s55 offen lds
    s_waitcnt vmcnt(12)
    s_waitcnt lgkmcnt(0)
    ds_read_b128 v[64:67], v140 offset:12288
    ds_read_b128 v[68:71], v141 offset:12288
    ds_read_b128 v[72:75], v142 offset:12288
    ds_read_b128 v[76:79], v143 offset:12288
    ds_read_b64_tr_b16 a[80:81], v136 offset:12288
    ds_read_b64_tr_b16 a[82:83], v137 offset:12288
    ds_read_b64_tr_b16 a[84:85], v136 offset:14336
    ds_read_b64_tr_b16 a[86:87], v137 offset:14336
    ds_read_b64_tr_b16 a[88:89], v138 offset:12288
    ds_read_b64_tr_b16 a[90:91], v139 offset:12288
    ds_read_b64_tr_b16 a[92:93], v138 offset:14336
    ds_read_b64_tr_b16 a[94:95], v139 offset:14336
    v_dot2c_f32_bf16 v232, 0x3f803f80, v48
    v_dot2c_f32_bf16 v128, v48, v48
    v_dot2c_f32_bf16 v233, 0x3f803f80, v49
    v_dot2c_f32_bf16 v129, v49, v49
    v_dot2c_f32_bf16 v234, 0x3f803f80, v50
    v_dot2c_f32_bf16 v130, v50, v50
    v_dot2c_f32_bf16 v235, 0x3f803f80, v51
    v_dot2c_f32_bf16 v131, v51, v51
    v_dot2c_f32_bf16 v236, 0x3f803f80, v52
    v_dot2c_f32_bf16 v132, v52, v52
    v_dot2c_f32_bf16 v237, 0x3f803f80, v53
    v_dot2c_f32_bf16 v133, v53, v53
    v_dot2c_f32_bf16 v238, 0x3f803f80, v54
    v_dot2c_f32_bf16 v134, v54, v54
    v_dot2c_f32_bf16 v239, 0x3f803f80, v55
    v_dot2c_f32_bf16 v135, v55, v55
    v_dot2c_f32_bf16 v232, 0x3f803f80, v56
    v_dot2c_f32_bf16 v128, v56, v56
    v_dot2c_f32_bf16 v233, 0x3f803f80, v57
    v_dot2c_f32_bf16 v129, v57, v57
    v_dot2c_f32_bf16 v234, 0x3f803f80, v58
    v_dot2c_f32_bf16 v130, v58, v58
    v_dot2c_f32_bf16 v235, 0x3f803f80, v59
    v_dot2c_f32_bf16 v131, v59, v59
    v_dot2c_f32_bf16 v236, 0x3f803f80, v60
    v_dot2c_f32_bf16 v132, v60, v60
    v_dot2c_f32_bf16 v237, 0x3f803f80, v61
    v_dot2c_f32_bf16 v133, v61, v61
    v_dot2c_f32_bf16 v238, 0x3f803f80, v62
    v_dot2c_f32_bf16 v134, v62, v62
    v_dot2c_f32_bf16 v239, 0x3f803f80, v63
    v_dot2c_f32_bf16 v135, v63, v63
    s_add_u32 m0, s52, 0
    s_add_u32 s55, s62, 0
    buffer_load_dwordx4 v8, s[44:47], s55 offen lds
    s_waitcnt vmcnt(9)
    s_waitcnt lgkmcnt(0)
    ds_read_b128 v[80:83], v140 offset:16384
    ds_read_b128 v[84:87], v141 offset:16384
    ds_read_b128 v[88:91], v142 offset:16384
    ds_read_b128 v[92:95], v143 offset:16384
    ds_read_b64_tr_b16 a[96:97], v136 offset:16384
    ds_read_b64_tr_b16 a[98:99], v137 offset:16384
    ds_read_b64_tr_b16 a[100:101], v136 offset:18432
    ds_read_b64_tr_b16 a[102:103], v137 offset:18432
    ds_read_b64_tr_b16 a[104:105], v138 offset:16384
    ds_read_b64_tr_b16 a[106:107], v139 offset:16384
    ds_read_b64_tr_b16 a[108:109], v138 offset:18432
    ds_read_b64_tr_b16 a[110:111], v139 offset:18432
    v_dot2c_f32_bf16 v232, 0x3f803f80, v64
    v_dot2c_f32_bf16 v128, v64, v64
    v_dot2c_f32_bf16 v233, 0x3f803f80, v65
    v_dot2c_f32_bf16 v129, v65, v65
    v_dot2c_f32_bf16 v234, 0x3f803f80, v66
    v_dot2c_f32_bf16 v130, v66, v66
    v_dot2c_f32_bf16 v235, 0x3f803f80, v67
    v_dot2c_f32_bf16 v131, v67, v67
    v_dot2c_f32_bf16 v236, 0x3f803f80, v68
    v_dot2c_f32_bf16 v132, v68, v68
    v_dot2c_f32_bf16 v237, 0x3f803f80, v69
    v_dot2c_f32_bf16 v133, v69, v69
    v_dot2c_f32_bf16 v238, 0x3f803f80, v70
    v_dot2c_f32_bf16 v134, v70, v70
    v_dot2c_f32_bf16 v239, 0x3f803f80, v71
    v_dot2c_f32_bf16 v135, v71, v71
    v_dot2c_f32_bf16 v232, 0x3f803f80, v72
    v_dot2c_f32_bf16 v128, v72, v72
    v_dot2c_f32_bf16 v233, 0x3f803f80, v73
    v_dot2c_f32_bf16 v129, v73, v73
    v_dot2c_f32_bf16 v234, 0x3f803f80, v74
    v_dot2c_f32_bf16 v130, v74, v74
    v_dot2c_f32_bf16 v235, 0x3f803f80, v75
    v_dot2c_f32_bf16 v131, v75, v75
    v_dot2c_f32_bf16 v236, 0x3f803f80, v76
    v_dot2c_f32_bf16 v132, v76, v76
    v_dot2c_f32_bf16 v237, 0x3f803f80, v77
    v_dot2c_f32_bf16 v133, v77, v77
    v_dot2c_f32_bf16 v238, 0x3f803f80, v78
    v_dot2c_f32_bf16 v134, v78, v78
    v_dot2c_f32_bf16 v239, 0x3f803f80, v79
    v_dot2c_f32_bf16 v135, v79, v79
    s_add_u32 m0, s52, 1024
    s_add_u32 s55, s62, 21504
    buffer_load_dwordx4 v8, s[44:47], s55 offen lds
    s_waitcnt vmcnt(6)
    s_waitcnt lgkmcnt(0)
    ds_read_b128 v[96:99], v140 offset:20480
    ds_read_b128 v[100:103], v141 offset:20480
    ds_read_b128 v[104:107], v142 offset:20480
    ds_read_b128 v[108:111], v143 offset:20480
    ds_read_b64_tr_b16 a[112:113], v136 offset:20480
    ds_read_b64_tr_b16 a[114:115], v137 offset:20480
    ds_read_b64_tr_b16 a[116:117], v136 offset:22528
    ds_read_b64_tr_b16 a[118:119], v137 offset:22528
    ds_read_b64_tr_b16 a[120:121], v138 offset:20480
    ds_read_b64_tr_b16 a[122:123], v139 offset:20480
    ds_read_b64_tr_b16 a[124:125], v138 offset:22528
    ds_read_b64_tr_b16 a[126:127], v139 offset:22528
    v_dot2c_f32_bf16 v232, 0x3f803f80, v80
    v_dot2c_f32_bf16 v128, v80, v80
    v_dot2c_f32_bf16 v233, 0x3f803f80, v81
    v_dot2c_f32_bf16 v129, v81, v81
    v_dot2c_f32_bf16 v234, 0x3f803f80, v82
    v_dot2c_f32_bf16 v130, v82, v82
    v_dot2c_f32_bf16 v235, 0x3f803f80, v83
    v_dot2c_f32_bf16 v131, v83, v83
    v_dot2c_f32_bf16 v236, 0x3f803f80, v84
    v_dot2c_f32_bf16 v132, v84, v84
    v_dot2c_f32_bf16 v237, 0x3f803f80, v85
    v_dot2c_f32_bf16 v133, v85, v85
    v_dot2c_f32_bf16 v238, 0x3f803f80, v86
    v_dot2c_f32_bf16 v134, v86, v86
    v_dot2c_f32_bf16 v239, 0x3f803f80, v87
    v_dot2c_f32_bf16 v135, v87, v87
    v_dot2c_f32_bf16 v232, 0x3f803f80, v88
    v_dot2c_f32_bf16 v128, v88, v88
    v_dot2c_f32_bf16 v233, 0x3f803f80, v89
    v_dot2c_f32_bf16 v129, v89, v89
    v_dot2c_f32_bf16 v234, 0x3f803f80, v90
    v_dot2c_f32_bf16 v130, v90, v90
    v_dot2c_f32_bf16 v235, 0x3f803f80, v91
    v_dot2c_f32_bf16 v131, v91, v91
    v_dot2c_f32_bf16 v236, 0x3f803f80, v92
    v_dot2c_f32_bf16 v132, v92, v92
    v_dot2c_f32_bf16 v237, 0x3f803f80, v93
    v_dot2c_f32_bf16 v133, v93, v93
    v_dot2c_f32_bf16 v238, 0x3f803f80, v94
    v_dot2c_f32_bf16 v134, v94, v94
    v_dot2c_f32_bf16 v239, 0x3f803f80, v95
    v_dot2c_f32_bf16 v135, v95, v95
    s_add_u32 m0, s52, 2048
    s_add_u32 s55, s62, 43008
    buffer_load_dwordx4 v8, s[44:47], s55 offen lds
    s_waitcnt vmcnt(3)
    s_waitcnt lgkmcnt(0)
    ds_read_b128 v[112:115], v140 offset:24576
    ds_read_b128 v[116:119], v141 offset:24576
    ds_read_b128 v[120:123], v142 offset:24576
    ds_read_b128 v[124:127], v143 offset:24576
    ds_read_b64_tr_b16 a[128:129], v136 offset:24576
    ds_read_b64_tr_b16 a[130:131], v137 offset:24576
    ds_read_b64_tr_b16 a[132:133], v136 offset:26624
    ds_read_b64_tr_b16 a[134:135], v137 offset:26624
    ds_read_b64_tr_b16 a[136:137], v138 offset:24576
    ds_read_b64_tr_b16 a[138:139], v139 offset:24576
    ds_read_b64_tr_b16 a[140:141], v138 offset:26624
    ds_read_b64_tr_b16 a[142:143], v139 offset:26624
    v_dot2c_f32_bf16 v232, 0x3f803f80, v96
    v_dot2c_f32_bf16 v128, v96, v96
    v_dot2c_f32_bf16 v233, 0x3f803f80, v97
    v_dot2c_f32_bf16 v129, v97, v97
    v_dot2c_f32_bf16 v234, 0x3f803f80, v98
    v_dot2c_f32_bf16 v130, v98, v98
    v_dot2c_f32_bf16 v235, 0x3f803f80, v99
    v_dot2c_f32_bf16 v131, v99, v99
    v_dot2c_f32_bf16 v236, 0x3f803f80, v100
    v_dot2c_f32_bf16 v132, v100, v100
    v_dot2c_f32_bf16 v237, 0x3f803f80, v101
    v_dot2c_f32_bf16 v133, v101, v101
    v_dot2c_f32_bf16 v238, 0x3f803f80, v102
    v_dot2c_f32_bf16 v134, v102, v102
    v_dot2c_f32_bf16 v239, 0x3f803f80, v103
    v_dot2c_f32_bf16 v135, v103, v103
    v_dot2c_f32_bf16 v232, 0x3f803f80, v104
    v_dot2c_f32_bf16 v128, v104, v104
    v_dot2c_f32_bf16 v233, 0x3f803f80, v105
    v_dot2c_f32_bf16 v129, v105, v105
    v_dot2c_f32_bf16 v234, 0x3f803f80, v106
    v_dot2c_f32_bf16 v130, v106, v106
    v_dot2c_f32_bf16 v235, 0x3f803f80, v107
    v_dot2c_f32_bf16 v131, v107, v107
    v_dot2c_f32_bf16 v236, 0x3f803f80, v108
    v_dot2c_f32_bf16 v132, v108, v108
    v_dot2c_f32_bf16 v237, 0x3f803f80, v109
    v_dot2c_f32_bf16 v133, v109, v109
    v_dot2c_f32_bf16 v238, 0x3f803f80, v110
    v_dot2c_f32_bf16 v134, v110, v110
    v_dot2c_f32_bf16 v239, 0x3f803f80, v111
    v_dot2c_f32_bf16 v135, v111, v111
    s_add_u32 m0, s52, 3072
    s_add_u32 s55, s62, 64512
    buffer_load_dwordx4 v8, s[44:47], s55 offen lds
    s_add_u32 m0, s52, 4096
    s_add_u32 s55, s62, 86016
    buffer_load_dwordx4 v8, s[44:47], s55 offen lds
    s_add_u32 m0, s52, 5120
    s_add_u32 s55, s62, 107520
    buffer_load_dwordx4 v8, s[44:47], s55 offen lds
    s_add_u32 m0, s52, 6144
    s_add_u32 s55, s62, 129024
    buffer_load_dwordx4 v8, s[44:47], s55 offen lds
    s_mul_i32 s7, s37, 14
    s_lshl_b32 s8, s36, 2
    s_min_u32 s8, s8, 10
    s_add_u32 s7, s7, s8
    v_min_u32 v230, 7, v1
    v_lshrrev_b32 v231, 1, v230
    v_add_u32 v231, s7, v231
    v_mul_u32_u24 v231, 2688, v231
    v_and_b32 v230, 1, v230
    v_mul_u32_u24 v230, 108, v230
    v_add_u32 v2, v230, v231
    s_mul_i32 s7, s37, 7
    s_and_b32 s8, s36, 1
    s_mul_i32 s8, s8, 3
    s_add_u32 s7, s7, s8
    v_min_u32 v231, 3, v1
    v_add_u32 v231, s7, v231
    v_mul_u32_u24 v254, 3584, v231
    v_mov_b32 v246, 17563648
    s_or_b32 s9, s2, s36
    s_cmp_lg_u32 s9, 0
    s_cbranch_scc1 no_epoch_ld
    global_load_dword v247, v246, s[34:35] sc1
no_epoch_ld:
    s_lshl_b32 s4, s15, 4
    s_add_u32 s4, s4, s38
    s_lshl_b32 s4, s4, 7
    s_add_u32 s4, s4, 16777216
    v_mov_b32 v5, s4
    s_lshl_b32 s4, s15, 4
    s_add_u32 s4, s4, s38
    s_lshl_b32 s4, s4, 7
    s_add_u32 s4, s4, 17104896
    v_mov_b32 v7, s4
    s_sub_u32 s5, s38, 12
    s_lshl_b32 s4, s15, 2
    s_add_u32 s4, s4, s5
    s_lshl_b32 s4, s4, 7
    s_add_u32 s4, s4, 17039360
    v_mov_b32 v6, s4
    s_lshl_b32 s4, s36, 4
    v_and_b32 v3, 15, v1
    v_add_u32 v3, s4, v3
    s_lshr_b32 s5, s10, 1
    s_add_u32 s6, s5, 8
    v_lshlrev_b32 v252, 4, v3
    v_add_u32 v252, s6, v252
    v_lshlrev_b32 v252, 7, v252
    v_add_u32 v252, 16777216, v252
    s_lshr_b32 s6, s10, 2
    v_lshlrev_b32 v253, 2, v3
    v_add_u32 v253, s6, v253
    v_lshlrev_b32 v253, 7, v253
    v_add_u32 v253, 17039360, v253
    s_lshl_b32 s6, s11, 2
    v_and_b32 v3, 3, v1
    v_add_u32 v3, s6, v3
    v_lshlrev_b32 v3, 4, v3
    v_add_u32 v3, s5, v3
    v_lshlrev_b32 v3, 7, v3
    v_add_u32 v3, 16777216, v3
    v_cmp_gt_u32 vcc, 32, v1
    s_nop 1
    v_cndmask_b32 v3, v3, v253, vcc
    v_cmp_gt_u32 vcc, 16, v1
    s_nop 1
    v_cndmask_b32 v3, v3, v252, vcc
    s_waitcnt lgkmcnt(8)
    v_dot2c_f32_bf16 v232, 0x3f803f80, v112
    v_dot2c_f32_bf16 v128, v112, v112
    v_dot2c_f32_bf16 v233, 0x3f803f80, v113
    v_dot2c_f32_bf16 v129, v113, v113
    v_dot2c_f32_bf16 v234, 0x3f803f80, v114
    v_dot2c_f32_bf16 v130, v114, v114
    v_dot2c_f32_bf16 v235, 0x3f803f80, v115
    v_dot2c_f32_bf16 v131, v115, v115
    v_dot2c_f32_bf16 v236, 0x3f803f80, v116
    v_dot2c_f32_bf16 v132, v116, v116
    v_dot2c_f32_bf16 v237, 0x3f803f80, v117
    v_dot2c_f32_bf16 v133, v117, v117
    v_dot2c_f32_bf16 v238, 0x3f803f80, v118
    v_dot2c_f32_bf16 v134, v118, v118
    v_dot2c_f32_bf16 v239, 0x3f803f80, v119
    v_dot2c_f32_bf16 v135, v119, v119
    v_dot2c_f32_bf16 v232, 0x3f803f80, v120
    v_dot2c_f32_bf16 v128, v120, v120
    v_dot2c_f32_bf16 v233, 0x3f803f80, v121
    v_dot2c_f32_bf16 v129, v121, v121
    v_dot2c_f32_bf16 v234, 0x3f803f80, v122
    v_dot2c_f32_bf16 v130, v122, v122
    v_dot2c_f32_bf16 v235, 0x3f803f80, v123
    v_dot2c_f32_bf16 v131, v123, v123
    v_dot2c_f32_bf16 v236, 0x3f803f80, v124
    v_dot2c_f32_bf16 v132, v124, v124
    v_dot2c_f32_bf16 v237, 0x3f803f80, v125
    v_dot2c_f32_bf16 v133, v125, v125
    v_dot2c_f32_bf16 v238, 0x3f803f80, v126
    v_dot2c_f32_bf16 v134, v126, v126
    v_dot2c_f32_bf16 v239, 0x3f803f80, v127
    v_dot2c_f32_bf16 v135, v127, v127
    s_nop 2
    s_waitcnt lgkmcnt(0)
    v_add_f32 v232, v232, v236
    v_add_f32 v233, v233, v237
    v_add_f32 v234, v234, v238
    v_add_f32 v235, v235, v239
    v_add_f32 v232, v232, v233
    v_add_f32 v234, v234, v235
    v_add_f32 v232, v232, v234
    v_mov_b32 v233, v232
    s_nop 1
    v_permlane32_swap_b32 v232, v233
    s_nop 0
    v_add_f32 v232, v232, v233
    v_mul_f32 v232, 0xbb124925, v232
    v_mov_b32 v144, v232
    v_mov_b32 v145, v232
    v_mov_b32 v146, v232
    v_mov_b32 v147, v232
    v_mov_b32 v148, v232
    v_mov_b32 v149, v232
    v_mov_b32 v150, v232
    v_mov_b32 v151, v232
    v_mov_b32 v152, v232
    v_mov_b32 v153, v232
    v_mov_b32 v154, v232
    v_mov_b32 v155, v232
    v_mov_b32 v156, v232
    v_mov_b32 v157, v232
    v_mov_b32 v158, v232
    v_mov_b32 v159, v232
    v_add_f32 v128, v128, v132
    v_add_f32 v129, v129, v133
    v_add_f32 v130, v130, v134
    v_add_f32 v131, v131, v135
    v_add_f32 v128, v128, v129
    v_add_f32 v130, v130, v131
    v_add_f32 v128, v128, v130
    v_mov_b32 v129, v128
    s_nop 1
    v_permlane32_swap_b32 v128, v129
    s_nop 0
    v_add_f32 v128, v128, v129
    v_mul_f32 v128, 0x3b124925, v128
    v_fma_f32 v128, -v232, v232, v128
    v_max_f32 v128, 0, v128
    v_add_f32 v15, 0x3727c5ac, v128
    v_rsq_f32 v128, v15
    s_nop 0
    v_mul_f32 v14, 0xbfb8aa3b, v128
    v_mul_f32 v129, 0x3e8b97f6, v128
    s_cmp_lt_u32 s38, 8
    s_cselect_b64 s[4:5], -1, 0
    s_nop 1
    v_cndmask_b32 v196, v128, v129, s[4:5]
    s_barrier
    s_or_b32 s9, s2, s36
    s_cmp_lg_u32 s9, 0
    s_cbranch_scc1 no_epoch_st
    s_waitcnt vmcnt(0)
    v_add_u32 v247, 1, v247
    v_max_u32 v247, 1, v247
    v_mov_b32 v248, 0
    s_mov_b64 exec, 1
    global_store_dword v246, v247, s[34:35] sc1
    global_store_dword v248, v247, s[32:33] sc1
    s_mov_b64 exec, -1
no_epoch_st:
    s_cmp_ge_u32 s38, 12
    s_cbranch_scc1 path_b
    v_mfma_f32_32x32x16_bf16 v[220:235], a[32:35], v[160:163], v[144:159]
    v_mfma_f32_32x32x16_bf16 v[220:235], a[36:39], v[164:167], v[220:235]
    s_sub_u32 s98, s65, s54
    s_add_u32 s98, s98, 0
    buffer_load_dword v255, v254, s[48:51], s98 offen
    s_nop 7
    s_nop 3
    v_mfma_f32_32x32x16_bf16 v[236:251], a[40:43], v[160:163], v[144:159]
    v_mfma_f32_32x32x16_bf16 v[236:251], a[44:47], v[164:167], v[236:251]
    s_sub_u32 s98, s65, s54
    s_add_u32 s98, s98, 401408
    buffer_load_dword v255, v254, s[48:51], s98 offen
    v_cvt_pk_bf16_f32 v16, v220, v221
    v_cvt_pk_bf16_f32 v17, v222, v223
    v_cvt_pk_bf16_f32 v18, v224, v225
    v_cvt_pk_bf16_f32 v19, v226, v227
    v_cvt_pk_bf16_f32 v20, v228, v229
    v_cvt_pk_bf16_f32 v21, v230, v231
    v_cvt_pk_bf16_f32 v22, v232, v233
    v_cvt_pk_bf16_f32 v23, v234, v235
    s_nop 3
    v_mfma_f32_32x32x16_bf16 v[220:235], a[48:51], v[160:163], v[144:159]
    v_mfma_f32_32x32x16_bf16 v[220:235], a[52:55], v[164:167], v[220:235]
    s_sub_u32 s98, s65, s54
    s_add_u32 s98, s98, 802816
    buffer_load_dword v255, v254, s[48:51], s98 offen
    v_cvt_pk_bf16_f32 v24, v236, v237
    v_cvt_pk_bf16_f32 v25, v238, v239
    v_cvt_pk_bf16_f32 v26, v240, v241
    v_cvt_pk_bf16_f32 v27, v242, v243
    v_cvt_pk_bf16_f32 v28, v244, v245
    v_cvt_pk_bf16_f32 v29, v246, v247
    v_cvt_pk_bf16_f32 v30, v248, v249
    v_cvt_pk_bf16_f32 v31, v250, v251
    s_nop 3
    v_mfma_f32_32x32x16_bf16 v[236:251], a[56:59], v[160:163], v[144:159]
    v_mfma_f32_32x32x16_bf16 v[236:251], a[60:63], v[164:167], v[236:251]
    v_cvt_pk_bf16_f32 v32, v220, v221
    v_cvt_pk_bf16_f32 v33, v222, v223
    v_cvt_pk_bf16_f32 v34, v224, v225
    v_cvt_pk_bf16_f32 v35, v226, v227
    v_cvt_pk_bf16_f32 v36, v228, v229
    v_cvt_pk_bf16_f32 v37, v230, v231
    v_cvt_pk_bf16_f32 v38, v232, v233
    v_cvt_pk_bf16_f32 v39, v234, v235
    s_nop 3
    v_mfma_f32_32x32x16_bf16 v[220:235], a[64:67], v[160:163], v[144:159]
    v_mfma_f32_32x32x16_bf16 v[220:235], a[68:71], v[164:167], v[220:235]
    s_add_u32 m0, s52, 28672
    s_add_u32 s55, s62, 602112
    buffer_load_dwordx4 v8, s[44:47], s55 offen lds
    v_cvt_pk_bf16_f32 v40, v236, v237
    v_cvt_pk_bf16_f32 v41, v238, v239
    v_cvt_pk_bf16_f32 v42, v240, v241
    v_cvt_pk_bf16_f32 v43, v242, v243
    v_cvt_pk_bf16_f32 v44, v244, v245
    v_cvt_pk_bf16_f32 v45, v246, v247
    v_cvt_pk_bf16_f32 v46, v248, v249
    v_cvt_pk_bf16_f32 v47, v250, v251
    s_nop 3
    v_mfma_f32_32x32x16_bf16 v[236:251], a[72:75], v[160:163], v[144:159]
    v_mfma_f32_32x32x16_bf16 v[236:251], a[76:79], v[164:167], v[236:251]
    s_add_u32 m0, s52, 29696
    s_add_u32 s55, s62, 623616
    buffer_load_dwordx4 v8, s[44:47], s55 offen lds
    v_cvt_pk_bf16_f32 v48, v220, v221
    v_cvt_pk_bf16_f32 v49, v222, v223
    v_cvt_pk_bf16_f32 v50, v224, v225
    v_cvt_pk_bf16_f32 v51, v226, v227
    v_cvt_pk_bf16_f32 v52, v228, v229
    v_cvt_pk_bf16_f32 v53, v230, v231
    v_cvt_pk_bf16_f32 v54, v232, v233
    v_cvt_pk_bf16_f32 v55, v234, v235
    s_nop 3
    v_mfma_f32_32x32x16_bf16 v[220:235], a[80:83], v[160:163], v[144:159]
    v_mfma_f32_32x32x16_bf16 v[220:235], a[84:87], v[164:167], v[220:235]
    v_cvt_pk_bf16_f32 v56, v236, v237
    v_cvt_pk_bf16_f32 v57, v238, v239
    v_cvt_pk_bf16_f32 v58, v240, v241
    v_cvt_pk_bf16_f32 v59, v242, v243
    v_cvt_pk_bf16_f32 v60, v244, v245
    v_cvt_pk_bf16_f32 v61, v246, v247
    v_cvt_pk_bf16_f32 v62, v248, v249
    v_cvt_pk_bf16_f32 v63, v250, v251
    s_nop 3
    v_mfma_f32_32x32x16_bf16 v[236:251], a[88:91], v[160:163], v[144:159]
    v_mfma_f32_32x32x16_bf16 v[236:251], a[92:95], v[164:167], v[236:251]
    s_add_u32 m0, s52, 30720
    s_add_u32 s55, s62, 645120
    buffer_load_dwordx4 v8, s[44:47], s55 offen lds
    v_cvt_pk_bf16_f32 v64, v220, v221
    v_cvt_pk_bf16_f32 v65, v222, v223
    v_cvt_pk_bf16_f32 v66, v224, v225
    v_cvt_pk_bf16_f32 v67, v226, v227
    v_cvt_pk_bf16_f32 v68, v228, v229
    v_cvt_pk_bf16_f32 v69, v230, v231
    v_cvt_pk_bf16_f32 v70, v232, v233
    v_cvt_pk_bf16_f32 v71, v234, v235
    s_nop 3
    v_mfma_f32_32x32x16_bf16 v[220:235], a[96:99], v[160:163], v[144:159]
    v_mfma_f32_32x32x16_bf16 v[220:235], a[100:103], v[164:167], v[220:235]
    s_add_u32 m0, s52, 31744
    s_add_u32 s55, s62, 666624
    buffer_load_dwordx4 v8, s[44:47], s55 offen lds
    v_cvt_pk_bf16_f32 v72, v236, v237
    v_cvt_pk_bf16_f32 v73, v238, v239
    v_cvt_pk_bf16_f32 v74, v240, v241
    v_cvt_pk_bf16_f32 v75, v242, v243
    v_cvt_pk_bf16_f32 v76, v244, v245
    v_cvt_pk_bf16_f32 v77, v246, v247
    v_cvt_pk_bf16_f32 v78, v248, v249
    v_cvt_pk_bf16_f32 v79, v250, v251
    s_nop 3
    v_mfma_f32_32x32x16_bf16 v[236:251], a[104:107], v[160:163], v[144:159]
    v_mfma_f32_32x32x16_bf16 v[236:251], a[108:111], v[164:167], v[236:251]
    s_add_u32 m0, s52, 32768
    s_add_u32 s55, s62, 688128
    buffer_load_dwordx4 v8, s[44:47], s55 offen lds
    v_cvt_pk_bf16_f32 v80, v220, v221
    v_cvt_pk_bf16_f32 v81, v222, v223
    v_cvt_pk_bf16_f32 v82, v224, v225
    v_cvt_pk_bf16_f32 v83, v226, v227
    v_cvt_pk_bf16_f32 v84, v228, v229
    v_cvt_pk_bf16_f32 v85, v230, v231
    v_cvt_pk_bf16_f32 v86, v232, v233
    v_cvt_pk_bf16_f32 v87, v234, v235
    s_nop 3
    v_mfma_f32_32x32x16_bf16 v[220:235], a[112:115], v[160:163], v[144:159]
    v_mfma_f32_32x32x16_bf16 v[220:235], a[116:119], v[164:167], v[220:235]
    v_cvt_pk_bf16_f32 v88, v236, v237
    v_cvt_pk_bf16_f32 v89, v238, v239
    v_cvt_pk_bf16_f32 v90, v240, v241
    v_cvt_pk_bf16_f32 v91, v242, v243
    v_cvt_pk_bf16_f32 v92, v244, v245
    v_cvt_pk_bf16_f32 v93, v246, v247
    v_cvt_pk_bf16_f32 v94, v248, v249
    v_cvt_pk_bf16_f32 v95, v250, v251
    s_nop 3
    v_mfma_f32_32x32x16_bf16 v[236:251], a[120:123], v[160:163], v[144:159]
    v_mfma_f32_32x32x16_bf16 v[236:251], a[124:127], v[164:167], v[236:251]
    s_add_u32 m0, s52, 33792
    s_add_u32 s55, s62, 709632
    buffer_load_dwordx4 v8, s[44:47], s55 offen lds
    v_cvt_pk_bf16_f32 v96, v220, v221
    v_cvt_pk_bf16_f32 v97, v222, v223
    v_cvt_pk_bf16_f32 v98, v224, v225
    v_cvt_pk_bf16_f32 v99, v226, v227
    v_cvt_pk_bf16_f32 v100, v228, v229
    v_cvt_pk_bf16_f32 v101, v230, v231
    v_cvt_pk_bf16_f32 v102, v232, v233
    v_cvt_pk_bf16_f32 v103, v234, v235
    s_nop 3
    v_mfma_f32_32x32x16_bf16 v[220:235], a[128:131], v[160:163], v[144:159]
    v_mfma_f32_32x32x16_bf16 v[220:235], a[132:135], v[164:167], v[220:235]
    s_add_u32 m0, s52, 34816
    s_add_u32 s55, s62, 731136
    buffer_load_dwordx4 v8, s[44:47], s55 offen lds
    v_cvt_pk_bf16_f32 v104, v236, v237
    v_cvt_pk_bf16_f32 v105, v238, v239
    v_cvt_pk_bf16_f32 v106, v240, v241
    v_cvt_pk_bf16_f32 v107, v242, v243
    v_cvt_pk_bf16_f32 v108, v244, v245
    v_cvt_pk_bf16_f32 v109, v246, v247
    v_cvt_pk_bf16_f32 v110, v248, v249
    v_cvt_pk_bf16_f32 v111, v250, v251
    s_nop 3
    v_mfma_f32_32x32x16_bf16 v[236:251], a[136:139], v[160:163], v[144:159]
    v_mfma_f32_32x32x16_bf16 v[236:251], a[140:143], v[164:167], v[236:251]
    v_cvt_pk_bf16_f32 v112, v220, v221
    v_cvt_pk_bf16_f32 v113, v222, v223
    v_cvt_pk_bf16_f32 v114, v224, v225
    v_cvt_pk_bf16_f32 v115, v226, v227
    v_cvt_pk_bf16_f32 v116, v228, v229
    v_cvt_pk_bf16_f32 v117, v230, v231
    v_cvt_pk_bf16_f32 v118, v232, v233
    v_cvt_pk_bf16_f32 v119, v234, v235
    s_nop 3
    s_nop 7
    v_cvt_pk_bf16_f32 v120, v236, v237
    v_cvt_pk_bf16_f32 v121, v238, v239
    v_cvt_pk_bf16_f32 v122, v240, v241
    v_cvt_pk_bf16_f32 v123, v242, v243
    v_cvt_pk_bf16_f32 v124, v244, v245
    v_cvt_pk_bf16_f32 v125, v246, v247
    v_cvt_pk_bf16_f32 v126, v248, v249
    v_cvt_pk_bf16_f32 v127, v250, v251
    v_mov_b32 v252, 0
    global_load_dword v203, v252, s[32:33] sc1
    v_add_u32 v192, 0, v10
    v_add_u32 v193, 0, v11
    s_nop 0
    s_waitcnt vmcnt(11)
    s_barrier
    ds_read_b64_tr_b16 a[0:1], v192 offset:0
    ds_read_b64_tr_b16 a[2:3], v192 offset:1024
    ds_read_b64_tr_b16 a[4:5], v193 offset:0
    ds_read_b64_tr_b16 a[6:7], v193 offset:1024
    ds_read_b64_tr_b16 a[8:9], v192 offset:2048
    ds_read_b64_tr_b16 a[10:11], v192 offset:3072
    ds_read_b64_tr_b16 a[12:13], v193 offset:2048
    ds_read_b64_tr_b16 a[14:15], v193 offset:3072
.p2align 6
    s_waitcnt lgkmcnt(6)
    v_mfma_f32_32x32x16_bf16 a[32:47], a[0:3], v[16:19], 0
    ds_read_b64_tr_b16 a[16:17], v192 offset:4096
    ds_read_b64_tr_b16 a[18:19], v192 offset:5120
    s_add_u32 m0, s52, 57344
    s_add_u32 s55, s65, 0
    buffer_load_dwordx4 v9, s[48:51], s55 offen lds
    s_waitcnt lgkmcnt(6)
    v_mfma_f32_32x32x16_bf16 a[48:63], a[4:7], v[16:19], 0
    ds_read_b64_tr_b16 a[20:21], v193 offset:4096
    ds_read_b64_tr_b16 a[22:23], v193 offset:5120
    s_waitcnt lgkmcnt(6)
    v_mfma_f32_32x32x16_bf16 a[32:47], a[8:11], v[20:23], a[32:47]
    ds_read_b64_tr_b16 a[24:25], v192 offset:6144
    ds_read_b64_tr_b16 a[26:27], v192 offset:7168
    s_add_u32 m0, s52, 58368
    s_add_u32 s55, s65, 28672
    buffer_load_dwordx4 v9, s[48:51], s55 offen lds
    s_waitcnt lgkmcnt(6)
    v_mfma_f32_32x32x16_bf16 a[48:63], a[12:15], v[20:23], a[48:63]
    ds_read_b64_tr_b16 a[28:29], v193 offset:6144
    ds_read_b64_tr_b16 a[30:31], v193 offset:7168
    s_waitcnt lgkmcnt(6)
    v_mfma_f32_32x32x16_bf16 a[32:47], a[16:19], v[24:27], a[32:47]
    ds_read_b64_tr_b16 a[0:1], v192 offset:8192
    ds_read_b64_tr_b16 a[2:3], v192 offset:9216
    s_add_u32 m0, s52, 59392
    s_add_u32 s55, s65, 57344
    buffer_load_dwordx4 v9, s[48:51], s55 offen lds
    s_waitcnt lgkmcnt(6)
    v_mfma_f32_32x32x16_bf16 a[48:63], a[20:23], v[24:27], a[48:63]
    ds_read_b64_tr_b16 a[4:5], v193 offset:8192
    ds_read_b64_tr_b16 a[6:7], v193 offset:9216
    s_waitcnt lgkmcnt(6)
    v_mfma_f32_32x32x16_bf16 a[32:47], a[24:27], v[28:31], a[32:47]
    ds_read_b64_tr_b16 a[8:9], v192 offset:10240
    ds_read_b64_tr_b16 a[10:11], v192 offset:11264
    s_add_u32 m0, s52, 60416
    s_add_u32 s55, s65, 86016
    buffer_load_dwordx4 v9, s[48:51], s55 offen lds
    s_waitcnt lgkmcnt(6)
    v_mfma_f32_32x32x16_bf16 a[48:63], a[28:31], v[28:31], a[48:63]
    ds_read_b64_tr_b16 a[12:13], v193 offset:10240
    ds_read_b64_tr_b16 a[14:15], v193 offset:11264
    s_waitcnt lgkmcnt(6)
    v_mfma_f32_32x32x16_bf16 a[32:47], a[0:3], v[32:35], a[32:47]
    ds_read_b64_tr_b16 a[16:17], v192 offset:12288
    ds_read_b64_tr_b16 a[18:19], v192 offset:13312
    s_add_u32 m0, s52, 61440
    s_add_u32 s55, s65, 114688
    buffer_load_dwordx4 v9, s[48:51], s55 offen lds
    s_waitcnt lgkmcnt(6)
    v_mfma_f32_32x32x16_bf16 a[48:63], a[4:7], v[32:35], a[48:63]
    ds_read_b64_tr_b16 a[20:21], v193 offset:12288
    ds_read_b64_tr_b16 a[22:23], v193 offset:13312
    s_waitcnt lgkmcnt(6)
    v_mfma_f32_32x32x16_bf16 a[32:47], a[8:11], v[36:39], a[32:47]
    ds_read_b64_tr_b16 a[24:25], v192 offset:14336
    ds_read_b64_tr_b16 a[26:27], v192 offset:15360
    s_add_u32 m0, s52, 62464
    s_add_u32 s55, s65, 143360
    buffer_load_dwordx4 v9, s[48:51], s55 offen lds
    s_waitcnt lgkmcnt(6)
    v_mfma_f32_32x32x16_bf16 a[48:63], a[12:15], v[36:39], a[48:63]
    ds_read_b64_tr_b16 a[28:29], v193 offset:14336
    ds_read_b64_tr_b16 a[30:31], v193 offset:15360
    s_waitcnt lgkmcnt(6)
    v_mfma_f32_32x32x16_bf16 a[32:47], a[16:19], v[40:43], a[32:47]
    ds_read_b64_tr_b16 a[0:1], v192 offset:16384
    ds_read_b64_tr_b16 a[2:3], v192 offset:17408
    s_add_u32 m0, s52, 63488
    s_add_u32 s55, s65, 172032
    buffer_load_dwordx4 v9, s[48:51], s55 offen lds
    s_waitcnt lgkmcnt(6)
    v_mfma_f32_32x32x16_bf16 a[48:63], a[20:23], v[40:43], a[48:63]
    ds_read_b64_tr_b16 a[4:5], v193 offset:16384
    ds_read_b64_tr_b16 a[6:7], v193 offset:17408
    s_waitcnt lgkmcnt(6)
    v_mfma_f32_32x32x16_bf16 a[32:47], a[24:27], v[44:47], a[32:47]
    ds_read_b64_tr_b16 a[8:9], v192 offset:18432
    ds_read_b64_tr_b16 a[10:11], v192 offset:19456
    s_add_u32 m0, s52, 86016
    s_add_u32 s55, s65, 401408
    buffer_load_dwordx4 v9, s[48:51], s55 offen lds
    s_waitcnt lgkmcnt(6)
    v_mfma_f32_32x32x16_bf16 a[48:63], a[28:31], v[44:47], a[48:63]
    ds_read_b64_tr_b16 a[12:13], v193 offset:18432
    ds_read_b64_tr_b16 a[14:15], v193 offset:19456
    s_waitcnt lgkmcnt(6)
    v_mfma_f32_32x32x16_bf16 a[32:47], a[0:3], v[48:51], a[32:47]
    ds_read_b64_tr_b16 a[16:17], v192 offset:20480
    ds_read_b64_tr_b16 a[18:19], v192 offset:21504
    s_add_u32 m0, s52, 87040
    s_add_u32 s55, s65, 430080
    buffer_load_dwordx4 v9, s[48:51], s55 offen lds
    s_waitcnt lgkmcnt(6)
    v_mfma_f32_32x32x16_bf16 a[48:63], a[4:7], v[48:51], a[48:63]
    ds_read_b64_tr_b16 a[20:21], v193 offset:20480
    ds_read_b64_tr_b16 a[22:23], v193 offset:21504
    s_waitcnt lgkmcnt(6)
    v_mfma_f32_32x32x16_bf16 a[32:47], a[8:11], v[52:55], a[32:47]
    ds_read_b64_tr_b16 a[24:25], v192 offset:22528
    ds_read_b64_tr_b16 a[26:27], v192 offset:23552
    s_add_u32 m0, s52, 88064
    s_add_u32 s55, s65, 458752
    buffer_load_dwordx4 v9, s[48:51], s55 offen lds
    s_waitcnt lgkmcnt(6)
    v_mfma_f32_32x32x16_bf16 a[48:63], a[12:15], v[52:55], a[48:63]
    ds_read_b64_tr_b16 a[28:29], v193 offset:22528
    ds_read_b64_tr_b16 a[30:31], v193 offset:23552
    s_waitcnt lgkmcnt(6)
    v_mfma_f32_32x32x16_bf16 a[32:47], a[16:19], v[56:59], a[32:47]
    ds_read_b64_tr_b16 a[0:1], v192 offset:24576
    ds_read_b64_tr_b16 a[2:3], v192 offset:25600
    s_add_u32 m0, s52, 89088
    s_add_u32 s55, s65, 487424
    buffer_load_dwordx4 v9, s[48:51], s55 offen lds
    s_waitcnt lgkmcnt(6)
    v_mfma_f32_32x32x16_bf16 a[48:63], a[20:23], v[56:59], a[48:63]
    ds_read_b64_tr_b16 a[4:5], v193 offset:24576
    ds_read_b64_tr_b16 a[6:7], v193 offset:25600
    s_waitcnt lgkmcnt(6)
    v_mfma_f32_32x32x16_bf16 a[32:47], a[24:27], v[60:63], a[32:47]
    ds_read_b64_tr_b16 a[8:9], v192 offset:26624
    ds_read_b64_tr_b16 a[10:11], v192 offset:27648
    s_add_u32 m0, s52, 90112
    s_add_u32 s55, s65, 516096
    buffer_load_dwordx4 v9, s[48:51], s55 offen lds
    s_waitcnt lgkmcnt(6)
    v_mfma_f32_32x32x16_bf16 a[48:63], a[28:31], v[60:63], a[48:63]
    ds_read_b64_tr_b16 a[12:13], v193 offset:26624
    ds_read_b64_tr_b16 a[14:15], v193 offset:27648
    s_waitcnt lgkmcnt(6)
    v_mfma_f32_32x32x16_bf16 a[32:47], a[0:3], v[64:67], a[32:47]
    v_add_u32 v194, 28672, v10
    v_add_u32 v195, 28672, v11
    s_waitcnt vmcnt(13)
    s_barrier
    ds_read_b64_tr_b16 a[16:17], v194 offset:0
    ds_read_b64_tr_b16 a[18:19], v194 offset:1024
    s_add_u32 m0, s52, 91136
    s_add_u32 s55, s65, 544768
    buffer_load_dwordx4 v9, s[48:51], s55 offen lds
    s_waitcnt lgkmcnt(6)
    v_mfma_f32_32x32x16_bf16 a[48:63], a[4:7], v[64:67], a[48:63]
    ds_read_b64_tr_b16 a[20:21], v195 offset:0
    ds_read_b64_tr_b16 a[22:23], v195 offset:1024
    s_waitcnt lgkmcnt(6)
    v_mfma_f32_32x32x16_bf16 a[32:47], a[8:11], v[68:71], a[32:47]
    ds_read_b64_tr_b16 a[24:25], v194 offset:2048
    ds_read_b64_tr_b16 a[26:27], v194 offset:3072
    s_add_u32 m0, s52, 92160
    s_add_u32 s55, s65, 573440
    buffer_load_dwordx4 v9, s[48:51], s55 offen lds
    s_waitcnt lgkmcnt(6)
    v_mfma_f32_32x32x16_bf16 a[48:63], a[12:15], v[68:71], a[48:63]
    ds_read_b64_tr_b16 a[28:29], v195 offset:2048
    ds_read_b64_tr_b16 a[30:31], v195 offset:3072
    s_waitcnt lgkmcnt(6)
    v_mfma_f32_32x32x16_bf16 a[32:47], a[16:19], v[72:75], a[32:47]
    ds_read_b64_tr_b16 a[0:1], v194 offset:4096
    ds_read_b64_tr_b16 a[2:3], v194 offset:5120
    s_sub_u32 s98, s65, s54
    s_add_u32 s98, s98, 1204224
    buffer_load_dword v255, v254, s[48:51], s98 offen
    s_waitcnt lgkmcnt(6)
    v_mfma_f32_32x32x16_bf16 a[48:63], a[20:23], v[72:75], a[48:63]
    ds_read_b64_tr_b16 a[4:5], v195 offset:4096
    ds_read_b64_tr_b16 a[6:7], v195 offset:5120
    s_add_u32 m0, s52, 114688
    s_add_u32 s55, s65, 802816
    buffer_load_dwordx4 v9, s[48:51], s55 offen lds
    s_waitcnt lgkmcnt(6)
    v_mfma_f32_32x32x16_bf16 a[32:47], a[24:27], v[76:79], a[32:47]
    ds_read_b64_tr_b16 a[8:9], v194 offset:6144
    ds_read_b64_tr_b16 a[10:11], v194 offset:7168
    s_add_u32 m0, s52, 115712
    s_add_u32 s55, s65, 831488
    buffer_load_dwordx4 v9, s[48:51], s55 offen lds
    s_waitcnt lgkmcnt(6)
    v_mfma_f32_32x32x16_bf16 a[48:63], a[28:31], v[76:79], a[48:63]
    ds_read_b64_tr_b16 a[12:13], v195 offset:6144
    ds_read_b64_tr_b16 a[14:15], v195 offset:7168
    s_waitcnt lgkmcnt(6)
    v_mfma_f32_32x32x16_bf16 a[32:47], a[0:3], v[80:83], a[32:47]
    ds_read_b64_tr_b16 a[16:17], v194 offset:8192
    ds_read_b64_tr_b16 a[18:19], v194 offset:9216
    s_add_u32 m0, s52, 116736
    s_add_u32 s55, s65, 860160
    buffer_load_dwordx4 v9, s[48:51], s55 offen lds
    s_waitcnt lgkmcnt(6)
    v_mfma_f32_32x32x16_bf16 a[48:63], a[4:7], v[80:83], a[48:63]
    ds_read_b64_tr_b16 a[20:21], v195 offset:8192
    ds_read_b64_tr_b16 a[22:23], v195 offset:9216
    s_waitcnt lgkmcnt(6)
    v_mfma_f32_32x32x16_bf16 a[32:47], a[8:11], v[84:87], a[32:47]
    ds_read_b64_tr_b16 a[24:25], v194 offset:10240
    ds_read_b64_tr_b16 a[26:27], v194 offset:11264
    s_add_u32 m0, s52, 117760
    s_add_u32 s55, s65, 888832
    buffer_load_dwordx4 v9, s[48:51], s55 offen lds
    s_waitcnt lgkmcnt(6)
    v_mfma_f32_32x32x16_bf16 a[48:63], a[12:15], v[84:87], a[48:63]
    ds_read_b64_tr_b16 a[28:29], v195 offset:10240
    ds_read_b64_tr_b16 a[30:31], v195 offset:11264
    s_waitcnt lgkmcnt(6)
    v_mfma_f32_32x32x16_bf16 a[32:47], a[16:19], v[88:91], a[32:47]
    ds_read_b64_tr_b16 a[0:1], v194 offset:12288
    ds_read_b64_tr_b16 a[2:3], v194 offset:13312
    s_add_u32 m0, s52, 118784
    s_add_u32 s55, s65, 917504
    buffer_load_dwordx4 v9, s[48:51], s55 offen lds
    s_waitcnt lgkmcnt(6)
    v_mfma_f32_32x32x16_bf16 a[48:63], a[20:23], v[88:91], a[48:63]
    ds_read_b64_tr_b16 a[4:5], v195 offset:12288
    ds_read_b64_tr_b16 a[6:7], v195 offset:13312
    s_waitcnt lgkmcnt(6)
    v_mfma_f32_32x32x16_bf16 a[32:47], a[24:27], v[92:95], a[32:47]
    ds_read_b64_tr_b16 a[8:9], v194 offset:14336
    ds_read_b64_tr_b16 a[10:11], v194 offset:15360
    s_add_u32 m0, s52, 119808
    s_add_u32 s55, s65, 946176
    buffer_load_dwordx4 v9, s[48:51], s55 offen lds
    s_waitcnt lgkmcnt(6)
    v_mfma_f32_32x32x16_bf16 a[48:63], a[28:31], v[92:95], a[48:63]
    ds_read_b64_tr_b16 a[12:13], v195 offset:14336
    ds_read_b64_tr_b16 a[14:15], v195 offset:15360
    s_waitcnt lgkmcnt(6)
    v_mfma_f32_32x32x16_bf16 a[32:47], a[0:3], v[96:99], a[32:47]
    ds_read_b64_tr_b16 a[16:17], v194 offset:16384
    ds_read_b64_tr_b16 a[18:19], v194 offset:17408
    s_add_u32 m0, s52, 120832
    s_add_u32 s55, s65, 974848
    buffer_load_dwordx4 v9, s[48:51], s55 offen lds
    s_waitcnt lgkmcnt(6)
    v_mfma_f32_32x32x16_bf16 a[48:63], a[4:7], v[96:99], a[48:63]
    ds_read_b64_tr_b16 a[20:21], v195 offset:16384
    ds_read_b64_tr_b16 a[22:23], v195 offset:17408
    s_waitcnt lgkmcnt(6)
    v_mfma_f32_32x32x16_bf16 a[32:47], a[8:11], v[100:103], a[32:47]
    ds_read_b64_tr_b16 a[24:25], v194 offset:18432
    ds_read_b64_tr_b16 a[26:27], v194 offset:19456
    s_sub_u32 s98, s66, s54
    s_add_u32 s98, s98, 0
    buffer_load_dword v255, v254, s[48:51], s98 offen
    s_waitcnt lgkmcnt(6)
    v_mfma_f32_32x32x16_bf16 a[48:63], a[12:15], v[100:103], a[48:63]
    ds_read_b64_tr_b16 a[28:29], v195 offset:18432
    ds_read_b64_tr_b16 a[30:31], v195 offset:19456
    s_waitcnt lgkmcnt(6)
    v_mfma_f32_32x32x16_bf16 a[32:47], a[16:19], v[104:107], a[32:47]
    ds_read_b64_tr_b16 a[0:1], v194 offset:20480
    ds_read_b64_tr_b16 a[2:3], v194 offset:21504
    s_waitcnt lgkmcnt(6)
    v_mfma_f32_32x32x16_bf16 a[48:63], a[20:23], v[104:107], a[48:63]
    ds_read_b64_tr_b16 a[4:5], v195 offset:20480
    ds_read_b64_tr_b16 a[6:7], v195 offset:21504
    s_waitcnt lgkmcnt(6)
    v_mfma_f32_32x32x16_bf16 a[32:47], a[24:27], v[108:111], a[32:47]
    ds_read_b64_tr_b16 a[8:9], v194 offset:22528
    ds_read_b64_tr_b16 a[10:11], v194 offset:23552
    s_waitcnt lgkmcnt(6)
    v_mfma_f32_32x32x16_bf16 a[48:63], a[28:31], v[108:111], a[48:63]
    ds_read_b64_tr_b16 a[12:13], v195 offset:22528
    ds_read_b64_tr_b16 a[14:15], v195 offset:23552
    s_waitcnt lgkmcnt(6)
    v_mfma_f32_32x32x16_bf16 a[32:47], a[0:3], v[112:115], a[32:47]
    ds_read_b64_tr_b16 a[16:17], v194 offset:24576
    ds_read_b64_tr_b16 a[18:19], v194 offset:25600
    s_waitcnt lgkmcnt(6)
    v_mfma_f32_32x32x16_bf16 a[48:63], a[4:7], v[112:115], a[48:63]
    ds_read_b64_tr_b16 a[20:21], v195 offset:24576
    ds_read_b64_tr_b16 a[22:23], v195 offset:25600
    s_waitcnt lgkmcnt(6)
    v_mfma_f32_32x32x16_bf16 a[32:47], a[8:11], v[116:119], a[32:47]
    ds_read_b64_tr_b16 a[24:25], v194 offset:26624
    ds_read_b64_tr_b16 a[26:27], v194 offset:27648
    s_waitcnt lgkmcnt(6)
    v_mfma_f32_32x32x16_bf16 a[48:63], a[12:15], v[116:119], a[48:63]
    ds_read_b64_tr_b16 a[28:29], v195 offset:26624
    ds_read_b64_tr_b16 a[30:31], v195 offset:27648
    s_waitcnt lgkmcnt(6)
    v_mfma_f32_32x32x16_bf16 a[32:47], a[16:19], v[120:123], a[32:47]
    v_add_u32 v192, 57344, v12
    v_add_u32 v193, 57344, v13
    s_waitcnt vmcnt(16)
    s_barrier
    ds_read_b64_tr_b16 a[0:1], v192 offset:0
    ds_read_b64_tr_b16 a[2:3], v192 offset:1024
    s_add_u32 m0, s52, 0
    s_add_u32 s55, s65, 1204224
    buffer_load_dwordx4 v9, s[48:51], s55 offen lds
    s_waitcnt lgkmcnt(6)
    v_mfma_f32_32x32x16_bf16 a[48:63], a[20:23], v[120:123], a[48:63]
    ds_read_b64_tr_b16 a[4:5], v193 offset:0
    ds_read_b64_tr_b16 a[6:7], v193 offset:1024
    s_waitcnt lgkmcnt(6)
    v_mfma_f32_32x32x16_bf16 a[32:47], a[24:27], v[124:127], a[32:47]
    ds_read_b64_tr_b16 a[8:9], v192 offset:14336
    ds_read_b64_tr_b16 a[10:11], v192 offset:15360
    s_add_u32 m0, s52, 1024
    s_add_u32 s55, s65, 1232896
    buffer_load_dwordx4 v9, s[48:51], s55 offen lds
    s_waitcnt lgkmcnt(6)
    v_mfma_f32_32x32x16_bf16 a[48:63], a[28:31], v[124:127], a[48:63]
    ds_read_b64_tr_b16 a[12:13], v193 offset:14336
    ds_read_b64_tr_b16 a[14:15], v193 offset:15360
    s_waitcnt lgkmcnt(6)
    v_mfma_f32_32x32x16_bf16 a[96:111], a[0:3], v[16:19], 0
    ds_read_b64_tr_b16 a[16:17], v192 offset:2048
    ds_read_b64_tr_b16 a[18:19], v192 offset:3072
    s_add_u32 m0, s52, 2048
    s_add_u32 s55, s65, 1261568
    buffer_load_dwordx4 v9, s[48:51], s55 offen lds
    s_waitcnt lgkmcnt(6)
    v_mfma_f32_32x32x16_bf16 a[112:127], a[4:7], v[16:19], 0
    ds_read_b64_tr_b16 a[20:21], v193 offset:2048
    ds_read_b64_tr_b16 a[22:23], v193 offset:3072
    s_waitcnt lgkmcnt(6)
    v_mfma_f32_32x32x16_bf16 a[128:143], a[8:11], v[16:19], 0
    ds_read_b64_tr_b16 a[24:25], v192 offset:16384
    ds_read_b64_tr_b16 a[26:27], v192 offset:17408
    s_add_u32 m0, s52, 3072
    s_add_u32 s55, s65, 1290240
    buffer_load_dwordx4 v9, s[48:51], s55 offen lds
    s_waitcnt lgkmcnt(6)
    v_mfma_f32_32x32x16_bf16 a[144:159], a[12:15], v[16:19], 0
    ds_read_b64_tr_b16 a[28:29], v193 offset:16384
    ds_read_b64_tr_b16 a[30:31], v193 offset:17408
    v_accvgpr_read_b32 v236, a32
    v_accvgpr_read_b32 v237, a33
    v_accvgpr_read_b32 v238, a34
    s_waitcnt lgkmcnt(6)
    v_mfma_f32_32x32x16_bf16 a[96:111], a[16:19], v[20:23], a[96:111]
    ds_read_b64_tr_b16 a[0:1], v192 offset:4096
    ds_read_b64_tr_b16 a[2:3], v192 offset:5120
    s_add_u32 m0, s52, 4096
    s_add_u32 s55, s65, 1318912
    buffer_load_dwordx4 v9, s[48:51], s55 offen lds
    s_waitcnt lgkmcnt(6)
    v_mfma_f32_32x32x16_bf16 a[112:127], a[20:23], v[20:23], a[112:127]
    ds_read_b64_tr_b16 a[4:5], v193 offset:4096
    ds_read_b64_tr_b16 a[6:7], v193 offset:5120
    v_accvgpr_read_b32 v239, a35
    v_mul_f32 v236, v196, v236
    v_mul_f32 v237, v196, v237
    s_waitcnt lgkmcnt(6)
    v_mfma_f32_32x32x16_bf16 a[128:143], a[24:27], v[20:23], a[128:143]
    ds_read_b64_tr_b16 a[8:9], v192 offset:18432
    ds_read_b64_tr_b16 a[10:11], v192 offset:19456
    s_add_u32 m0, s52, 5120
    s_add_u32 s55, s65, 1347584
    buffer_load_dwordx4 v9, s[48:51], s55 offen lds
    s_waitcnt lgkmcnt(6)
    v_mfma_f32_32x32x16_bf16 a[144:159], a[28:31], v[20:23], a[144:159]
    ds_read_b64_tr_b16 a[12:13], v193 offset:18432
    ds_read_b64_tr_b16 a[14:15], v193 offset:19456
    v_mul_f32 v238, v196, v238
    v_mul_f32 v239, v196, v239
    v_cvt_pk_bf16_f32 v220, v236, v237
    s_waitcnt lgkmcnt(6)
    v_mfma_f32_32x32x16_bf16 a[96:111], a[0:3], v[24:27], a[96:111]
    ds_read_b64_tr_b16 a[16:17], v192 offset:6144
    ds_read_b64_tr_b16 a[18:19], v192 offset:7168
    s_add_u32 m0, s52, 6144
    s_add_u32 s55, s65, 1376256
    buffer_load_dwordx4 v9, s[48:51], s55 offen lds
    s_waitcnt lgkmcnt(6)
    v_mfma_f32_32x32x16_bf16 a[112:127], a[4:7], v[24:27], a[112:127]
    ds_read_b64_tr_b16 a[20:21], v193 offset:6144
    ds_read_b64_tr_b16 a[22:23], v193 offset:7168
    v_cvt_pk_bf16_f32 v221, v238, v239
    v_accvgpr_read_b32 v240, a36
    v_accvgpr_read_b32 v241, a37
    s_waitcnt lgkmcnt(6)
    v_mfma_f32_32x32x16_bf16 a[128:143], a[8:11], v[24:27], a[128:143]
    ds_read_b64_tr_b16 a[24:25], v192 offset:20480
    ds_read_b64_tr_b16 a[26:27], v192 offset:21504
    s_sub_u32 s98, s66, s54
    s_add_u32 s98, s98, 401408
    buffer_load_dword v255, v254, s[48:51], s98 offen
    s_waitcnt lgkmcnt(6)
    v_mfma_f32_32x32x16_bf16 a[144:159], a[12:15], v[24:27], a[144:159]
    ds_read_b64_tr_b16 a[28:29], v193 offset:20480
    ds_read_b64_tr_b16 a[30:31], v193 offset:21504
    v_accvgpr_read_b32 v242, a38
    v_accvgpr_read_b32 v243, a39
    v_mul_f32 v240, v196, v240
    s_waitcnt lgkmcnt(6)
    v_mfma_f32_32x32x16_bf16 a[96:111], a[16:19], v[28:31], a[96:111]
    ds_read_b64_tr_b16 a[0:1], v192 offset:8192
    ds_read_b64_tr_b16 a[2:3], v192 offset:9216
    v_mul_f32 v241, v196, v241
    v_mul_f32 v242, v196, v242
    v_mul_f32 v243, v196, v243
    s_waitcnt lgkmcnt(6)
    v_mfma_f32_32x32x16_bf16 a[112:127], a[20:23], v[28:31], a[112:127]
    ds_read_b64_tr_b16 a[4:5], v193 offset:8192
    ds_read_b64_tr_b16 a[6:7], v193 offset:9216
    v_cvt_pk_bf16_f32 v222, v240, v241
    v_cvt_pk_bf16_f32 v223, v242, v243
    s_waitcnt lgkmcnt(6)
    v_mfma_f32_32x32x16_bf16 a[128:143], a[24:27], v[28:31], a[128:143]
    ds_read_b64_tr_b16 a[8:9], v192 offset:22528
    ds_read_b64_tr_b16 a[10:11], v192 offset:23552
    global_store_dwordx4 v198, v[220:223], s[34:35] offset:0 sc1
    s_waitcnt lgkmcnt(6)
    v_mfma_f32_32x32x16_bf16 a[144:159], a[28:31], v[28:31], a[144:159]
    ds_read_b64_tr_b16 a[12:13], v193 offset:22528
    ds_read_b64_tr_b16 a[14:15], v193 offset:23552
    v_accvgpr_read_b32 v236, a40
    v_accvgpr_read_b32 v237, a41
    v_accvgpr_read_b32 v238, a42
    s_waitcnt lgkmcnt(6)
    v_mfma_f32_32x32x16_bf16 a[96:111], a[0:3], v[32:35], a[96:111]
    ds_read_b64_tr_b16 a[16:17], v192 offset:10240
    ds_read_b64_tr_b16 a[18:19], v192 offset:11264
    v_accvgpr_read_b32 v239, a43
    v_mul_f32 v236, v196, v236
    v_mul_f32 v237, v196, v237
    s_waitcnt lgkmcnt(6)
    v_mfma_f32_32x32x16_bf16 a[112:127], a[4:7], v[32:35], a[112:127]
    ds_read_b64_tr_b16 a[20:21], v193 offset:10240
    ds_read_b64_tr_b16 a[22:23], v193 offset:11264
    v_mul_f32 v238, v196, v238
    v_mul_f32 v239, v196, v239
    v_cvt_pk_bf16_f32 v224, v236, v237
    s_waitcnt lgkmcnt(6)
    v_mfma_f32_32x32x16_bf16 a[128:143], a[8:11], v[32:35], a[128:143]
    ds_read_b64_tr_b16 a[24:25], v192 offset:24576
    ds_read_b64_tr_b16 a[26:27], v192 offset:25600
    v_cvt_pk_bf16_f32 v225, v238, v239
    v_accvgpr_read_b32 v240, a44
    v_accvgpr_read_b32 v241, a45
    s_waitcnt lgkmcnt(6)
    v_mfma_f32_32x32x16_bf16 a[144:159], a[12:15], v[32:35], a[144:159]
    ds_read_b64_tr_b16 a[28:29], v193 offset:24576
    ds_read_b64_tr_b16 a[30:31], v193 offset:25600
    v_accvgpr_read_b32 v242, a46
    v_accvgpr_read_b32 v243, a47
    v_mul_f32 v240, v196, v240
    s_waitcnt lgkmcnt(6)
    v_mfma_f32_32x32x16_bf16 a[96:111], a[16:19], v[36:39], a[96:111]
    ds_read_b64_tr_b16 a[0:1], v192 offset:12288
    ds_read_b64_tr_b16 a[2:3], v192 offset:13312
    v_mul_f32 v241, v196, v241
    v_mul_f32 v242, v196, v242
    v_mul_f32 v243, v196, v243
    s_waitcnt lgkmcnt(6)
    v_mfma_f32_32x32x16_bf16 a[112:127], a[20:23], v[36:39], a[112:127]
    ds_read_b64_tr_b16 a[4:5], v193 offset:12288
    ds_read_b64_tr_b16 a[6:7], v193 offset:13312
    v_cvt_pk_bf16_f32 v226, v240, v241
    v_cvt_pk_bf16_f32 v227, v242, v243
    v_cndmask_b32 v226, v226, 0, s[56:57]
    s_waitcnt lgkmcnt(6)
    v_mfma_f32_32x32x16_bf16 a[128:143], a[24:27], v[36:39], a[128:143]
    ds_read_b64_tr_b16 a[8:9], v192 offset:26624
    ds_read_b64_tr_b16 a[10:11], v192 offset:27648
    v_cndmask_b32 v227, v227, 0, s[56:57]
    s_waitcnt lgkmcnt(6)
    v_mfma_f32_32x32x16_bf16 a[144:159], a[28:31], v[36:39], a[144:159]
    ds_read_b64_tr_b16 a[12:13], v193 offset:26624
    ds_read_b64_tr_b16 a[14:15], v193 offset:27648
    global_store_dwordx4 v198, v[224:227], s[34:35] offset:1024 sc1
    s_waitcnt lgkmcnt(6)
    v_mfma_f32_32x32x16_bf16 a[96:111], a[0:3], v[40:43], a[96:111]
    v_add_u32 v194, 86016, v12
    v_add_u32 v195, 86016, v13
    s_waitcnt vmcnt(19)
    s_barrier
    ds_read_b64_tr_b16 a[16:17], v194 offset:0
    ds_read_b64_tr_b16 a[18:19], v194 offset:1024
    s_add_u32 m0, s52, 28672
    s_add_u32 s55, s66, 0
    buffer_load_dwordx4 v9, s[48:51], s55 offen lds
    s_waitcnt lgkmcnt(6)
    v_mfma_f32_32x32x16_bf16 a[112:127], a[4:7], v[40:43], a[112:127]
    ds_read_b64_tr_b16 a[20:21], v195 offset:0
    ds_read_b64_tr_b16 a[22:23], v195 offset:1024
    v_accvgpr_read_b32 v236, a48
    v_accvgpr_read_b32 v237, a49
    v_accvgpr_read_b32 v238, a50
    s_waitcnt lgkmcnt(6)
    v_mfma_f32_32x32x16_bf16 a[128:143], a[8:11], v[40:43], a[128:143]
    ds_read_b64_tr_b16 a[24:25], v194 offset:14336
    ds_read_b64_tr_b16 a[26:27], v194 offset:15360
    s_add_u32 m0, s52, 29696
    s_add_u32 s55, s66, 28672
    buffer_load_dwordx4 v9, s[48:51], s55 offen lds
    s_waitcnt lgkmcnt(6)
    v_mfma_f32_32x32x16_bf16 a[144:159], a[12:15], v[40:43], a[144:159]
    ds_read_b64_tr_b16 a[28:29], v195 offset:14336
    ds_read_b64_tr_b16 a[30:31], v195 offset:15360
    v_accvgpr_read_b32 v239, a51
    v_mul_f32 v236, v196, v236
    v_mul_f32 v237, v196, v237
    s_waitcnt lgkmcnt(6)
    v_mfma_f32_32x32x16_bf16 a[96:111], a[16:19], v[44:47], a[96:111]
    ds_read_b64_tr_b16 a[0:1], v194 offset:2048
    ds_read_b64_tr_b16 a[2:3], v194 offset:3072
    s_add_u32 m0, s52, 30720
    s_add_u32 s55, s66, 57344
    buffer_load_dwordx4 v9, s[48:51], s55 offen lds
    s_waitcnt lgkmcnt(6)
    v_mfma_f32_32x32x16_bf16 a[112:127], a[20:23], v[44:47], a[112:127]
    ds_read_b64_tr_b16 a[4:5], v195 offset:2048
    ds_read_b64_tr_b16 a[6:7], v195 offset:3072
    v_mul_f32 v238, v196, v238
    v_mul_f32 v239, v196, v239
    v_cvt_pk_bf16_f32 v228, v236, v237
    s_waitcnt lgkmcnt(6)
    v_mfma_f32_32x32x16_bf16 a[128:143], a[24:27], v[44:47], a[128:143]
    ds_read_b64_tr_b16 a[8:9], v194 offset:16384
    ds_read_b64_tr_b16 a[10:11], v194 offset:17408
    s_add_u32 m0, s52, 31744
    s_add_u32 s55, s66, 86016
    buffer_load_dwordx4 v9, s[48:51], s55 offen lds
    s_waitcnt lgkmcnt(6)
    v_mfma_f32_32x32x16_bf16 a[144:159], a[28:31], v[44:47], a[144:159]
    ds_read_b64_tr_b16 a[12:13], v195 offset:16384
    ds_read_b64_tr_b16 a[14:15], v195 offset:17408
    v_cvt_pk_bf16_f32 v229, v238, v239
    v_accvgpr_read_b32 v240, a52
    v_accvgpr_read_b32 v241, a53
    s_waitcnt lgkmcnt(6)
    v_mfma_f32_32x32x16_bf16 a[96:111], a[0:3], v[48:51], a[96:111]
    ds_read_b64_tr_b16 a[16:17], v194 offset:4096
    ds_read_b64_tr_b16 a[18:19], v194 offset:5120
    s_add_u32 m0, s52, 32768
    s_add_u32 s55, s66, 114688
    buffer_load_dwordx4 v9, s[48:51], s55 offen lds
    s_waitcnt lgkmcnt(6)
    v_mfma_f32_32x32x16_bf16 a[112:127], a[4:7], v[48:51], a[112:127]
    ds_read_b64_tr_b16 a[20:21], v195 offset:4096
    ds_read_b64_tr_b16 a[22:23], v195 offset:5120
    v_accvgpr_read_b32 v242, a54
    v_accvgpr_read_b32 v243, a55
    v_mul_f32 v240, v196, v240
    s_waitcnt lgkmcnt(6)
    v_mfma_f32_32x32x16_bf16 a[128:143], a[8:11], v[48:51], a[128:143]
    ds_read_b64_tr_b16 a[24:25], v194 offset:18432
    ds_read_b64_tr_b16 a[26:27], v194 offset:19456
    s_add_u32 m0, s52, 33792
    s_add_u32 s55, s66, 143360
    buffer_load_dwordx4 v9, s[48:51], s55 offen lds
    s_waitcnt lgkmcnt(6)
    v_mfma_f32_32x32x16_bf16 a[144:159], a[12:15], v[48:51], a[144:159]
    ds_read_b64_tr_b16 a[28:29], v195 offset:18432
    ds_read_b64_tr_b16 a[30:31], v195 offset:19456
    v_mul_f32 v241, v196, v241
    v_mul_f32 v242, v196, v242
    v_mul_f32 v243, v196, v243
    s_waitcnt lgkmcnt(6)
    v_mfma_f32_32x32x16_bf16 a[96:111], a[16:19], v[52:55], a[96:111]
    ds_read_b64_tr_b16 a[0:1], v194 offset:6144
    ds_read_b64_tr_b16 a[2:3], v194 offset:7168
    s_add_u32 m0, s52, 34816
    s_add_u32 s55, s66, 172032
    buffer_load_dwordx4 v9, s[48:51], s55 offen lds
    s_waitcnt lgkmcnt(6)
    v_mfma_f32_32x32x16_bf16 a[112:127], a[20:23], v[52:55], a[112:127]
    ds_read_b64_tr_b16 a[4:5], v195 offset:6144
    ds_read_b64_tr_b16 a[6:7], v195 offset:7168
    v_cvt_pk_bf16_f32 v230, v240, v241
    v_cvt_pk_bf16_f32 v231, v242, v243
    s_waitcnt lgkmcnt(6)
    v_mfma_f32_32x32x16_bf16 a[128:143], a[24:27], v[52:55], a[128:143]
    ds_read_b64_tr_b16 a[8:9], v194 offset:20480
    ds_read_b64_tr_b16 a[10:11], v194 offset:21504
    s_sub_u32 s98, s66, s54
    s_add_u32 s98, s98, 802816
    buffer_load_dword v255, v254, s[48:51], s98 offen
    s_waitcnt lgkmcnt(6)
    v_mfma_f32_32x32x16_bf16 a[144:159], a[28:31], v[52:55], a[144:159]
    ds_read_b64_tr_b16 a[12:13], v195 offset:20480
    ds_read_b64_tr_b16 a[14:15], v195 offset:21504
    global_store_dwordx4 v199, v[228:231], s[34:35] offset:0 sc1
    s_waitcnt lgkmcnt(6)
    v_mfma_f32_32x32x16_bf16 a[96:111], a[0:3], v[56:59], a[96:111]
    ds_read_b64_tr_b16 a[16:17], v194 offset:8192
    ds_read_b64_tr_b16 a[18:19], v194 offset:9216
    v_accvgpr_read_b32 v236, a56
    v_accvgpr_read_b32 v237, a57
    v_accvgpr_read_b32 v238, a58
    s_waitcnt lgkmcnt(6)
    v_mfma_f32_32x32x16_bf16 a[112:127], a[4:7], v[56:59], a[112:127]
    ds_read_b64_tr_b16 a[20:21], v195 offset:8192
    ds_read_b64_tr_b16 a[22:23], v195 offset:9216
    v_accvgpr_read_b32 v239, a59
    v_mul_f32 v236, v196, v236
    v_mul_f32 v237, v196, v237
    s_waitcnt lgkmcnt(6)
    v_mfma_f32_32x32x16_bf16 a[128:143], a[8:11], v[56:59], a[128:143]
    ds_read_b64_tr_b16 a[24:25], v194 offset:22528
    ds_read_b64_tr_b16 a[26:27], v194 offset:23552
    v_mul_f32 v238, v196, v238
    v_mul_f32 v239, v196, v239
    v_cvt_pk_bf16_f32 v232, v236, v237
    s_waitcnt lgkmcnt(6)
    v_mfma_f32_32x32x16_bf16 a[144:159], a[12:15], v[56:59], a[144:159]
    ds_read_b64_tr_b16 a[28:29], v195 offset:22528
    ds_read_b64_tr_b16 a[30:31], v195 offset:23552
    v_cvt_pk_bf16_f32 v233, v238, v239
    v_accvgpr_read_b32 v240, a60
    v_accvgpr_read_b32 v241, a61
    s_waitcnt lgkmcnt(6)
    v_mfma_f32_32x32x16_bf16 a[96:111], a[16:19], v[60:63], a[96:111]
    ds_read_b64_tr_b16 a[0:1], v194 offset:10240
    ds_read_b64_tr_b16 a[2:3], v194 offset:11264
    v_accvgpr_read_b32 v242, a62
    v_accvgpr_read_b32 v243, a63
    v_mul_f32 v240, v196, v240
    s_waitcnt lgkmcnt(6)
    v_mfma_f32_32x32x16_bf16 a[112:127], a[20:23], v[60:63], a[112:127]
    ds_read_b64_tr_b16 a[4:5], v195 offset:10240
    ds_read_b64_tr_b16 a[6:7], v195 offset:11264
    v_mul_f32 v241, v196, v241
    v_mul_f32 v242, v196, v242
    v_mul_f32 v243, v196, v243
    s_waitcnt lgkmcnt(6)
    v_mfma_f32_32x32x16_bf16 a[128:143], a[24:27], v[60:63], a[128:143]
    ds_read_b64_tr_b16 a[8:9], v194 offset:24576
    ds_read_b64_tr_b16 a[10:11], v194 offset:25600
    v_cvt_pk_bf16_f32 v234, v240, v241
    v_cvt_pk_bf16_f32 v235, v242, v243
    v_cndmask_b32 v234, v234, 0, s[56:57]
    s_waitcnt lgkmcnt(6)
    v_mfma_f32_32x32x16_bf16 a[144:159], a[28:31], v[60:63], a[144:159]
    ds_read_b64_tr_b16 a[12:13], v195 offset:24576
    ds_read_b64_tr_b16 a[14:15], v195 offset:25600
    v_cndmask_b32 v235, v235, 0, s[56:57]
    s_waitcnt lgkmcnt(6)
    v_mfma_f32_32x32x16_bf16 a[96:111], a[0:3], v[64:67], a[96:111]
    ds_read_b64_tr_b16 a[16:17], v194 offset:12288
    ds_read_b64_tr_b16 a[18:19], v194 offset:13312
    global_store_dwordx4 v199, v[232:235], s[34:35] offset:1024 sc1
    s_waitcnt lgkmcnt(6)
    v_mfma_f32_32x32x16_bf16 a[112:127], a[4:7], v[64:67], a[112:127]
    ds_read_b64_tr_b16 a[20:21], v195 offset:12288
    ds_read_b64_tr_b16 a[22:23], v195 offset:13312
    s_waitcnt lgkmcnt(6)
    v_mfma_f32_32x32x16_bf16 a[128:143], a[8:11], v[64:67], a[128:143]
    ds_read_b64_tr_b16 a[24:25], v194 offset:26624
    ds_read_b64_tr_b16 a[26:27], v194 offset:27648
    s_waitcnt lgkmcnt(6)
    v_mfma_f32_32x32x16_bf16 a[144:159], a[12:15], v[64:67], a[144:159]
    ds_read_b64_tr_b16 a[28:29], v195 offset:26624
    ds_read_b64_tr_b16 a[30:31], v195 offset:27648
    s_waitcnt lgkmcnt(6)
    v_mfma_f32_32x32x16_bf16 a[96:111], a[16:19], v[68:71], a[96:111]
    v_add_u32 v192, 114688, v12
    v_add_u32 v193, 114688, v13
    s_waitcnt vmcnt(21)
    s_barrier
    ds_read_b64_tr_b16 a[0:1], v192 offset:0
    ds_read_b64_tr_b16 a[2:3], v192 offset:1024
    s_add_u32 m0, s52, 57344
    s_add_u32 s55, s66, 401408
    buffer_load_dwordx4 v9, s[48:51], s55 offen lds
    s_waitcnt lgkmcnt(6)
    v_mfma_f32_32x32x16_bf16 a[112:127], a[20:23], v[68:71], a[112:127]
    ds_read_b64_tr_b16 a[4:5], v193 offset:0
    ds_read_b64_tr_b16 a[6:7], v193 offset:1024
    s_waitcnt lgkmcnt(6)
    v_mfma_f32_32x32x16_bf16 a[128:143], a[24:27], v[68:71], a[128:143]
    ds_read_b64_tr_b16 a[8:9], v192 offset:14336
    ds_read_b64_tr_b16 a[10:11], v192 offset:15360
    s_add_u32 m0, s52, 58368
    s_add_u32 s55, s66, 430080
    buffer_load_dwordx4 v9, s[48:51], s55 offen lds
    s_waitcnt lgkmcnt(6)
    v_mfma_f32_32x32x16_bf16 a[144:159], a[28:31], v[68:71], a[144:159]
    ds_read_b64_tr_b16 a[12:13], v193 offset:14336
    ds_read_b64_tr_b16 a[14:15], v193 offset:15360
    s_waitcnt lgkmcnt(6)
    v_mfma_f32_32x32x16_bf16 a[96:111], a[0:3], v[72:75], a[96:111]
    ds_read_b64_tr_b16 a[16:17], v192 offset:2048
    ds_read_b64_tr_b16 a[18:19], v192 offset:3072
    s_add_u32 m0, s52, 59392
    s_add_u32 s55, s66, 458752
    buffer_load_dwordx4 v9, s[48:51], s55 offen lds
    s_waitcnt lgkmcnt(6)
    v_mfma_f32_32x32x16_bf16 a[112:127], a[4:7], v[72:75], a[112:127]
    ds_read_b64_tr_b16 a[20:21], v193 offset:2048
    ds_read_b64_tr_b16 a[22:23], v193 offset:3072
    s_waitcnt lgkmcnt(6)
    v_mfma_f32_32x32x16_bf16 a[128:143], a[8:11], v[72:75], a[128:143]
    ds_read_b64_tr_b16 a[24:25], v192 offset:16384
    ds_read_b64_tr_b16 a[26:27], v192 offset:17408
    s_add_u32 m0, s52, 60416
    s_add_u32 s55, s66, 487424
    buffer_load_dwordx4 v9, s[48:51], s55 offen lds
    s_waitcnt lgkmcnt(6)
    v_mfma_f32_32x32x16_bf16 a[144:159], a[12:15], v[72:75], a[144:159]
    ds_read_b64_tr_b16 a[28:29], v193 offset:16384
    ds_read_b64_tr_b16 a[30:31], v193 offset:17408
    s_waitcnt lgkmcnt(6)
    v_mfma_f32_32x32x16_bf16 a[96:111], a[16:19], v[76:79], a[96:111]
    ds_read_b64_tr_b16 a[0:1], v192 offset:4096
    ds_read_b64_tr_b16 a[2:3], v192 offset:5120
    s_add_u32 m0, s52, 61440
    s_add_u32 s55, s66, 516096
    buffer_load_dwordx4 v9, s[48:51], s55 offen lds
    s_waitcnt lgkmcnt(6)
    v_mfma_f32_32x32x16_bf16 a[112:127], a[20:23], v[76:79], a[112:127]
    ds_read_b64_tr_b16 a[4:5], v193 offset:4096
    ds_read_b64_tr_b16 a[6:7], v193 offset:5120
    s_waitcnt lgkmcnt(6)
    v_mfma_f32_32x32x16_bf16 a[128:143], a[24:27], v[76:79], a[128:143]
    ds_read_b64_tr_b16 a[8:9], v192 offset:18432
    ds_read_b64_tr_b16 a[10:11], v192 offset:19456
    s_add_u32 m0, s52, 62464
    s_add_u32 s55, s66, 544768
    buffer_load_dwordx4 v9, s[48:51], s55 offen lds
    s_waitcnt lgkmcnt(6)
    v_mfma_f32_32x32x16_bf16 a[144:159], a[28:31], v[76:79], a[144:159]
    ds_read_b64_tr_b16 a[12:13], v193 offset:18432
    ds_read_b64_tr_b16 a[14:15], v193 offset:19456
    s_waitcnt lgkmcnt(6)
    v_mfma_f32_32x32x16_bf16 a[96:111], a[0:3], v[80:83], a[96:111]
    ds_read_b64_tr_b16 a[16:17], v192 offset:6144
    ds_read_b64_tr_b16 a[18:19], v192 offset:7168
    s_add_u32 m0, s52, 63488
    s_add_u32 s55, s66, 573440
    buffer_load_dwordx4 v9, s[48:51], s55 offen lds
    s_waitcnt lgkmcnt(6)
    v_mfma_f32_32x32x16_bf16 a[112:127], a[4:7], v[80:83], a[112:127]
    ds_read_b64_tr_b16 a[20:21], v193 offset:6144
    ds_read_b64_tr_b16 a[22:23], v193 offset:7168
    s_waitcnt lgkmcnt(6)
    v_mfma_f32_32x32x16_bf16 a[128:143], a[8:11], v[80:83], a[128:143]
    ds_read_b64_tr_b16 a[24:25], v192 offset:20480
    ds_read_b64_tr_b16 a[26:27], v192 offset:21504
    s_sub_u32 s98, s66, s54
    s_add_u32 s98, s98, 1204224
    buffer_load_dword v255, v254, s[48:51], s98 offen
    s_waitcnt lgkmcnt(6)
    v_mfma_f32_32x32x16_bf16 a[144:159], a[12:15], v[80:83], a[144:159]
    ds_read_b64_tr_b16 a[28:29], v193 offset:20480
    ds_read_b64_tr_b16 a[30:31], v193 offset:21504
    s_waitcnt lgkmcnt(6)
    v_mfma_f32_32x32x16_bf16 a[96:111], a[16:19], v[84:87], a[96:111]
    ds_read_b64_tr_b16 a[0:1], v192 offset:8192
    ds_read_b64_tr_b16 a[2:3], v192 offset:9216
    s_waitcnt lgkmcnt(6)
    v_mfma_f32_32x32x16_bf16 a[112:127], a[20:23], v[84:87], a[112:127]
    ds_read_b64_tr_b16 a[4:5], v193 offset:8192
    ds_read_b64_tr_b16 a[6:7], v193 offset:9216
    s_waitcnt lgkmcnt(6)
    v_mfma_f32_32x32x16_bf16 a[128:143], a[24:27], v[84:87], a[128:143]
    ds_read_b64_tr_b16 a[8:9], v192 offset:22528
    ds_read_b64_tr_b16 a[10:11], v192 offset:23552
    s_waitcnt lgkmcnt(6)
    v_mfma_f32_32x32x16_bf16 a[144:159], a[28:31], v[84:87], a[144:159]
    ds_read_b64_tr_b16 a[12:13], v193 offset:22528
    ds_read_b64_tr_b16 a[14:15], v193 offset:23552
    s_waitcnt lgkmcnt(6)
    v_mfma_f32_32x32x16_bf16 a[96:111], a[0:3], v[88:91], a[96:111]
    ds_read_b64_tr_b16 a[16:17], v192 offset:10240
    ds_read_b64_tr_b16 a[18:19], v192 offset:11264
    s_waitcnt lgkmcnt(6)
    v_mfma_f32_32x32x16_bf16 a[112:127], a[4:7], v[88:91], a[112:127]
    ds_read_b64_tr_b16 a[20:21], v193 offset:10240
    ds_read_b64_tr_b16 a[22:23], v193 offset:11264
    s_waitcnt lgkmcnt(6)
    v_mfma_f32_32x32x16_bf16 a[128:143], a[8:11], v[88:91], a[128:143]
    ds_read_b64_tr_b16 a[24:25], v192 offset:24576
    ds_read_b64_tr_b16 a[26:27], v192 offset:25600
    s_waitcnt lgkmcnt(6)
    v_mfma_f32_32x32x16_bf16 a[144:159], a[12:15], v[88:91], a[144:159]
    ds_read_b64_tr_b16 a[28:29], v193 offset:24576
    ds_read_b64_tr_b16 a[30:31], v193 offset:25600
    s_waitcnt lgkmcnt(6)
    v_mfma_f32_32x32x16_bf16 a[96:111], a[16:19], v[92:95], a[96:111]
    ds_read_b64_tr_b16 a[0:1], v192 offset:12288
    ds_read_b64_tr_b16 a[2:3], v192 offset:13312
    s_waitcnt lgkmcnt(6)
    v_mfma_f32_32x32x16_bf16 a[112:127], a[20:23], v[92:95], a[112:127]
    ds_read_b64_tr_b16 a[4:5], v193 offset:12288
    ds_read_b64_tr_b16 a[6:7], v193 offset:13312
    s_waitcnt lgkmcnt(6)
    v_mfma_f32_32x32x16_bf16 a[128:143], a[24:27], v[92:95], a[128:143]
    ds_read_b64_tr_b16 a[8:9], v192 offset:26624
    ds_read_b64_tr_b16 a[10:11], v192 offset:27648
    s_waitcnt lgkmcnt(6)
    v_mfma_f32_32x32x16_bf16 a[144:159], a[28:31], v[92:95], a[144:159]
    ds_read_b64_tr_b16 a[12:13], v193 offset:26624
    ds_read_b64_tr_b16 a[14:15], v193 offset:27648
    s_waitcnt lgkmcnt(6)
    v_mfma_f32_32x32x16_bf16 a[96:111], a[0:3], v[96:99], a[96:111]
    v_add_u32 v194, 0, v12
    v_add_u32 v195, 0, v13
    s_waitcnt vmcnt(21)
    s_barrier
    ds_read_b64_tr_b16 a[16:17], v194 offset:0
    ds_read_b64_tr_b16 a[18:19], v194 offset:1024
    s_add_u32 m0, s52, 86016
    s_add_u32 s55, s66, 802816
    buffer_load_dwordx4 v9, s[48:51], s55 offen lds
    s_waitcnt lgkmcnt(6)
    v_mfma_f32_32x32x16_bf16 a[112:127], a[4:7], v[96:99], a[112:127]
    ds_read_b64_tr_b16 a[20:21], v195 offset:0
    ds_read_b64_tr_b16 a[22:23], v195 offset:1024
    s_waitcnt lgkmcnt(6)
    v_mfma_f32_32x32x16_bf16 a[128:143], a[8:11], v[96:99], a[128:143]
    ds_read_b64_tr_b16 a[24:25], v194 offset:14336
    ds_read_b64_tr_b16 a[26:27], v194 offset:15360
    s_add_u32 m0, s52, 87040
    s_add_u32 s55, s66, 831488
    buffer_load_dwordx4 v9, s[48:51], s55 offen lds
    s_waitcnt lgkmcnt(6)
    v_mfma_f32_32x32x16_bf16 a[144:159], a[12:15], v[96:99], a[144:159]
    ds_read_b64_tr_b16 a[28:29], v195 offset:14336
    ds_read_b64_tr_b16 a[30:31], v195 offset:15360
    s_waitcnt lgkmcnt(6)
    v_mfma_f32_32x32x16_bf16 a[96:111], a[16:19], v[100:103], a[96:111]
    ds_read_b64_tr_b16 a[0:1], v194 offset:2048
    ds_read_b64_tr_b16 a[2:3], v194 offset:3072
    s_add_u32 m0, s52, 88064
    s_add_u32 s55, s66, 860160
    buffer_load_dwordx4 v9, s[48:51], s55 offen lds
    s_waitcnt lgkmcnt(6)
    v_mfma_f32_32x32x16_bf16 a[112:127], a[20:23], v[100:103], a[112:127]
    ds_read_b64_tr_b16 a[4:5], v195 offset:2048
    ds_read_b64_tr_b16 a[6:7], v195 offset:3072
    s_waitcnt lgkmcnt(6)
    v_mfma_f32_32x32x16_bf16 a[128:143], a[24:27], v[100:103], a[128:143]
    ds_read_b64_tr_b16 a[8:9], v194 offset:16384
    ds_read_b64_tr_b16 a[10:11], v194 offset:17408
    s_add_u32 m0, s52, 89088
    s_add_u32 s55, s66, 888832
    buffer_load_dwordx4 v9, s[48:51], s55 offen lds
    s_waitcnt lgkmcnt(6)
    v_mfma_f32_32x32x16_bf16 a[144:159], a[28:31], v[100:103], a[144:159]
    ds_read_b64_tr_b16 a[12:13], v195 offset:16384
    ds_read_b64_tr_b16 a[14:15], v195 offset:17408
    s_waitcnt lgkmcnt(6)
    v_mfma_f32_32x32x16_bf16 a[96:111], a[0:3], v[104:107], a[96:111]
    ds_read_b64_tr_b16 a[16:17], v194 offset:4096
    ds_read_b64_tr_b16 a[18:19], v194 offset:5120
    s_add_u32 m0, s52, 90112
    s_add_u32 s55, s66, 917504
    buffer_load_dwordx4 v9, s[48:51], s55 offen lds
    s_waitcnt lgkmcnt(6)
    v_mfma_f32_32x32x16_bf16 a[112:127], a[4:7], v[104:107], a[112:127]
    ds_read_b64_tr_b16 a[20:21], v195 offset:4096
    ds_read_b64_tr_b16 a[22:23], v195 offset:5120
    s_waitcnt lgkmcnt(6)
    v_mfma_f32_32x32x16_bf16 a[128:143], a[8:11], v[104:107], a[128:143]
    ds_read_b64_tr_b16 a[24:25], v194 offset:18432
    ds_read_b64_tr_b16 a[26:27], v194 offset:19456
    s_add_u32 m0, s52, 91136
    s_add_u32 s55, s66, 946176
    buffer_load_dwordx4 v9, s[48:51], s55 offen lds
    s_waitcnt lgkmcnt(6)
    v_mfma_f32_32x32x16_bf16 a[144:159], a[12:15], v[104:107], a[144:159]
    ds_read_b64_tr_b16 a[28:29], v195 offset:18432
    ds_read_b64_tr_b16 a[30:31], v195 offset:19456
    s_waitcnt lgkmcnt(6)
    v_mfma_f32_32x32x16_bf16 a[96:111], a[16:19], v[108:111], a[96:111]
    ds_read_b64_tr_b16 a[0:1], v194 offset:6144
    ds_read_b64_tr_b16 a[2:3], v194 offset:7168
    s_add_u32 m0, s52, 92160
    s_add_u32 s55, s66, 974848
    buffer_load_dwordx4 v9, s[48:51], s55 offen lds
    s_waitcnt lgkmcnt(6)
    v_mfma_f32_32x32x16_bf16 a[112:127], a[20:23], v[108:111], a[112:127]
    ds_read_b64_tr_b16 a[4:5], v195 offset:6144
    ds_read_b64_tr_b16 a[6:7], v195 offset:7168
    s_waitcnt lgkmcnt(6)
    v_mfma_f32_32x32x16_bf16 a[128:143], a[24:27], v[108:111], a[128:143]
    ds_read_b64_tr_b16 a[8:9], v194 offset:20480
    ds_read_b64_tr_b16 a[10:11], v194 offset:21504
    s_waitcnt lgkmcnt(6)
    v_mfma_f32_32x32x16_bf16 a[144:159], a[28:31], v[108:111], a[144:159]
    ds_read_b64_tr_b16 a[12:13], v195 offset:20480
    ds_read_b64_tr_b16 a[14:15], v195 offset:21504
    s_waitcnt lgkmcnt(6)
    v_mfma_f32_32x32x16_bf16 a[96:111], a[0:3], v[112:115], a[96:111]
    ds_read_b64_tr_b16 a[16:17], v194 offset:8192
    ds_read_b64_tr_b16 a[18:19], v194 offset:9216
    s_waitcnt lgkmcnt(6)
    v_mfma_f32_32x32x16_bf16 a[112:127], a[4:7], v[112:115], a[112:127]
    ds_read_b64_tr_b16 a[20:21], v195 offset:8192
    ds_read_b64_tr_b16 a[22:23], v195 offset:9216
    s_waitcnt lgkmcnt(6)
    v_mfma_f32_32x32x16_bf16 a[128:143], a[8:11], v[112:115], a[128:143]
    ds_read_b64_tr_b16 a[24:25], v194 offset:22528
    ds_read_b64_tr_b16 a[26:27], v194 offset:23552
    s_waitcnt lgkmcnt(6)
    v_mfma_f32_32x32x16_bf16 a[144:159], a[12:15], v[112:115], a[144:159]
    ds_read_b64_tr_b16 a[28:29], v195 offset:22528
    ds_read_b64_tr_b16 a[30:31], v195 offset:23552
    s_waitcnt lgkmcnt(6)
    v_mfma_f32_32x32x16_bf16 a[96:111], a[16:19], v[116:119], a[96:111]
    ds_read_b64_tr_b16 a[0:1], v194 offset:10240
    ds_read_b64_tr_b16 a[2:3], v194 offset:11264
    s_waitcnt lgkmcnt(6)
    v_mfma_f32_32x32x16_bf16 a[112:127], a[20:23], v[116:119], a[112:127]
    ds_read_b64_tr_b16 a[4:5], v195 offset:10240
    ds_read_b64_tr_b16 a[6:7], v195 offset:11264
    s_waitcnt lgkmcnt(6)
    v_mfma_f32_32x32x16_bf16 a[128:143], a[24:27], v[116:119], a[128:143]
    ds_read_b64_tr_b16 a[8:9], v194 offset:24576
    ds_read_b64_tr_b16 a[10:11], v194 offset:25600
    s_waitcnt lgkmcnt(6)
    v_mfma_f32_32x32x16_bf16 a[144:159], a[28:31], v[116:119], a[144:159]
    ds_read_b64_tr_b16 a[12:13], v195 offset:24576
    ds_read_b64_tr_b16 a[14:15], v195 offset:25600
    s_waitcnt lgkmcnt(6)
    v_mfma_f32_32x32x16_bf16 a[96:111], a[0:3], v[120:123], a[96:111]
    ds_read_b64_tr_b16 a[16:17], v194 offset:12288
    ds_read_b64_tr_b16 a[18:19], v194 offset:13312
    s_waitcnt lgkmcnt(6)
    v_mfma_f32_32x32x16_bf16 a[112:127], a[4:7], v[120:123], a[112:127]
    ds_read_b64_tr_b16 a[20:21], v195 offset:12288
    ds_read_b64_tr_b16 a[22:23], v195 offset:13312
    s_waitcnt lgkmcnt(6)
    v_mfma_f32_32x32x16_bf16 a[128:143], a[8:11], v[120:123], a[128:143]
    ds_read_b64_tr_b16 a[24:25], v194 offset:26624
    ds_read_b64_tr_b16 a[26:27], v194 offset:27648
    s_waitcnt lgkmcnt(6)
    v_mfma_f32_32x32x16_bf16 a[144:159], a[12:15], v[120:123], a[144:159]
    ds_read_b64_tr_b16 a[28:29], v195 offset:26624
    ds_read_b64_tr_b16 a[30:31], v195 offset:27648
    s_waitcnt lgkmcnt(6)
    v_mfma_f32_32x32x16_bf16 a[96:111], a[16:19], v[124:127], a[96:111]
    v_add_u32 v192, 28672, v12
    v_add_u32 v193, 28672, v13
    s_waitcnt vmcnt(18)
    s_barrier
    s_waitcnt vmcnt(58)
    s_mov_b32 s4, 0
tagspin_3:
    v_readfirstlane_b32 s39, v203
    s_add_u32 s4, s4, 1
    s_cmp_lg_u32 s39, 0
    s_cbranch_scc1 tagok_4
    s_cmp_lt_u32 s4, 40000
    s_cbranch_scc0 tagok_4
    v_mov_b32 v252, 0
    global_load_dword v203, v252, s[32:33] sc1
    s_waitcnt vmcnt(0)
    s_nop 0
    s_branch tagspin_3
tagok_4:
    s_waitcnt vmcnt(15)
    s_mov_b64 exec, 1
    global_store_dword v5, v203, s[34:35] sc1
    s_mov_b64 exec, -1
    ds_read_b64_tr_b16 a[0:1], v192 offset:0
    ds_read_b64_tr_b16 a[2:3], v192 offset:1024
    s_add_u32 m0, s52, 114688
    s_add_u32 s55, s66, 1204224
    buffer_load_dwordx4 v9, s[48:51], s55 offen lds
    s_waitcnt lgkmcnt(6)
    v_mfma_f32_32x32x16_bf16 a[112:127], a[20:23], v[124:127], a[112:127]
    ds_read_b64_tr_b16 a[4:5], v193 offset:0
    ds_read_b64_tr_b16 a[6:7], v193 offset:1024
    s_waitcnt lgkmcnt(6)
    v_mfma_f32_32x32x16_bf16 a[128:143], a[24:27], v[124:127], a[128:143]
    ds_read_b64_tr_b16 a[8:9], v192 offset:14336
    ds_read_b64_tr_b16 a[10:11], v192 offset:15360
    s_add_u32 m0, s52, 115712
    s_add_u32 s55, s66, 1232896
    buffer_load_dwordx4 v9, s[48:51], s55 offen lds
    s_waitcnt lgkmcnt(6)
    v_mfma_f32_32x32x16_bf16 a[144:159], a[28:31], v[124:127], a[144:159]
    ds_read_b64_tr_b16 a[12:13], v193 offset:14336
    ds_read_b64_tr_b16 a[14:15], v193 offset:15360
    s_waitcnt lgkmcnt(6)
    v_mfma_f32_32x32x16_bf16 v[128:143], a[0:3], v[16:19], 0
    ds_read_b64_tr_b16 a[16:17], v192 offset:2048
    ds_read_b64_tr_b16 a[18:19], v192 offset:3072
    s_add_u32 m0, s52, 116736
    s_add_u32 s55, s66, 1261568
    buffer_load_dwordx4 v9, s[48:51], s55 offen lds
    s_waitcnt lgkmcnt(6)
    v_mfma_f32_32x32x16_bf16 v[144:159], a[4:7], v[16:19], 0
    ds_read_b64_tr_b16 a[20:21], v193 offset:2048
    ds_read_b64_tr_b16 a[22:23], v193 offset:3072
    s_waitcnt lgkmcnt(6)
    v_mfma_f32_32x32x16_bf16 v[160:175], a[8:11], v[16:19], 0
    ds_read_b64_tr_b16 a[24:25], v192 offset:16384
    ds_read_b64_tr_b16 a[26:27], v192 offset:17408
    s_add_u32 m0, s52, 117760
    s_add_u32 s55, s66, 1290240
    buffer_load_dwordx4 v9, s[48:51], s55 offen lds
    s_waitcnt lgkmcnt(6)
    v_mfma_f32_32x32x16_bf16 v[176:191], a[12:15], v[16:19], 0
    ds_read_b64_tr_b16 a[28:29], v193 offset:16384
    ds_read_b64_tr_b16 a[30:31], v193 offset:17408
    s_lshl_b32 s4, s67, 12
    v_add_u32 v202, s4, v200
    v_accvgpr_read_b32 v228, a96
    s_waitcnt lgkmcnt(6)
    v_mfma_f32_32x32x16_bf16 v[128:143], a[16:19], v[20:23], v[128:143]
    ds_read_b64_tr_b16 a[0:1], v192 offset:4096
    ds_read_b64_tr_b16 a[2:3], v192 offset:5120
    s_add_u32 m0, s52, 118784
    s_add_u32 s55, s66, 1318912
    buffer_load_dwordx4 v9, s[48:51], s55 offen lds
    s_waitcnt lgkmcnt(6)
    v_mfma_f32_32x32x16_bf16 v[144:159], a[20:23], v[20:23], v[144:159]
    ds_read_b64_tr_b16 a[4:5], v193 offset:4096
    ds_read_b64_tr_b16 a[6:7], v193 offset:5120
    v_accvgpr_read_b32 v229, a97
    v_accvgpr_read_b32 v230, a98
    v_accvgpr_read_b32 v231, a99
    s_waitcnt lgkmcnt(6)
    v_mfma_f32_32x32x16_bf16 v[160:175], a[24:27], v[20:23], v[160:175]
    ds_read_b64_tr_b16 a[8:9], v192 offset:18432
    ds_read_b64_tr_b16 a[10:11], v192 offset:19456
    s_add_u32 m0, s52, 119808
    s_add_u32 s55, s66, 1347584
    buffer_load_dwordx4 v9, s[48:51], s55 offen lds
    s_waitcnt lgkmcnt(6)
    v_mfma_f32_32x32x16_bf16 v[176:191], a[28:31], v[20:23], v[176:191]
    ds_read_b64_tr_b16 a[12:13], v193 offset:18432
    ds_read_b64_tr_b16 a[14:15], v193 offset:19456
    v_accvgpr_read_b32 v236, a128
    v_accvgpr_read_b32 v237, a129
    v_accvgpr_read_b32 v238, a130
    s_waitcnt lgkmcnt(6)
    v_mfma_f32_32x32x16_bf16 v[128:143], a[0:3], v[24:27], v[128:143]
    ds_read_b64_tr_b16 a[16:17], v192 offset:6144
    ds_read_b64_tr_b16 a[18:19], v192 offset:7168
    s_add_u32 m0, s52, 120832
    s_add_u32 s55, s66, 1376256
    buffer_load_dwordx4 v9, s[48:51], s55 offen lds
    s_waitcnt lgkmcnt(6)
    v_mfma_f32_32x32x16_bf16 v[144:159], a[4:7], v[24:27], v[144:159]
    ds_read_b64_tr_b16 a[20:21], v193 offset:6144
    ds_read_b64_tr_b16 a[22:23], v193 offset:7168
    v_accvgpr_read_b32 v239, a131
    v_mul_f32 v232, v14, v228
    v_mul_f32 v233, v14, v229
    s_waitcnt lgkmcnt(6)
    v_mfma_f32_32x32x16_bf16 v[160:175], a[8:11], v[24:27], v[160:175]
    ds_read_b64_tr_b16 a[24:25], v192 offset:20480
    ds_read_b64_tr_b16 a[26:27], v192 offset:21504
    s_and_b32 s4, s12, 3
    s_mul_i32 s5, s4, 448
    s_mul_i32 s6, s36, 112
    s_add_u32 s5, s5, s6
    v_add_u32 v252, s5, v1
    v_mul_u32_u24 v252, 896, v252
    s_lshl_b32 s6, s13, 7
    v_add_u32 v252, s6, v252
    global_load_dword v255, v252, s[28:29]
    v_min_u32 v253, 47, v1
    v_add_u32 v253, s5, v253
    v_add_u32 v253, 64, v253
    v_mul_u32_u24 v253, 896, v253
    v_add_u32 v253, s6, v253
    global_load_dword v255, v253, s[28:29]
    s_mul_i32 s5, s4, 112
    s_mul_i32 s4, s36, 28
    s_add_u32 s5, s5, s4
    v_min_u32 v252, 27, v1
    v_add_u32 v252, s5, v252
    v_mul_u32_u24 v252, 896, v252
    v_add_u32 v252, s6, v252
    global_load_dword v255, v252, s[20:21]
    s_waitcnt lgkmcnt(6)
    v_mfma_f32_32x32x16_bf16 v[176:191], a[12:15], v[24:27], v[176:191]
    ds_read_b64_tr_b16 a[28:29], v193 offset:20480
    ds_read_b64_tr_b16 a[30:31], v193 offset:21504
    v_mul_f32 v234, v14, v230
    v_mul_f32 v235, v14, v231
    s_waitcnt lgkmcnt(6)
    v_mfma_f32_32x32x16_bf16 v[128:143], a[16:19], v[28:31], v[128:143]
    ds_read_b64_tr_b16 a[0:1], v192 offset:8192
    ds_read_b64_tr_b16 a[2:3], v192 offset:9216
    v_exp_f32 v232, v232
    s_waitcnt lgkmcnt(6)
    v_mfma_f32_32x32x16_bf16 v[144:159], a[20:23], v[28:31], v[144:159]
    ds_read_b64_tr_b16 a[4:5], v193 offset:8192
    ds_read_b64_tr_b16 a[6:7], v193 offset:9216
    v_exp_f32 v233, v233
    s_waitcnt lgkmcnt(6)
    v_mfma_f32_32x32x16_bf16 v[160:175], a[24:27], v[28:31], v[160:175]
    ds_read_b64_tr_b16 a[8:9], v192 offset:22528
    ds_read_b64_tr_b16 a[10:11], v192 offset:23552
    v_exp_f32 v234, v234
    s_waitcnt lgkmcnt(6)
    v_mfma_f32_32x32x16_bf16 v[176:191], a[28:31], v[28:31], v[176:191]
    ds_read_b64_tr_b16 a[12:13], v193 offset:22528
    ds_read_b64_tr_b16 a[14:15], v193 offset:23552
    v_exp_f32 v235, v235
    v_mul_f32 v236, v228, v236
    s_waitcnt lgkmcnt(6)
    v_mfma_f32_32x32x16_bf16 v[128:143], a[0:3], v[32:35], v[128:143]
    ds_read_b64_tr_b16 a[16:17], v192 offset:10240
    ds_read_b64_tr_b16 a[18:19], v192 offset:11264
    v_mul_f32 v237, v229, v237
    v_mul_f32 v238, v230, v238
    v_mul_f32 v239, v231, v239
    s_waitcnt lgkmcnt(6)
    v_mfma_f32_32x32x16_bf16 v[144:159], a[4:7], v[32:35], v[144:159]
    ds_read_b64_tr_b16 a[20:21], v193 offset:10240
    ds_read_b64_tr_b16 a[22:23], v193 offset:11264
    v_fma_f32 v232, v232, v15, v15
    v_fma_f32 v233, v233, v15, v15
    v_fma_f32 v234, v234, v15, v15
    s_waitcnt lgkmcnt(6)
    v_mfma_f32_32x32x16_bf16 v[160:175], a[8:11], v[32:35], v[160:175]
    ds_read_b64_tr_b16 a[24:25], v192 offset:24576
    ds_read_b64_tr_b16 a[26:27], v192 offset:25600
    v_fma_f32 v235, v235, v15, v15
    v_rcp_f32 v232, v232
    s_waitcnt lgkmcnt(6)
    v_mfma_f32_32x32x16_bf16 v[176:191], a[12:15], v[32:35], v[176:191]
    ds_read_b64_tr_b16 a[28:29], v193 offset:24576
    ds_read_b64_tr_b16 a[30:31], v193 offset:25600
    v_rcp_f32 v233, v233
    s_waitcnt lgkmcnt(6)
    v_mfma_f32_32x32x16_bf16 v[128:143], a[16:19], v[36:39], v[128:143]
    ds_read_b64_tr_b16 a[0:1], v192 offset:12288
    ds_read_b64_tr_b16 a[2:3], v192 offset:13312
    v_rcp_f32 v234, v234
    s_waitcnt lgkmcnt(6)
    v_mfma_f32_32x32x16_bf16 v[144:159], a[20:23], v[36:39], v[144:159]
    ds_read_b64_tr_b16 a[4:5], v193 offset:12288
    ds_read_b64_tr_b16 a[6:7], v193 offset:13312
    v_rcp_f32 v235, v235
    v_accvgpr_read_b32 v240, a100
    s_waitcnt lgkmcnt(6)
    v_mfma_f32_32x32x16_bf16 v[160:175], a[24:27], v[36:39], v[160:175]
    ds_read_b64_tr_b16 a[8:9], v192 offset:26624
    ds_read_b64_tr_b16 a[10:11], v192 offset:27648
    v_accvgpr_read_b32 v241, a101
    v_accvgpr_read_b32 v242, a102
    v_accvgpr_read_b32 v243, a103
    s_waitcnt lgkmcnt(6)
    v_mfma_f32_32x32x16_bf16 v[176:191], a[28:31], v[36:39], v[176:191]
    ds_read_b64_tr_b16 a[12:13], v193 offset:26624
    ds_read_b64_tr_b16 a[14:15], v193 offset:27648
    v_accvgpr_read_b32 v248, a132
    v_accvgpr_read_b32 v249, a133
    v_accvgpr_read_b32 v250, a134
    s_waitcnt lgkmcnt(6)
    v_mfma_f32_32x32x16_bf16 v[128:143], a[0:3], v[40:43], v[128:143]
    v_add_u32 v194, 57344, v12
    v_add_u32 v195, 57344, v13
    s_waitcnt vmcnt(19)
    s_barrier
    ds_read_b64_tr_b16 a[16:17], v194 offset:0
    ds_read_b64_tr_b16 a[18:19], v194 offset:1024
    v_accvgpr_read_b32 v251, a135
    v_mul_f32 v244, v14, v240
    v_mul_f32 v245, v14, v241
    s_waitcnt lgkmcnt(6)
    v_mfma_f32_32x32x16_bf16 v[144:159], a[4:7], v[40:43], v[144:159]
    ds_read_b64_tr_b16 a[20:21], v195 offset:0
    ds_read_b64_tr_b16 a[22:23], v195 offset:1024
    v_mul_f32 v246, v14, v242
    v_mul_f32 v247, v14, v243
    s_waitcnt lgkmcnt(6)
    v_mfma_f32_32x32x16_bf16 v[160:175], a[8:11], v[40:43], v[160:175]
    ds_read_b64_tr_b16 a[24:25], v194 offset:14336
    ds_read_b64_tr_b16 a[26:27], v194 offset:15360
    v_exp_f32 v244, v244
    s_waitcnt lgkmcnt(6)
    v_mfma_f32_32x32x16_bf16 v[176:191], a[12:15], v[40:43], v[176:191]
    ds_read_b64_tr_b16 a[28:29], v195 offset:14336
    ds_read_b64_tr_b16 a[30:31], v195 offset:15360
    v_exp_f32 v245, v245
    v_mul_f32 v236, v236, v232
    s_waitcnt lgkmcnt(6)
    v_mfma_f32_32x32x16_bf16 v[128:143], a[16:19], v[44:47], v[128:143]
    ds_read_b64_tr_b16 a[0:1], v194 offset:2048
    ds_read_b64_tr_b16 a[2:3], v194 offset:3072
    v_mul_f32 v237, v237, v233
    v_mul_f32 v238, v238, v234
    v_mul_f32 v239, v239, v235
    s_waitcnt lgkmcnt(6)
    v_mfma_f32_32x32x16_bf16 v[144:159], a[20:23], v[44:47], v[144:159]
    ds_read_b64_tr_b16 a[4:5], v195 offset:2048
    ds_read_b64_tr_b16 a[6:7], v195 offset:3072
    v_cvt_pk_bf16_f32 v220, v236, v237
    v_cvt_pk_bf16_f32 v221, v238, v239
    s_waitcnt lgkmcnt(6)
    v_mfma_f32_32x32x16_bf16 v[160:175], a[24:27], v[44:47], v[160:175]
    ds_read_b64_tr_b16 a[8:9], v194 offset:16384
    ds_read_b64_tr_b16 a[10:11], v194 offset:17408
    v_exp_f32 v246, v246
    s_waitcnt lgkmcnt(6)
    v_mfma_f32_32x32x16_bf16 v[176:191], a[28:31], v[44:47], v[176:191]
    ds_read_b64_tr_b16 a[12:13], v195 offset:16384
    ds_read_b64_tr_b16 a[14:15], v195 offset:17408
    v_exp_f32 v247, v247
    v_mul_f32 v248, v240, v248
    s_waitcnt lgkmcnt(6)
    v_mfma_f32_32x32x16_bf16 v[128:143], a[0:3], v[48:51], v[128:143]
    ds_read_b64_tr_b16 a[16:17], v194 offset:4096
    ds_read_b64_tr_b16 a[18:19], v194 offset:5120
    v_mul_f32 v249, v241, v249
    v_mul_f32 v250, v242, v250
    v_mul_f32 v251, v243, v251
    s_waitcnt lgkmcnt(6)
    v_mfma_f32_32x32x16_bf16 v[144:159], a[4:7], v[48:51], v[144:159]
    ds_read_b64_tr_b16 a[20:21], v195 offset:4096
    ds_read_b64_tr_b16 a[22:23], v195 offset:5120
    v_fma_f32 v244, v244, v15, v15
    v_fma_f32 v245, v245, v15, v15
    v_fma_f32 v246, v246, v15, v15
    s_waitcnt lgkmcnt(6)
    v_mfma_f32_32x32x16_bf16 v[160:175], a[8:11], v[48:51], v[160:175]
    ds_read_b64_tr_b16 a[24:25], v194 offset:18432
    ds_read_b64_tr_b16 a[26:27], v194 offset:19456
    v_fma_f32 v247, v247, v15, v15
    v_rcp_f32 v244, v244
    s_waitcnt lgkmcnt(6)
    v_mfma_f32_32x32x16_bf16 v[176:191], a[12:15], v[48:51], v[176:191]
    ds_read_b64_tr_b16 a[28:29], v195 offset:18432
    ds_read_b64_tr_b16 a[30:31], v195 offset:19456
    v_rcp_f32 v245, v245
    s_waitcnt lgkmcnt(6)
    v_mfma_f32_32x32x16_bf16 v[128:143], a[16:19], v[52:55], v[128:143]
    ds_read_b64_tr_b16 a[0:1], v194 offset:6144
    ds_read_b64_tr_b16 a[2:3], v194 offset:7168
    v_rcp_f32 v246, v246
    s_waitcnt lgkmcnt(6)
    v_mfma_f32_32x32x16_bf16 v[144:159], a[20:23], v[52:55], v[144:159]
    ds_read_b64_tr_b16 a[4:5], v195 offset:6144
    ds_read_b64_tr_b16 a[6:7], v195 offset:7168
    v_rcp_f32 v247, v247
    v_accvgpr_read_b32 v228, a104
    s_waitcnt lgkmcnt(6)
    v_mfma_f32_32x32x16_bf16 v[160:175], a[24:27], v[52:55], v[160:175]
    ds_read_b64_tr_b16 a[8:9], v194 offset:20480
    ds_read_b64_tr_b16 a[10:11], v194 offset:21504
    v_accvgpr_read_b32 v229, a105
    v_accvgpr_read_b32 v230, a106
    v_accvgpr_read_b32 v231, a107
    s_waitcnt lgkmcnt(6)
    v_mfma_f32_32x32x16_bf16 v[176:191], a[28:31], v[52:55], v[176:191]
    ds_read_b64_tr_b16 a[12:13], v195 offset:20480
    ds_read_b64_tr_b16 a[14:15], v195 offset:21504
    v_accvgpr_read_b32 v236, a136
    v_accvgpr_read_b32 v237, a137
    v_accvgpr_read_b32 v238, a138
    s_waitcnt lgkmcnt(6)
    v_mfma_f32_32x32x16_bf16 v[128:143], a[0:3], v[56:59], v[128:143]
    ds_read_b64_tr_b16 a[16:17], v194 offset:8192
    ds_read_b64_tr_b16 a[18:19], v194 offset:9216
    v_accvgpr_read_b32 v239, a139
    v_mul_f32 v232, v14, v228
    v_mul_f32 v233, v14, v229
    s_waitcnt lgkmcnt(6)
    v_mfma_f32_32x32x16_bf16 v[144:159], a[4:7], v[56:59], v[144:159]
    ds_read_b64_tr_b16 a[20:21], v195 offset:8192
    ds_read_b64_tr_b16 a[22:23], v195 offset:9216
    v_mul_f32 v234, v14, v230
    v_mul_f32 v235, v14, v231
    s_waitcnt lgkmcnt(6)
    v_mfma_f32_32x32x16_bf16 v[160:175], a[8:11], v[56:59], v[160:175]
    ds_read_b64_tr_b16 a[24:25], v194 offset:22528
    ds_read_b64_tr_b16 a[26:27], v194 offset:23552
    v_exp_f32 v232, v232
    s_waitcnt lgkmcnt(6)
    v_mfma_f32_32x32x16_bf16 v[176:191], a[12:15], v[56:59], v[176:191]
    ds_read_b64_tr_b16 a[28:29], v195 offset:22528
    ds_read_b64_tr_b16 a[30:31], v195 offset:23552
    v_exp_f32 v233, v233
    v_mul_f32 v248, v248, v244
    s_waitcnt lgkmcnt(6)
    v_mfma_f32_32x32x16_bf16 v[128:143], a[16:19], v[60:63], v[128:143]
    ds_read_b64_tr_b16 a[0:1], v194 offset:10240
    ds_read_b64_tr_b16 a[2:3], v194 offset:11264
    v_mul_f32 v249, v249, v245
    v_mul_f32 v250, v250, v246
    v_mul_f32 v251, v251, v247
    s_waitcnt lgkmcnt(6)
    v_mfma_f32_32x32x16_bf16 v[144:159], a[20:23], v[60:63], v[144:159]
    ds_read_b64_tr_b16 a[4:5], v195 offset:10240
    ds_read_b64_tr_b16 a[6:7], v195 offset:11264
    v_cvt_pk_bf16_f32 v222, v248, v249
    v_cvt_pk_bf16_f32 v223, v250, v251
    s_waitcnt lgkmcnt(6)
    v_mfma_f32_32x32x16_bf16 v[160:175], a[24:27], v[60:63], v[160:175]
    ds_read_b64_tr_b16 a[8:9], v194 offset:24576
    ds_read_b64_tr_b16 a[10:11], v194 offset:25600
    global_store_dwordx4 v202, v[220:223], s[34:35] offset:0 sc1
    s_waitcnt lgkmcnt(6)
    v_mfma_f32_32x32x16_bf16 v[176:191], a[28:31], v[60:63], v[176:191]
    ds_read_b64_tr_b16 a[12:13], v195 offset:24576
    ds_read_b64_tr_b16 a[14:15], v195 offset:25600
    v_exp_f32 v234, v234
    s_waitcnt lgkmcnt(6)
    v_mfma_f32_32x32x16_bf16 v[128:143], a[0:3], v[64:67], v[128:143]
    ds_read_b64_tr_b16 a[16:17], v194 offset:12288
    ds_read_b64_tr_b16 a[18:19], v194 offset:13312
    v_exp_f32 v235, v235
    v_mul_f32 v236, v228, v236
    s_waitcnt lgkmcnt(6)
    v_mfma_f32_32x32x16_bf16 v[144:159], a[4:7], v[64:67], v[144:159]
    ds_read_b64_tr_b16 a[20:21], v195 offset:12288
    ds_read_b64_tr_b16 a[22:23], v195 offset:13312
    v_mul_f32 v237, v229, v237
    v_mul_f32 v238, v230, v238
    v_mul_f32 v239, v231, v239
    s_waitcnt lgkmcnt(6)
    v_mfma_f32_32x32x16_bf16 v[160:175], a[8:11], v[64:67], v[160:175]
    ds_read_b64_tr_b16 a[24:25], v194 offset:26624
    ds_read_b64_tr_b16 a[26:27], v194 offset:27648
    v_fma_f32 v232, v232, v15, v15
    v_fma_f32 v233, v233, v15, v15
    v_fma_f32 v234, v234, v15, v15
    s_waitcnt lgkmcnt(6)
    v_mfma_f32_32x32x16_bf16 v[176:191], a[12:15], v[64:67], v[176:191]
    ds_read_b64_tr_b16 a[28:29], v195 offset:26624
    ds_read_b64_tr_b16 a[30:31], v195 offset:27648
    v_fma_f32 v235, v235, v15, v15
    v_rcp_f32 v232, v232
    s_waitcnt lgkmcnt(6)
    v_mfma_f32_32x32x16_bf16 v[128:143], a[16:19], v[68:71], v[128:143]
    v_add_u32 v192, 86016, v12
    v_add_u32 v193, 86016, v13
    s_waitcnt vmcnt(12)
    s_barrier
    ds_read_b64_tr_b16 a[0:1], v192 offset:0
    ds_read_b64_tr_b16 a[2:3], v192 offset:1024
    v_rcp_f32 v233, v233
    s_waitcnt lgkmcnt(6)
    v_mfma_f32_32x32x16_bf16 v[144:159], a[20:23], v[68:71], v[144:159]
    ds_read_b64_tr_b16 a[4:5], v193 offset:0
    ds_read_b64_tr_b16 a[6:7], v193 offset:1024
    v_rcp_f32 v234, v234
    s_waitcnt lgkmcnt(6)
    v_mfma_f32_32x32x16_bf16 v[160:175], a[24:27], v[68:71], v[160:175]
    ds_read_b64_tr_b16 a[8:9], v192 offset:14336
    ds_read_b64_tr_b16 a[10:11], v192 offset:15360
    v_rcp_f32 v235, v235
    v_accvgpr_read_b32 v240, a108
    s_waitcnt lgkmcnt(6)
    v_mfma_f32_32x32x16_bf16 v[176:191], a[28:31], v[68:71], v[176:191]
    ds_read_b64_tr_b16 a[12:13], v193 offset:14336
    ds_read_b64_tr_b16 a[14:15], v193 offset:15360
    v_accvgpr_read_b32 v241, a109
    v_accvgpr_read_b32 v242, a110
    v_accvgpr_read_b32 v243, a111
    s_waitcnt lgkmcnt(6)
    v_mfma_f32_32x32x16_bf16 v[128:143], a[0:3], v[72:75], v[128:143]
    ds_read_b64_tr_b16 a[16:17], v192 offset:2048
    ds_read_b64_tr_b16 a[18:19], v192 offset:3072
    v_accvgpr_read_b32 v248, a140
    v_accvgpr_read_b32 v249, a141
    v_accvgpr_read_b32 v250, a142
    s_waitcnt lgkmcnt(6)
    v_mfma_f32_32x32x16_bf16 v[144:159], a[4:7], v[72:75], v[144:159]
    ds_read_b64_tr_b16 a[20:21], v193 offset:2048
    ds_read_b64_tr_b16 a[22:23], v193 offset:3072
    v_accvgpr_read_b32 v251, a143
    v_mul_f32 v244, v14, v240
    v_mul_f32 v245, v14, v241
    s_waitcnt lgkmcnt(6)
    v_mfma_f32_32x32x16_bf16 v[160:175], a[8:11], v[72:75], v[160:175]
    ds_read_b64_tr_b16 a[24:25], v192 offset:16384
    ds_read_b64_tr_b16 a[26:27], v192 offset:17408
    v_mul_f32 v246, v14, v242
    v_mul_f32 v247, v14, v243
    s_waitcnt lgkmcnt(6)
    v_mfma_f32_32x32x16_bf16 v[176:191], a[12:15], v[72:75], v[176:191]
    ds_read_b64_tr_b16 a[28:29], v193 offset:16384
    ds_read_b64_tr_b16 a[30:31], v193 offset:17408
    v_exp_f32 v244, v244
    s_waitcnt lgkmcnt(6)
    v_mfma_f32_32x32x16_bf16 v[128:143], a[16:19], v[76:79], v[128:143]
    ds_read_b64_tr_b16 a[0:1], v192 offset:4096
    ds_read_b64_tr_b16 a[2:3], v192 offset:5120
    v_exp_f32 v245, v245
    v_mul_f32 v236, v236, v232
    s_waitcnt lgkmcnt(6)
    v_mfma_f32_32x32x16_bf16 v[144:159], a[20:23], v[76:79], v[144:159]
    ds_read_b64_tr_b16 a[4:5], v193 offset:4096
    ds_read_b64_tr_b16 a[6:7], v193 offset:5120
    v_mul_f32 v237, v237, v233
    v_mul_f32 v238, v238, v234
    v_mul_f32 v239, v239, v235
    s_waitcnt lgkmcnt(6)
    v_mfma_f32_32x32x16_bf16 v[160:175], a[24:27], v[76:79], v[160:175]
    ds_read_b64_tr_b16 a[8:9], v192 offset:18432
    ds_read_b64_tr_b16 a[10:11], v192 offset:19456
    v_cvt_pk_bf16_f32 v224, v236, v237
    v_cvt_pk_bf16_f32 v225, v238, v239
    s_waitcnt lgkmcnt(6)
    v_mfma_f32_32x32x16_bf16 v[176:191], a[28:31], v[76:79], v[176:191]
    ds_read_b64_tr_b16 a[12:13], v193 offset:18432
    ds_read_b64_tr_b16 a[14:15], v193 offset:19456
    v_exp_f32 v246, v246
    s_waitcnt lgkmcnt(6)
    v_mfma_f32_32x32x16_bf16 v[128:143], a[0:3], v[80:83], v[128:143]
    ds_read_b64_tr_b16 a[16:17], v192 offset:6144
    ds_read_b64_tr_b16 a[18:19], v192 offset:7168
    v_exp_f32 v247, v247
    v_mul_f32 v248, v240, v248
    s_waitcnt lgkmcnt(6)
    v_mfma_f32_32x32x16_bf16 v[144:159], a[4:7], v[80:83], v[144:159]
    ds_read_b64_tr_b16 a[20:21], v193 offset:6144
    ds_read_b64_tr_b16 a[22:23], v193 offset:7168
    v_mul_f32 v249, v241, v249
    v_mul_f32 v250, v242, v250
    v_mul_f32 v251, v243, v251
    s_waitcnt lgkmcnt(6)
    v_mfma_f32_32x32x16_bf16 v[160:175], a[8:11], v[80:83], v[160:175]
    ds_read_b64_tr_b16 a[24:25], v192 offset:20480
    ds_read_b64_tr_b16 a[26:27], v192 offset:21504
    v_fma_f32 v244, v244, v15, v15
    v_fma_f32 v245, v245, v15, v15
    v_fma_f32 v246, v246, v15, v15
    s_waitcnt lgkmcnt(6)
    v_mfma_f32_32x32x16_bf16 v[176:191], a[12:15], v[80:83], v[176:191]
    ds_read_b64_tr_b16 a[28:29], v193 offset:20480
    ds_read_b64_tr_b16 a[30:31], v193 offset:21504
    v_fma_f32 v247, v247, v15, v15
    v_rcp_f32 v244, v244
    s_waitcnt lgkmcnt(6)
    v_mfma_f32_32x32x16_bf16 v[128:143], a[16:19], v[84:87], v[128:143]
    ds_read_b64_tr_b16 a[0:1], v192 offset:8192
    ds_read_b64_tr_b16 a[2:3], v192 offset:9216
    v_rcp_f32 v245, v245
    s_waitcnt lgkmcnt(6)
    v_mfma_f32_32x32x16_bf16 v[144:159], a[20:23], v[84:87], v[144:159]
    ds_read_b64_tr_b16 a[4:5], v193 offset:8192
    ds_read_b64_tr_b16 a[6:7], v193 offset:9216
    v_rcp_f32 v246, v246
    s_waitcnt lgkmcnt(6)
    v_mfma_f32_32x32x16_bf16 v[160:175], a[24:27], v[84:87], v[160:175]
    ds_read_b64_tr_b16 a[8:9], v192 offset:22528
    ds_read_b64_tr_b16 a[10:11], v192 offset:23552
    v_rcp_f32 v247, v247
    v_accvgpr_read_b32 v228, a112
    s_waitcnt lgkmcnt(6)
    v_mfma_f32_32x32x16_bf16 v[176:191], a[28:31], v[84:87], v[176:191]
    ds_read_b64_tr_b16 a[12:13], v193 offset:22528
    ds_read_b64_tr_b16 a[14:15], v193 offset:23552
    v_accvgpr_read_b32 v229, a113
    v_accvgpr_read_b32 v230, a114
    v_accvgpr_read_b32 v231, a115
    s_waitcnt lgkmcnt(6)
    v_mfma_f32_32x32x16_bf16 v[128:143], a[0:3], v[88:91], v[128:143]
    ds_read_b64_tr_b16 a[16:17], v192 offset:10240
    ds_read_b64_tr_b16 a[18:19], v192 offset:11264
    v_accvgpr_read_b32 v236, a144
    v_accvgpr_read_b32 v237, a145
    v_accvgpr_read_b32 v238, a146
    s_waitcnt lgkmcnt(6)
    v_mfma_f32_32x32x16_bf16 v[144:159], a[4:7], v[88:91], v[144:159]
    ds_read_b64_tr_b16 a[20:21], v193 offset:10240
    ds_read_b64_tr_b16 a[22:23], v193 offset:11264
    v_accvgpr_read_b32 v239, a147
    v_mul_f32 v232, v14, v228
    v_mul_f32 v233, v14, v229
    s_waitcnt lgkmcnt(6)
    v_mfma_f32_32x32x16_bf16 v[160:175], a[8:11], v[88:91], v[160:175]
    ds_read_b64_tr_b16 a[24:25], v192 offset:24576
    ds_read_b64_tr_b16 a[26:27], v192 offset:25600
    v_mul_f32 v234, v14, v230
    v_mul_f32 v235, v14, v231
    s_waitcnt lgkmcnt(6)
    v_mfma_f32_32x32x16_bf16 v[176:191], a[12:15], v[88:91], v[176:191]
    ds_read_b64_tr_b16 a[28:29], v193 offset:24576
    ds_read_b64_tr_b16 a[30:31], v193 offset:25600
    v_exp_f32 v232, v232
    s_waitcnt lgkmcnt(6)
    v_mfma_f32_32x32x16_bf16 v[128:143], a[16:19], v[92:95], v[128:143]
    ds_read_b64_tr_b16 a[0:1], v192 offset:12288
    ds_read_b64_tr_b16 a[2:3], v192 offset:13312
    v_exp_f32 v233, v233
    v_mul_f32 v248, v248, v244
    s_waitcnt lgkmcnt(6)
    v_mfma_f32_32x32x16_bf16 v[144:159], a[20:23], v[92:95], v[144:159]
    ds_read_b64_tr_b16 a[4:5], v193 offset:12288
    ds_read_b64_tr_b16 a[6:7], v193 offset:13312
    v_mul_f32 v249, v249, v245
    v_mul_f32 v250, v250, v246
    v_mul_f32 v251, v251, v247
    s_waitcnt lgkmcnt(6)
    v_mfma_f32_32x32x16_bf16 v[160:175], a[24:27], v[92:95], v[160:175]
    ds_read_b64_tr_b16 a[8:9], v192 offset:26624
    ds_read_b64_tr_b16 a[10:11], v192 offset:27648
    v_cvt_pk_bf16_f32 v226, v248, v249
    v_cvt_pk_bf16_f32 v227, v250, v251
    s_waitcnt lgkmcnt(6)
    v_mfma_f32_32x32x16_bf16 v[176:191], a[28:31], v[92:95], v[176:191]
    ds_read_b64_tr_b16 a[12:13], v193 offset:26624
    ds_read_b64_tr_b16 a[14:15], v193 offset:27648
    global_store_dwordx4 v202, v[224:227], s[34:35] offset:1024 sc1
    s_waitcnt lgkmcnt(6)
    v_mfma_f32_32x32x16_bf16 v[128:143], a[0:3], v[96:99], v[128:143]
    v_add_u32 v194, 114688, v12
    v_add_u32 v195, 114688, v13
    s_waitcnt vmcnt(5)
    s_barrier
    ds_read_b64_tr_b16 a[16:17], v194 offset:0
    ds_read_b64_tr_b16 a[18:19], v194 offset:1024
    v_exp_f32 v234, v234
    s_waitcnt lgkmcnt(6)
    v_mfma_f32_32x32x16_bf16 v[144:159], a[4:7], v[96:99], v[144:159]
    ds_read_b64_tr_b16 a[20:21], v195 offset:0
    ds_read_b64_tr_b16 a[22:23], v195 offset:1024
    v_exp_f32 v235, v235
    v_mul_f32 v236, v228, v236
    s_waitcnt lgkmcnt(6)
    v_mfma_f32_32x32x16_bf16 v[160:175], a[8:11], v[96:99], v[160:175]
    ds_read_b64_tr_b16 a[24:25], v194 offset:14336
    ds_read_b64_tr_b16 a[26:27], v194 offset:15360
    v_mul_f32 v237, v229, v237
    v_mul_f32 v238, v230, v238
    v_mul_f32 v239, v231, v239
    s_waitcnt lgkmcnt(6)
    v_mfma_f32_32x32x16_bf16 v[176:191], a[12:15], v[96:99], v[176:191]
    ds_read_b64_tr_b16 a[28:29], v195 offset:14336
    ds_read_b64_tr_b16 a[30:31], v195 offset:15360
    v_fma_f32 v232, v232, v15, v15
    v_fma_f32 v233, v233, v15, v15
    v_fma_f32 v234, v234, v15, v15
    s_waitcnt lgkmcnt(6)
    v_mfma_f32_32x32x16_bf16 v[128:143], a[16:19], v[100:103], v[128:143]
    ds_read_b64_tr_b16 a[0:1], v194 offset:2048
    ds_read_b64_tr_b16 a[2:3], v194 offset:3072
    v_fma_f32 v235, v235, v15, v15
    v_rcp_f32 v232, v232
    s_waitcnt lgkmcnt(6)
    v_mfma_f32_32x32x16_bf16 v[144:159], a[20:23], v[100:103], v[144:159]
    ds_read_b64_tr_b16 a[4:5], v195 offset:2048
    ds_read_b64_tr_b16 a[6:7], v195 offset:3072
    v_rcp_f32 v233, v233
    s_waitcnt lgkmcnt(6)
    v_mfma_f32_32x32x16_bf16 v[160:175], a[24:27], v[100:103], v[160:175]
    ds_read_b64_tr_b16 a[8:9], v194 offset:16384
    ds_read_b64_tr_b16 a[10:11], v194 offset:17408
    v_rcp_f32 v234, v234
    s_waitcnt lgkmcnt(6)
    v_mfma_f32_32x32x16_bf16 v[176:191], a[28:31], v[100:103], v[176:191]
    ds_read_b64_tr_b16 a[12:13], v195 offset:16384
    ds_read_b64_tr_b16 a[14:15], v195 offset:17408
    v_rcp_f32 v235, v235
    v_accvgpr_read_b32 v240, a116
    s_waitcnt lgkmcnt(6)
    v_mfma_f32_32x32x16_bf16 v[128:143], a[0:3], v[104:107], v[128:143]
    ds_read_b64_tr_b16 a[16:17], v194 offset:4096
    ds_read_b64_tr_b16 a[18:19], v194 offset:5120
    v_accvgpr_read_b32 v241, a117
    v_accvgpr_read_b32 v242, a118
    v_accvgpr_read_b32 v243, a119
    s_waitcnt lgkmcnt(6)
    v_mfma_f32_32x32x16_bf16 v[144:159], a[4:7], v[104:107], v[144:159]
    ds_read_b64_tr_b16 a[20:21], v195 offset:4096
    ds_read_b64_tr_b16 a[22:23], v195 offset:5120
    v_accvgpr_read_b32 v248, a148
    v_accvgpr_read_b32 v249, a149
    v_accvgpr_read_b32 v250, a150
    s_waitcnt lgkmcnt(6)
    v_mfma_f32_32x32x16_bf16 v[160:175], a[8:11], v[104:107], v[160:175]
    ds_read_b64_tr_b16 a[24:25], v194 offset:18432
    ds_read_b64_tr_b16 a[26:27], v194 offset:19456
    v_accvgpr_read_b32 v251, a151
    v_mul_f32 v244, v14, v240
    v_mul_f32 v245, v14, v241
    s_waitcnt lgkmcnt(6)
    v_mfma_f32_32x32x16_bf16 v[176:191], a[12:15], v[104:107], v[176:191]
    ds_read_b64_tr_b16 a[28:29], v195 offset:18432
    ds_read_b64_tr_b16 a[30:31], v195 offset:19456
    v_mul_f32 v246, v14, v242
    v_mul_f32 v247, v14, v243
    s_waitcnt lgkmcnt(6)
    v_mfma_f32_32x32x16_bf16 v[128:143], a[16:19], v[108:111], v[128:143]
    ds_read_b64_tr_b16 a[0:1], v194 offset:6144
    ds_read_b64_tr_b16 a[2:3], v194 offset:7168
    v_exp_f32 v244, v244
    s_waitcnt lgkmcnt(6)
    v_mfma_f32_32x32x16_bf16 v[144:159], a[20:23], v[108:111], v[144:159]
    ds_read_b64_tr_b16 a[4:5], v195 offset:6144
    ds_read_b64_tr_b16 a[6:7], v195 offset:7168
    v_exp_f32 v245, v245
    v_mul_f32 v236, v236, v232
    s_waitcnt lgkmcnt(6)
    v_mfma_f32_32x32x16_bf16 v[160:175], a[24:27], v[108:111], v[160:175]
    ds_read_b64_tr_b16 a[8:9], v194 offset:20480
    ds_read_b64_tr_b16 a[10:11], v194 offset:21504
    v_mul_f32 v237, v237, v233
    v_mul_f32 v238, v238, v234
    v_mul_f32 v239, v239, v235
    s_waitcnt lgkmcnt(6)
    v_mfma_f32_32x32x16_bf16 v[176:191], a[28:31], v[108:111], v[176:191]
    ds_read_b64_tr_b16 a[12:13], v195 offset:20480
    ds_read_b64_tr_b16 a[14:15], v195 offset:21504
    v_cvt_pk_bf16_f32 v220, v236, v237
    v_cvt_pk_bf16_f32 v221, v238, v239
    s_waitcnt lgkmcnt(6)
    v_mfma_f32_32x32x16_bf16 v[128:143], a[0:3], v[112:115], v[128:143]
    ds_read_b64_tr_b16 a[16:17], v194 offset:8192
    ds_read_b64_tr_b16 a[18:19], v194 offset:9216
    v_exp_f32 v246, v246
    s_waitcnt lgkmcnt(6)
    v_mfma_f32_32x32x16_bf16 v[144:159], a[4:7], v[112:115], v[144:159]
    ds_read_b64_tr_b16 a[20:21], v195 offset:8192
    ds_read_b64_tr_b16 a[22:23], v195 offset:9216
    v_exp_f32 v247, v247
    v_mul_f32 v248, v240, v248
    s_waitcnt lgkmcnt(6)
    v_mfma_f32_32x32x16_bf16 v[160:175], a[8:11], v[112:115], v[160:175]
    ds_read_b64_tr_b16 a[24:25], v194 offset:22528
    ds_read_b64_tr_b16 a[26:27], v194 offset:23552
    v_mul_f32 v249, v241, v249
    v_mul_f32 v250, v242, v250
    v_mul_f32 v251, v243, v251
    s_waitcnt lgkmcnt(6)
    v_mfma_f32_32x32x16_bf16 v[176:191], a[12:15], v[112:115], v[176:191]
    ds_read_b64_tr_b16 a[28:29], v195 offset:22528
    ds_read_b64_tr_b16 a[30:31], v195 offset:23552
    v_fma_f32 v244, v244, v15, v15
    v_fma_f32 v245, v245, v15, v15
    v_fma_f32 v246, v246, v15, v15
    s_waitcnt lgkmcnt(6)
    v_mfma_f32_32x32x16_bf16 v[128:143], a[16:19], v[116:119], v[128:143]
    ds_read_b64_tr_b16 a[0:1], v194 offset:10240
    ds_read_b64_tr_b16 a[2:3], v194 offset:11264
    v_fma_f32 v247, v247, v15, v15
    v_rcp_f32 v244, v244
    s_waitcnt lgkmcnt(6)
    v_mfma_f32_32x32x16_bf16 v[144:159], a[20:23], v[116:119], v[144:159]
    ds_read_b64_tr_b16 a[4:5], v195 offset:10240
    ds_read_b64_tr_b16 a[6:7], v195 offset:11264
    v_rcp_f32 v245, v245
    s_waitcnt lgkmcnt(6)
    v_mfma_f32_32x32x16_bf16 v[160:175], a[24:27], v[116:119], v[160:175]
    ds_read_b64_tr_b16 a[8:9], v194 offset:24576
    ds_read_b64_tr_b16 a[10:11], v194 offset:25600
    v_rcp_f32 v246, v246
    s_waitcnt lgkmcnt(6)
    v_mfma_f32_32x32x16_bf16 v[176:191], a[28:31], v[116:119], v[176:191]
    ds_read_b64_tr_b16 a[12:13], v195 offset:24576
    ds_read_b64_tr_b16 a[14:15], v195 offset:25600
    v_rcp_f32 v247, v247
    v_accvgpr_read_b32 v228, a120
    s_waitcnt lgkmcnt(6)
    v_mfma_f32_32x32x16_bf16 v[128:143], a[0:3], v[120:123], v[128:143]
    ds_read_b64_tr_b16 a[16:17], v194 offset:12288
    ds_read_b64_tr_b16 a[18:19], v194 offset:13312
    v_accvgpr_read_b32 v229, a121
    v_accvgpr_read_b32 v230, a122
    v_accvgpr_read_b32 v231, a123
    s_waitcnt lgkmcnt(6)
    v_mfma_f32_32x32x16_bf16 v[144:159], a[4:7], v[120:123], v[144:159]
    ds_read_b64_tr_b16 a[20:21], v195 offset:12288
    ds_read_b64_tr_b16 a[22:23], v195 offset:13312
    v_accvgpr_read_b32 v236, a152
    v_accvgpr_read_b32 v237, a153
    v_accvgpr_read_b32 v238, a154
    s_waitcnt lgkmcnt(6)
    v_mfma_f32_32x32x16_bf16 v[160:175], a[8:11], v[120:123], v[160:175]
    ds_read_b64_tr_b16 a[24:25], v194 offset:26624
    ds_read_b64_tr_b16 a[26:27], v194 offset:27648
    v_accvgpr_read_b32 v239, a155
    v_mul_f32 v232, v14, v228
    v_mul_f32 v233, v14, v229
    s_waitcnt lgkmcnt(6)
    v_mfma_f32_32x32x16_bf16 v[176:191], a[12:15], v[120:123], v[176:191]
    ds_read_b64_tr_b16 a[28:29], v195 offset:26624
    ds_read_b64_tr_b16 a[30:31], v195 offset:27648
    v_mul_f32 v234, v14, v230
    v_mul_f32 v235, v14, v231
    s_waitcnt lgkmcnt(6)
    v_mfma_f32_32x32x16_bf16 v[128:143], a[16:19], v[124:127], v[128:143]
    v_exp_f32 v232, v232
    s_waitcnt lgkmcnt(4)
    v_mfma_f32_32x32x16_bf16 v[144:159], a[20:23], v[124:127], v[144:159]
    v_exp_f32 v233, v233
    v_mul_f32 v248, v248, v244
    s_waitcnt lgkmcnt(2)
    v_mfma_f32_32x32x16_bf16 v[160:175], a[24:27], v[124:127], v[160:175]
    v_mul_f32 v249, v249, v245
    v_mul_f32 v250, v250, v246
    v_mul_f32 v251, v251, v247
    s_waitcnt lgkmcnt(0)
    v_mfma_f32_32x32x16_bf16 v[176:191], a[28:31], v[124:127], v[176:191]
    v_cvt_pk_bf16_f32 v222, v248, v249
    v_cvt_pk_bf16_f32 v223, v250, v251
    global_store_dwordx4 v202, v[220:223], s[34:35] offset:2048 sc1
    v_exp_f32 v234, v234
    v_exp_f32 v235, v235
    v_mul_f32 v236, v228, v236
    v_mul_f32 v237, v229, v237
    v_mul_f32 v238, v230, v238
    v_mul_f32 v239, v231, v239
    v_fma_f32 v232, v232, v15, v15
    v_fma_f32 v233, v233, v15, v15
    v_fma_f32 v234, v234, v15, v15
    v_fma_f32 v235, v235, v15, v15
    v_rcp_f32 v232, v232
    v_rcp_f32 v233, v233
    v_rcp_f32 v234, v234
    v_rcp_f32 v235, v235
    v_accvgpr_read_b32 v240, a124
    v_accvgpr_read_b32 v241, a125
    v_accvgpr_read_b32 v242, a126
    v_accvgpr_read_b32 v243, a127
    v_accvgpr_read_b32 v248, a156
    v_accvgpr_read_b32 v249, a157
    v_accvgpr_read_b32 v250, a158
    v_accvgpr_read_b32 v251, a159
    v_mul_f32 v244, v14, v240
    v_mul_f32 v245, v14, v241
    v_mul_f32 v246, v14, v242
    v_mul_f32 v247, v14, v243
    v_exp_f32 v244, v244
    v_exp_f32 v245, v245
    v_mul_f32 v236, v236, v232
    v_mul_f32 v237, v237, v233
    v_mul_f32 v238, v238, v234
    v_mul_f32 v239, v239, v235
    v_cvt_pk_bf16_f32 v224, v236, v237
    v_cvt_pk_bf16_f32 v225, v238, v239
    v_exp_f32 v246, v246
    v_exp_f32 v247, v247
    v_mul_f32 v248, v240, v248
    v_mul_f32 v249, v241, v249
    v_mul_f32 v250, v242, v250
    v_mul_f32 v251, v243, v251
    v_fma_f32 v244, v244, v15, v15
    v_fma_f32 v245, v245, v15, v15
    v_fma_f32 v246, v246, v15, v15
    v_fma_f32 v247, v247, v15, v15
    v_rcp_f32 v244, v244
    v_rcp_f32 v245, v245
    v_rcp_f32 v246, v246
    v_rcp_f32 v247, v247
    s_nop 0
    v_mul_f32 v248, v248, v244
    v_mul_f32 v249, v249, v245
    v_mul_f32 v250, v250, v246
    v_mul_f32 v251, v251, v247
    v_cvt_pk_bf16_f32 v226, v248, v249
    v_cvt_pk_bf16_f32 v227, v250, v251
    global_store_dwordx4 v202, v[224:227], s[34:35] offset:3072 sc1
    s_barrier
    s_nop 7
    global_load_dword v4, v3, s[34:35] sc1
    s_lshl_b32 s4, s68, 12
    v_add_u32 v202, s4, v200
    v_mul_f32 v232, v14, v128
    v_mul_f32 v233, v14, v129
    v_mul_f32 v234, v14, v130
    v_mul_f32 v235, v14, v131
    v_exp_f32 v232, v232
    v_exp_f32 v233, v233
    v_exp_f32 v234, v234
    v_exp_f32 v235, v235
    v_mul_f32 v236, v128, v160
    v_mul_f32 v237, v129, v161
    v_mul_f32 v238, v130, v162
    v_mul_f32 v239, v131, v163
    v_fma_f32 v232, v232, v15, v15
    v_fma_f32 v233, v233, v15, v15
    v_fma_f32 v234, v234, v15, v15
    v_fma_f32 v235, v235, v15, v15
    v_rcp_f32 v232, v232
    v_rcp_f32 v233, v233
    v_rcp_f32 v234, v234
    v_rcp_f32 v235, v235
    v_mul_f32 v244, v14, v132
    v_mul_f32 v245, v14, v133
    v_mul_f32 v246, v14, v134
    v_mul_f32 v247, v14, v135
    v_exp_f32 v244, v244
    v_exp_f32 v245, v245
    v_exp_f32 v246, v246
    v_exp_f32 v247, v247
    v_mul_f32 v248, v132, v164
    v_mul_f32 v249, v133, v165
    v_mul_f32 v236, v236, v232
    v_mul_f32 v237, v237, v233
    v_mul_f32 v238, v238, v234
    v_mul_f32 v239, v239, v235
    v_cvt_pk_bf16_f32 v96, v236, v237
    v_cvt_pk_bf16_f32 v97, v238, v239
    v_mul_f32 v250, v134, v166
    v_mul_f32 v251, v135, v167
    v_fma_f32 v244, v244, v15, v15
    v_fma_f32 v245, v245, v15, v15
    v_fma_f32 v246, v246, v15, v15
    v_fma_f32 v247, v247, v15, v15
    v_rcp_f32 v244, v244
    v_rcp_f32 v245, v245
    v_rcp_f32 v246, v246
    v_rcp_f32 v247, v247
    v_mul_f32 v232, v14, v136
    v_mul_f32 v233, v14, v137
    v_mul_f32 v234, v14, v138
    v_mul_f32 v235, v14, v139
    v_exp_f32 v232, v232
    v_exp_f32 v233, v233
    v_exp_f32 v234, v234
    v_exp_f32 v235, v235
    v_mul_f32 v236, v136, v168
    v_mul_f32 v237, v137, v169
    v_mul_f32 v248, v248, v244
    v_mul_f32 v249, v249, v245
    v_mul_f32 v250, v250, v246
    v_mul_f32 v251, v251, v247
    v_cvt_pk_bf16_f32 v98, v248, v249
    v_cvt_pk_bf16_f32 v99, v250, v251
    v_mul_f32 v238, v138, v170
    v_mul_f32 v239, v139, v171
    v_fma_f32 v232, v232, v15, v15
    v_fma_f32 v233, v233, v15, v15
    v_fma_f32 v234, v234, v15, v15
    v_fma_f32 v235, v235, v15, v15
    global_load_dword v253, v3, s[34:35] sc1
    v_rcp_f32 v232, v232
    v_rcp_f32 v233, v233
    v_rcp_f32 v234, v234
    v_rcp_f32 v235, v235
    v_mul_f32 v244, v14, v140
    v_mul_f32 v245, v14, v141
    v_mul_f32 v246, v14, v142
    v_mul_f32 v247, v14, v143
    v_exp_f32 v244, v244
    v_exp_f32 v245, v245
    v_exp_f32 v246, v246
    v_exp_f32 v247, v247
    v_mul_f32 v248, v140, v172
    v_mul_f32 v249, v141, v173
    v_mul_f32 v236, v236, v232
    v_mul_f32 v237, v237, v233
    v_mul_f32 v238, v238, v234
    v_mul_f32 v239, v239, v235
    v_cvt_pk_bf16_f32 v100, v236, v237
    v_cvt_pk_bf16_f32 v101, v238, v239
    v_mul_f32 v250, v142, v174
    v_mul_f32 v251, v143, v175
    v_fma_f32 v244, v244, v15, v15
    v_fma_f32 v245, v245, v15, v15
    v_fma_f32 v246, v246, v15, v15
    v_fma_f32 v247, v247, v15, v15
    v_rcp_f32 v244, v244
    v_rcp_f32 v245, v245
    v_rcp_f32 v246, v246
    v_rcp_f32 v247, v247
    v_mul_f32 v232, v14, v144
    v_mul_f32 v233, v14, v145
    v_mul_f32 v234, v14, v146
    v_mul_f32 v235, v14, v147
    v_exp_f32 v232, v232
    v_lshlrev_b32 v2, 4, v1
    s_lshl_b32 s4, s10, 6
    s_lshl_b32 s5, s36, 4
    s_add_u32 s5, s5, s4
    s_lshl_b32 s5, s5, 12
    s_add_u32 s5, s5, 2097152
    s_add_u32 s52, s34, s5
    s_addc_u32 s53, s35, 0
    s_lshl_b32 s69, s11, 2
    s_add_u32 s69, s69, s4
    s_lshl_b32 s69, s69, 11
    s_waitcnt vmcnt(1)
    v_cmp_ne_u32 vcc, s39, v4
    s_nop 0
    s_cbranch_vccz ready_5
    s_waitcnt vmcnt(0)
    v_cmp_ne_u32 vcc, s39, v253
    s_nop 0
    s_cbranch_vccz ready_5
    s_mov_b32 s4, 0
poll_6:
    global_load_dword v4, v3, s[34:35] sc1
    s_waitcnt vmcnt(0)
    v_cmp_ne_u32 vcc, s39, v4
    s_add_u32 s4, s4, 1
    s_cbranch_vccz polldone_7
    s_cmp_lt_u32 s4, 40000
    s_cbranch_scc0 polldone_7
    s_branch poll_6
polldone_7:
ready_5:
    global_load_dwordx4 a[192:195], v2, s[52:53] offset:0 sc1
    s_mov_b32 s60, 3
    s_mov_b32 s40, s28
    s_and_b32 s41, s29, 0xffff
    s_mul_i32 s42, s14, 1605632
    global_load_dwordx4 a[196:199], v2, s[52:53] offset:1024 sc1
    s_mov_b32 s43, 0x20000
    s_mov_b32 s44, s20
    s_and_b32 s45, s21, 0xffff
    s_mov_b32 s46, 401408
    s_mov_b32 s47, 0x20000
    global_load_dwordx4 a[200:203], v2, s[52:53] offset:2048 sc1
    s_add_u32 s48, s34, 8388608
    s_addc_u32 s49, s35, 0
    s_and_b32 s49, s49, 0xffff
    s_mul_i32 s50, s14, 7340032
    s_mov_b32 s51, 0x20000
    global_load_dwordx4 a[204:207], v2, s[52:53] offset:3072 sc1
    s_mul_i32 s61, s36, 40960
    s_add_u32 s62, s61, 16384
    s_lshl_b32 s4, s13, 7
    s_mul_i32 s5, s36, 401408
    s_add_u32 s63, s4, s5
    s_xor_b32 s3, s36, 0
    s_lshl_b32 s3, s3, 11
    s_add_u32 s3, s3, s69
    s_add_u32 s98, s34, s3
    s_addc_u32 s99, s35, 0
    global_load_dwordx4 a[160:163], v2, s[98:99] offset:0 sc1
    s_mov_b32 s97, s63
    s_mul_i32 s5, s36, 100352
    s_add_u32 s67, s4, s5
    s_and_b32 s4, s36, 1
    s_xor_b32 s4, s4, 0
    global_load_dwordx4 a[164:167], v2, s[98:99] offset:1024 sc1
    s_lshl_b32 s5, s12, 1
    s_add_u32 s4, s4, s5
    s_mul_i32 s5, s4, 114688
    s_mul_i32 s6, s36, 28672
    s_xor_b32 s3, s36, 1
    s_lshl_b32 s3, s3, 11
    s_add_u32 s3, s3, s69
    s_add_u32 s98, s34, s3
    s_addc_u32 s99, s35, 0
    global_load_dwordx4 a[168:171], v2, s[98:99] offset:0 sc1
    s_add_u32 s5, s5, s6
    s_add_u32 s5, s5, 8388608
    s_add_u32 s64, s34, s5
    s_addc_u32 s65, s35, 0
    s_lshl_b32 s5, s4, 15
    s_lshl_b32 s6, s36, 13
    global_load_dwordx4 a[172:175], v2, s[98:99] offset:1024 sc1
    s_add_u32 s5, s5, s6
    s_add_u32 s58, s5, 6291456
    s_and_b32 s4, s36, 1
    s_xor_b32 s4, s4, 1
    s_lshl_b32 s5, s12, 1
    s_xor_b32 s3, s36, 2
    s_lshl_b32 s3, s3, 11
    s_add_u32 s3, s3, s69
    s_add_u32 s98, s34, s3
    s_addc_u32 s99, s35, 0
    global_load_dwordx4 a[176:179], v2, s[98:99] offset:0 sc1
    s_add_u32 s4, s4, s5
    s_mul_i32 s5, s4, 114688
    s_mul_i32 s6, s36, 28672
    s_add_u32 s5, s5, s6
    global_load_dwordx4 a[180:183], v2, s[98:99] offset:1024 sc1
    s_add_u32 s5, s5, 8388608
    s_add_u32 s100, s34, s5
    s_addc_u32 s101, s35, 0
    s_lshl_b32 s5, s4, 15
    s_lshl_b32 s6, s36, 13
    s_add_u32 s5, s5, s6
    s_xor_b32 s3, s36, 3
    s_lshl_b32 s3, s3, 11
    s_add_u32 s3, s3, s69
    s_add_u32 s98, s34, s3
    s_addc_u32 s99, s35, 0
    global_load_dwordx4 a[184:187], v2, s[98:99] offset:0 sc1
    s_add_u32 s59, s5, 6291456
    v_lshrrev_b32 v16, 3, v1
    v_and_b32 v17, 7, v1
    v_bfe_u32 v18, v1, 4, 1
    v_lshlrev_b32 v18, 2, v18
    global_load_dwordx4 a[188:191], v2, s[98:99] offset:1024 sc1
    v_xor_b32 v18, v17, v18
    v_mul_u32_u24 v19, 896, v16
    v_lshl_add_u32 v5, v18, 4, v19
    v_lshrrev_b32 v16, 5, v1
    s_add_u32 s54, s52, 4096
    s_addc_u32 s55, s53, 0
    global_load_dwordx4 a[208:211], v2, s[54:55] offset:0 sc1
    v_bfe_u32 v17, v1, 2, 2
    v_lshl_add_u32 v18, v16, 2, v17
    v_lshlrev_b32 v18, 7, v18
    v_add_u32 v18, s61, v18
    v_bfe_u32 v19, v1, 4, 1
    global_load_dwordx4 a[212:215], v2, s[54:55] offset:1024 sc1
    v_and_b32 v20, 3, v1
    v_lshlrev_b32 v19, 5, v19
    v_lshl_add_u32 v19, v20, 3, v19
    v_lshrrev_b32 v20, 1, v17
    v_lshlrev_b32 v20, 6, v20
    global_load_dwordx4 a[216:219], v2, s[54:55] offset:2048 sc1
    s_lshr_b32 s4, s36, 1
    s_lshl_b32 s4, s4, 6
    s_xor_b32 s5, s4, 0
    v_add_u32 v21, s5, v19
    global_load_dwordx4 a[220:223], v2, s[54:55] offset:3072 sc1
    v_xor_b32 v21, v21, v20
    v_add_u32 v8, v21, v18
    s_xor_b32 s5, s4, 64
    v_add_u32 v21, s5, v19
    v_xor_b32 v21, v21, v20
    s_add_u32 s54, s52, 8192
    s_addc_u32 s55, s53, 0
    global_load_dwordx4 a[224:227], v2, s[54:55] offset:0 sc1
    v_add_u32 v9, v21, v18
    v_add_u32 v10, s61, v2
    s_xor_b32 s4, s36, 1
    s_mul_i32 s4, s4, 40960
    v_add_u32 v11, s4, v2
    global_load_dwordx4 a[228:231], v2, s[54:55] offset:1024 sc1
    s_xor_b32 s4, s36, 2
    s_mul_i32 s4, s4, 40960
    v_add_u32 v12, s4, v2
    s_xor_b32 s4, s36, 3
    global_load_dwordx4 a[232:235], v2, s[54:55] offset:2048 sc1
    s_mul_i32 s4, s4, 40960
    v_add_u32 v13, s4, v2
    v_bfe_u32 v16, v1, 4, 1
    s_lshl_b32 s4, s12, 1
    v_add_u32 v16, s4, v16
    global_load_dwordx4 a[236:239], v2, s[54:55] offset:3072 sc1
    v_lshlrev_b32 v16, 4, v16
    v_and_b32 v17, 15, v1
    v_add_u32 v16, v16, v17
    v_lshlrev_b32 v16, 7, v16
    v_add_u32 v3, 17104896, v16
    s_nop 3
    v_exp_f32 v233, v233
    v_exp_f32 v234, v234
    v_exp_f32 v235, v235
    v_mul_f32 v236, v144, v176
    v_mul_f32 v237, v145, v177
    v_mul_f32 v248, v248, v244
    v_mul_f32 v249, v249, v245
    v_mul_f32 v250, v250, v246
    v_mul_f32 v251, v251, v247
    v_cvt_pk_bf16_f32 v102, v248, v249
    v_cvt_pk_bf16_f32 v103, v250, v251
    v_mul_f32 v238, v146, v178
    v_mul_f32 v239, v147, v179
    v_fma_f32 v232, v232, v15, v15
    v_fma_f32 v233, v233, v15, v15
    v_fma_f32 v234, v234, v15, v15
    v_fma_f32 v235, v235, v15, v15
    v_rcp_f32 v232, v232
    v_rcp_f32 v233, v233
    v_rcp_f32 v234, v234
    v_rcp_f32 v235, v235
    v_mul_f32 v244, v14, v148
    v_mul_f32 v245, v14, v149
    v_mul_f32 v246, v14, v150
    v_mul_f32 v247, v14, v151
    v_exp_f32 v244, v244
    v_exp_f32 v245, v245
    v_exp_f32 v246, v246
    v_exp_f32 v247, v247
    v_mul_f32 v248, v148, v180
    v_mul_f32 v249, v149, v181
    v_mul_f32 v236, v236, v232
    v_mul_f32 v237, v237, v233
    v_mul_f32 v238, v238, v234
    v_mul_f32 v239, v239, v235
    v_cvt_pk_bf16_f32 v104, v236, v237
    v_cvt_pk_bf16_f32 v105, v238, v239
    v_mul_f32 v250, v150, v182
    v_mul_f32 v251, v151, v183
    v_fma_f32 v244, v244, v15, v15
    v_fma_f32 v245, v245, v15, v15
    v_fma_f32 v246, v246, v15, v15
    v_fma_f32 v247, v247, v15, v15
    v_rcp_f32 v244, v244
    v_rcp_f32 v245, v245
    v_rcp_f32 v246, v246
    v_rcp_f32 v247, v247
    v_mul_f32 v232, v14, v152
    v_mul_f32 v233, v14, v153
    v_mul_f32 v234, v14, v154
    v_mul_f32 v235, v14, v155
    v_exp_f32 v232, v232
    v_exp_f32 v233, v233
    v_exp_f32 v234, v234
    v_exp_f32 v235, v235
    v_mul_f32 v236, v152, v184
    v_mul_f32 v237, v153, v185
    v_mul_f32 v248, v248, v244
    v_mul_f32 v249, v249, v245
    v_mul_f32 v250, v250, v246
    v_mul_f32 v251, v251, v247
    v_cvt_pk_bf16_f32 v106, v248, v249
    v_cvt_pk_bf16_f32 v107, v250, v251
    v_mul_f32 v238, v154, v186
    v_mul_f32 v239, v155, v187
    v_fma_f32 v232, v232, v15, v15
    v_fma_f32 v233, v233, v15, v15
    v_fma_f32 v234, v234, v15, v15
    v_fma_f32 v235, v235, v15, v15
    v_rcp_f32 v232, v232
    v_rcp_f32 v233, v233
    v_rcp_f32 v234, v234
    v_rcp_f32 v235, v235
    v_mul_f32 v244, v14, v156
    v_mul_f32 v245, v14, v157
    v_mul_f32 v246, v14, v158
    v_mul_f32 v247, v14, v159
    v_exp_f32 v244, v244
    v_exp_f32 v245, v245
    v_exp_f32 v246, v246
    v_exp_f32 v247, v247
    v_mul_f32 v248, v156, v188
    v_mul_f32 v249, v157, v189
    v_mul_f32 v236, v236, v232
    v_mul_f32 v237, v237, v233
    v_mul_f32 v238, v238, v234
    v_mul_f32 v239, v239, v235
    v_cvt_pk_bf16_f32 v108, v236, v237
    v_cvt_pk_bf16_f32 v109, v238, v239
    v_mul_f32 v250, v158, v190
    v_mul_f32 v251, v159, v191
    v_fma_f32 v244, v244, v15, v15
    v_fma_f32 v245, v245, v15, v15
    v_fma_f32 v246, v246, v15, v15
    v_fma_f32 v247, v247, v15, v15
    v_rcp_f32 v244, v244
    v_rcp_f32 v245, v245
    v_rcp_f32 v246, v246
    v_rcp_f32 v247, v247
    s_nop 0
    v_mul_f32 v248, v248, v244
    v_mul_f32 v249, v249, v245
    v_mul_f32 v250, v250, v246
    v_mul_f32 v251, v251, v247
    v_cvt_pk_bf16_f32 v110, v248, v249
    v_cvt_pk_bf16_f32 v111, v250, v251
    global_store_dwordx4 v202, v[96:99], s[34:35] offset:0 sc1
    global_store_dwordx4 v202, v[100:103], s[34:35] offset:1024 sc1
    global_store_dwordx4 v202, v[104:107], s[34:35] offset:2048 sc1
    global_store_dwordx4 v202, v[108:111], s[34:35] offset:3072 sc1
    v_mov_b32 v14, v203
    s_waitcnt vmcnt(12)
    v_mfma_f32_32x32x16_bf16 v[16:31], a[192:195], a[160:163], 0
    v_mfma_f32_32x32x16_bf16 v[16:31], a[196:199], a[164:167], v[16:31]
    s_nop 7
    s_nop 4
    s_branch attn_entry
path_b:
    v_mfma_f32_32x32x16_bf16 v[220:235], a[32:35], v[160:163], v[144:159]
    v_mfma_f32_32x32x16_bf16 v[220:235], a[36:39], v[164:167], v[220:235]
    s_sub_u32 s98, s63, s53
    s_add_u32 s98, s98, 0
    buffer_load_dword v255, v2, s[44:47], s98 offen
    s_nop 7
    s_nop 3
    v_mfma_f32_32x32x16_bf16 v[236:251], a[40:43], v[160:163], v[144:159]
    v_mfma_f32_32x32x16_bf16 v[236:251], a[44:47], v[164:167], v[236:251]
    s_sub_u32 s98, s63, s53
    s_add_u32 s98, s98, 602112
    buffer_load_dword v255, v2, s[44:47], s98 offen
    v_cvt_pk_bf16_f32 v16, v220, v221
    v_cvt_pk_bf16_f32 v17, v222, v223
    v_cvt_pk_bf16_f32 v18, v224, v225
    v_cvt_pk_bf16_f32 v19, v226, v227
    v_cvt_pk_bf16_f32 v20, v228, v229
    v_cvt_pk_bf16_f32 v21, v230, v231
    v_cvt_pk_bf16_f32 v22, v232, v233
    v_cvt_pk_bf16_f32 v23, v234, v235
    s_nop 3
    v_mfma_f32_32x32x16_bf16 v[220:235], a[48:51], v[160:163], v[144:159]
    v_mfma_f32_32x32x16_bf16 v[220:235], a[52:55], v[164:167], v[220:235]
    s_sub_u32 s98, s64, s53
    s_add_u32 s98, s98, 0
    buffer_load_dword v255, v2, s[44:47], s98 offen
    v_cvt_pk_bf16_f32 v24, v236, v237
    v_cvt_pk_bf16_f32 v25, v238, v239
    v_cvt_pk_bf16_f32 v26, v240, v241
    v_cvt_pk_bf16_f32 v27, v242, v243
    v_cvt_pk_bf16_f32 v28, v244, v245
    v_cvt_pk_bf16_f32 v29, v246, v247
    v_cvt_pk_bf16_f32 v30, v248, v249
    v_cvt_pk_bf16_f32 v31, v250, v251
    s_nop 3
    v_mfma_f32_32x32x16_bf16 v[236:251], a[56:59], v[160:163], v[144:159]
    v_mfma_f32_32x32x16_bf16 v[236:251], a[60:63], v[164:167], v[236:251]
    v_cvt_pk_bf16_f32 v32, v220, v221
    v_cvt_pk_bf16_f32 v33, v222, v223
    v_cvt_pk_bf16_f32 v34, v224, v225
    v_cvt_pk_bf16_f32 v35, v226, v227
    v_cvt_pk_bf16_f32 v36, v228, v229
    v_cvt_pk_bf16_f32 v37, v230, v231
    v_cvt_pk_bf16_f32 v38, v232, v233
    v_cvt_pk_bf16_f32 v39, v234, v235
    s_nop 3
    v_mfma_f32_32x32x16_bf16 v[220:235], a[64:67], v[160:163], v[144:159]
    v_mfma_f32_32x32x16_bf16 v[220:235], a[68:71], v[164:167], v[220:235]
    s_add_u32 m0, s52, 28672
    s_add_u32 s55, s62, 602112
    buffer_load_dwordx4 v8, s[44:47], s55 offen lds
    v_cvt_pk_bf16_f32 v40, v236, v237
    v_cvt_pk_bf16_f32 v41, v238, v239
    v_cvt_pk_bf16_f32 v42, v240, v241
    v_cvt_pk_bf16_f32 v43, v242, v243
    v_cvt_pk_bf16_f32 v44, v244, v245
    v_cvt_pk_bf16_f32 v45, v246, v247
    v_cvt_pk_bf16_f32 v46, v248, v249
    v_cvt_pk_bf16_f32 v47, v250, v251
    s_nop 3
    v_mfma_f32_32x32x16_bf16 v[236:251], a[72:75], v[160:163], v[144:159]
    v_mfma_f32_32x32x16_bf16 v[236:251], a[76:79], v[164:167], v[236:251]
    s_add_u32 m0, s52, 29696
    s_add_u32 s55, s62, 623616
    buffer_load_dwordx4 v8, s[44:47], s55 offen lds
    v_cvt_pk_bf16_f32 v48, v220, v221
    v_cvt_pk_bf16_f32 v49, v222, v223
    v_cvt_pk_bf16_f32 v50, v224, v225
    v_cvt_pk_bf16_f32 v51, v226, v227
    v_cvt_pk_bf16_f32 v52, v228, v229
    v_cvt_pk_bf16_f32 v53, v230, v231
    v_cvt_pk_bf16_f32 v54, v232, v233
    v_cvt_pk_bf16_f32 v55, v234, v235
    s_nop 3
    v_mfma_f32_32x32x16_bf16 v[220:235], a[80:83], v[160:163], v[144:159]
    v_mfma_f32_32x32x16_bf16 v[220:235], a[84:87], v[164:167], v[220:235]
    v_cvt_pk_bf16_f32 v56, v236, v237
    v_cvt_pk_bf16_f32 v57, v238, v239
    v_cvt_pk_bf16_f32 v58, v240, v241
    v_cvt_pk_bf16_f32 v59, v242, v243
    v_cvt_pk_bf16_f32 v60, v244, v245
    v_cvt_pk_bf16_f32 v61, v246, v247
    v_cvt_pk_bf16_f32 v62, v248, v249
    v_cvt_pk_bf16_f32 v63, v250, v251
    s_nop 3
    v_mfma_f32_32x32x16_bf16 v[236:251], a[88:91], v[160:163], v[144:159]
    v_mfma_f32_32x32x16_bf16 v[236:251], a[92:95], v[164:167], v[236:251]
    s_add_u32 m0, s52, 30720
    s_add_u32 s55, s62, 645120
    buffer_load_dwordx4 v8, s[44:47], s55 offen lds
    v_cvt_pk_bf16_f32 v64, v220, v221
    v_cvt_pk_bf16_f32 v65, v222, v223
    v_cvt_pk_bf16_f32 v66, v224, v225
    v_cvt_pk_bf16_f32 v67, v226, v227
    v_cvt_pk_bf16_f32 v68, v228, v229
    v_cvt_pk_bf16_f32 v69, v230, v231
    v_cvt_pk_bf16_f32 v70, v232, v233
    v_cvt_pk_bf16_f32 v71, v234, v235
    s_nop 3
    v_mfma_f32_32x32x16_bf16 v[220:235], a[96:99], v[160:163], v[144:159]
    v_mfma_f32_32x32x16_bf16 v[220:235], a[100:103], v[164:167], v[220:235]
    s_add_u32 m0, s52, 31744
    s_add_u32 s55, s62, 666624
    buffer_load_dwordx4 v8, s[44:47], s55 offen lds
    v_cvt_pk_bf16_f32 v72, v236, v237
    v_cvt_pk_bf16_f32 v73, v238, v239
    v_cvt_pk_bf16_f32 v74, v240, v241
    v_cvt_pk_bf16_f32 v75, v242, v243
    v_cvt_pk_bf16_f32 v76, v244, v245
    v_cvt_pk_bf16_f32 v77, v246, v247
    v_cvt_pk_bf16_f32 v78, v248, v249
    v_cvt_pk_bf16_f32 v79, v250, v251
    s_nop 3
    v_mfma_f32_32x32x16_bf16 v[236:251], a[104:107], v[160:163], v[144:159]
    v_mfma_f32_32x32x16_bf16 v[236:251], a[108:111], v[164:167], v[236:251]
    s_add_u32 m0, s52, 32768
    s_add_u32 s55, s62, 688128
    buffer_load_dwordx4 v8, s[44:47], s55 offen lds
    v_cvt_pk_bf16_f32 v80, v220, v221
    v_cvt_pk_bf16_f32 v81, v222, v223
    v_cvt_pk_bf16_f32 v82, v224, v225
    v_cvt_pk_bf16_f32 v83, v226, v227
    v_cvt_pk_bf16_f32 v84, v228, v229
    v_cvt_pk_bf16_f32 v85, v230, v231
    v_cvt_pk_bf16_f32 v86, v232, v233
    v_cvt_pk_bf16_f32 v87, v234, v235
    s_nop 3
    v_mfma_f32_32x32x16_bf16 v[220:235], a[112:115], v[160:163], v[144:159]
    v_mfma_f32_32x32x16_bf16 v[220:235], a[116:119], v[164:167], v[220:235]
    v_cvt_pk_bf16_f32 v88, v236, v237
    v_cvt_pk_bf16_f32 v89, v238, v239
    v_cvt_pk_bf16_f32 v90, v240, v241
    v_cvt_pk_bf16_f32 v91, v242, v243
    v_cvt_pk_bf16_f32 v92, v244, v245
    v_cvt_pk_bf16_f32 v93, v246, v247
    v_cvt_pk_bf16_f32 v94, v248, v249
    v_cvt_pk_bf16_f32 v95, v250, v251
    s_nop 3
    v_mfma_f32_32x32x16_bf16 v[236:251], a[120:123], v[160:163], v[144:159]
    v_mfma_f32_32x32x16_bf16 v[236:251], a[124:127], v[164:167], v[236:251]
    s_add_u32 m0, s52, 33792
    s_add_u32 s55, s62, 709632
    buffer_load_dwordx4 v8, s[44:47], s55 offen lds
    v_cvt_pk_bf16_f32 v96, v220, v221
    v_cvt_pk_bf16_f32 v97, v222, v223
    v_cvt_pk_bf16_f32 v98, v224, v225
    v_cvt_pk_bf16_f32 v99, v226, v227
    v_cvt_pk_bf16_f32 v100, v228, v229
    v_cvt_pk_bf16_f32 v101, v230, v231
    v_cvt_pk_bf16_f32 v102, v232, v233
    v_cvt_pk_bf16_f32 v103, v234, v235
    s_nop 3
    v_mfma_f32_32x32x16_bf16 v[220:235], a[128:131], v[160:163], v[144:159]
    v_mfma_f32_32x32x16_bf16 v[220:235], a[132:135], v[164:167], v[220:235]
    s_add_u32 m0, s52, 34816
    s_add_u32 s55, s62, 731136
    buffer_load_dwordx4 v8, s[44:47], s55 offen lds
    v_cvt_pk_bf16_f32 v104, v236, v237
    v_cvt_pk_bf16_f32 v105, v238, v239
    v_cvt_pk_bf16_f32 v106, v240, v241
    v_cvt_pk_bf16_f32 v107, v242, v243
    v_cvt_pk_bf16_f32 v108, v244, v245
    v_cvt_pk_bf16_f32 v109, v246, v247
    v_cvt_pk_bf16_f32 v110, v248, v249
    v_cvt_pk_bf16_f32 v111, v250, v251
    s_nop 3
    v_mfma_f32_32x32x16_bf16 v[236:251], a[136:139], v[160:163], v[144:159]
    v_mfma_f32_32x32x16_bf16 v[236:251], a[140:143], v[164:167], v[236:251]
    v_cvt_pk_bf16_f32 v112, v220, v221
    v_cvt_pk_bf16_f32 v113, v222, v223
    v_cvt_pk_bf16_f32 v114, v224, v225
    v_cvt_pk_bf16_f32 v115, v226, v227
    v_cvt_pk_bf16_f32 v116, v228, v229
    v_cvt_pk_bf16_f32 v117, v230, v231
    v_cvt_pk_bf16_f32 v118, v232, v233
    v_cvt_pk_bf16_f32 v119, v234, v235
    s_nop 3
    s_nop 7
    v_cvt_pk_bf16_f32 v120, v236, v237
    v_cvt_pk_bf16_f32 v121, v238, v239
    v_cvt_pk_bf16_f32 v122, v240, v241
    v_cvt_pk_bf16_f32 v123, v242, v243
    v_cvt_pk_bf16_f32 v124, v244, v245
    v_cvt_pk_bf16_f32 v125, v246, v247
    v_cvt_pk_bf16_f32 v126, v248, v249
    v_cvt_pk_bf16_f32 v127, v250, v251
    v_and_b32 v236, 31, v1
    v_lshlrev_b32 v236, 2, v236
    s_lshl_b32 s4, s36, 7
    s_add_u32 s4, s4, 143360
    v_add_u32 v236, s4, v236
    ds_write_b32 v236, v128
    s_waitcnt lgkmcnt(0)
    v_lshrrev_b32 v237, 5, v1
    v_lshlrev_b32 v237, 4, v237
    v_add_u32 v237, s4, v237
    ds_read_b128 v[204:207], v237 offset:0
    ds_read_b128 v[208:211], v237 offset:32
    ds_read_b128 v[212:215], v237 offset:64
    ds_read_b128 v[216:219], v237 offset:96
    s_waitcnt lgkmcnt(0)
    v_mov_b32 v252, 0
    global_load_dword v203, v252, s[32:33] sc1
    v_add_u32 v192, 0, v10
    v_add_u32 v193, 0, v11
    s_nop 0
    s_waitcnt vmcnt(11)
    s_barrier
    ds_read_b64_tr_b16 a[0:1], v192 offset:0
    ds_read_b64_tr_b16 a[2:3], v192 offset:1024
    ds_read_b64_tr_b16 a[4:5], v193 offset:0
    ds_read_b64_tr_b16 a[6:7], v193 offset:1024
    ds_read_b64_tr_b16 a[8:9], v192 offset:2048
    ds_read_b64_tr_b16 a[10:11], v192 offset:3072
    ds_read_b64_tr_b16 a[12:13], v193 offset:2048
    ds_read_b64_tr_b16 a[14:15], v193 offset:3072
.p2align 6
    s_waitcnt lgkmcnt(6)
    v_mfma_f32_32x32x16_bf16 a[32:47], a[0:3], v[16:19], 0
    ds_read_b64_tr_b16 a[16:17], v192 offset:4096
    ds_read_b64_tr_b16 a[18:19], v192 offset:5120
    s_add_u32 m0, s52, 57344
    s_add_u32 s55, s63, 0
    buffer_load_dwordx4 v8, s[44:47], s55 offen lds
    s_waitcnt lgkmcnt(6)
    v_mfma_f32_32x32x16_bf16 a[48:63], a[4:7], v[16:19], 0
    ds_read_b64_tr_b16 a[20:21], v193 offset:4096
    ds_read_b64_tr_b16 a[22:23], v193 offset:5120
    s_waitcnt lgkmcnt(6)
    v_mfma_f32_32x32x16_bf16 a[32:47], a[8:11], v[20:23], a[32:47]
    ds_read_b64_tr_b16 a[24:25], v192 offset:6144
    ds_read_b64_tr_b16 a[26:27], v192 offset:7168
    s_add_u32 m0, s52, 58368
    s_add_u32 s55, s63, 21504
    buffer_load_dwordx4 v8, s[44:47], s55 offen lds
    s_waitcnt lgkmcnt(6)
    v_mfma_f32_32x32x16_bf16 a[48:63], a[12:15], v[20:23], a[48:63]
    ds_read_b64_tr_b16 a[28:29], v193 offset:6144
    ds_read_b64_tr_b16 a[30:31], v193 offset:7168
    s_waitcnt lgkmcnt(6)
    v_mfma_f32_32x32x16_bf16 a[32:47], a[16:19], v[24:27], a[32:47]
    ds_read_b64_tr_b16 a[0:1], v192 offset:8192
    ds_read_b64_tr_b16 a[2:3], v192 offset:9216
    s_add_u32 m0, s52, 59392
    s_add_u32 s55, s63, 43008
    buffer_load_dwordx4 v8, s[44:47], s55 offen lds
    s_waitcnt lgkmcnt(6)
    v_mfma_f32_32x32x16_bf16 a[48:63], a[20:23], v[24:27], a[48:63]
    ds_read_b64_tr_b16 a[4:5], v193 offset:8192
    ds_read_b64_tr_b16 a[6:7], v193 offset:9216
    s_waitcnt lgkmcnt(6)
    v_mfma_f32_32x32x16_bf16 a[32:47], a[24:27], v[28:31], a[32:47]
    ds_read_b64_tr_b16 a[8:9], v192 offset:10240
    ds_read_b64_tr_b16 a[10:11], v192 offset:11264
    s_add_u32 m0, s52, 60416
    s_add_u32 s55, s63, 64512
    buffer_load_dwordx4 v8, s[44:47], s55 offen lds
    s_waitcnt lgkmcnt(6)
    v_mfma_f32_32x32x16_bf16 a[48:63], a[28:31], v[28:31], a[48:63]
    ds_read_b64_tr_b16 a[12:13], v193 offset:10240
    ds_read_b64_tr_b16 a[14:15], v193 offset:11264
    s_waitcnt lgkmcnt(6)
    v_mfma_f32_32x32x16_bf16 a[32:47], a[0:3], v[32:35], a[32:47]
    ds_read_b64_tr_b16 a[16:17], v192 offset:12288
    ds_read_b64_tr_b16 a[18:19], v192 offset:13312
    s_add_u32 m0, s52, 61440
    s_add_u32 s55, s63, 86016
    buffer_load_dwordx4 v8, s[44:47], s55 offen lds
    s_waitcnt lgkmcnt(6)
    v_mfma_f32_32x32x16_bf16 a[48:63], a[4:7], v[32:35], a[48:63]
    ds_read_b64_tr_b16 a[20:21], v193 offset:12288
    ds_read_b64_tr_b16 a[22:23], v193 offset:13312
    s_waitcnt lgkmcnt(6)
    v_mfma_f32_32x32x16_bf16 a[32:47], a[8:11], v[36:39], a[32:47]
    ds_read_b64_tr_b16 a[24:25], v192 offset:14336
    ds_read_b64_tr_b16 a[26:27], v192 offset:15360
    s_add_u32 m0, s52, 62464
    s_add_u32 s55, s63, 107520
    buffer_load_dwordx4 v8, s[44:47], s55 offen lds
    s_waitcnt lgkmcnt(6)
    v_mfma_f32_32x32x16_bf16 a[48:63], a[12:15], v[36:39], a[48:63]
    ds_read_b64_tr_b16 a[28:29], v193 offset:14336
    ds_read_b64_tr_b16 a[30:31], v193 offset:15360
    s_waitcnt lgkmcnt(6)
    v_mfma_f32_32x32x16_bf16 a[32:47], a[16:19], v[40:43], a[32:47]
    ds_read_b64_tr_b16 a[0:1], v192 offset:16384
    ds_read_b64_tr_b16 a[2:3], v192 offset:17408
    s_add_u32 m0, s52, 63488
    s_add_u32 s55, s63, 129024
    buffer_load_dwordx4 v8, s[44:47], s55 offen lds
    s_waitcnt lgkmcnt(6)
    v_mfma_f32_32x32x16_bf16 a[48:63], a[20:23], v[40:43], a[48:63]
    ds_read_b64_tr_b16 a[4:5], v193 offset:16384
    ds_read_b64_tr_b16 a[6:7], v193 offset:17408
    s_waitcnt lgkmcnt(6)
    v_mfma_f32_32x32x16_bf16 a[32:47], a[24:27], v[44:47], a[32:47]
    ds_read_b64_tr_b16 a[8:9], v192 offset:18432
    ds_read_b64_tr_b16 a[10:11], v192 offset:19456
    s_add_u32 m0, s52, 86016
    s_add_u32 s55, s63, 602112
    buffer_load_dwordx4 v8, s[44:47], s55 offen lds
    s_waitcnt lgkmcnt(6)
    v_mfma_f32_32x32x16_bf16 a[48:63], a[28:31], v[44:47], a[48:63]
    ds_read_b64_tr_b16 a[12:13], v193 offset:18432
    ds_read_b64_tr_b16 a[14:15], v193 offset:19456
    s_waitcnt lgkmcnt(6)
    v_mfma_f32_32x32x16_bf16 a[32:47], a[0:3], v[48:51], a[32:47]
    ds_read_b64_tr_b16 a[16:17], v192 offset:20480
    ds_read_b64_tr_b16 a[18:19], v192 offset:21504
    s_add_u32 m0, s52, 87040
    s_add_u32 s55, s63, 623616
    buffer_load_dwordx4 v8, s[44:47], s55 offen lds
    s_waitcnt lgkmcnt(6)
    v_mfma_f32_32x32x16_bf16 a[48:63], a[4:7], v[48:51], a[48:63]
    ds_read_b64_tr_b16 a[20:21], v193 offset:20480
    ds_read_b64_tr_b16 a[22:23], v193 offset:21504
    s_waitcnt lgkmcnt(6)
    v_mfma_f32_32x32x16_bf16 a[32:47], a[8:11], v[52:55], a[32:47]
    ds_read_b64_tr_b16 a[24:25], v192 offset:22528
    ds_read_b64_tr_b16 a[26:27], v192 offset:23552
    s_add_u32 m0, s52, 88064
    s_add_u32 s55, s63, 645120
    buffer_load_dwordx4 v8, s[44:47], s55 offen lds
    s_waitcnt lgkmcnt(6)
    v_mfma_f32_32x32x16_bf16 a[48:63], a[12:15], v[52:55], a[48:63]
    ds_read_b64_tr_b16 a[28:29], v193 offset:22528
    ds_read_b64_tr_b16 a[30:31], v193 offset:23552
    s_waitcnt lgkmcnt(6)
    v_mfma_f32_32x32x16_bf16 a[32:47], a[16:19], v[56:59], a[32:47]
    ds_read_b64_tr_b16 a[0:1], v192 offset:24576
    ds_read_b64_tr_b16 a[2:3], v192 offset:25600
    s_add_u32 m0, s52, 89088
    s_add_u32 s55, s63, 666624
    buffer_load_dwordx4 v8, s[44:47], s55 offen lds
    s_waitcnt lgkmcnt(6)
    v_mfma_f32_32x32x16_bf16 a[48:63], a[20:23], v[56:59], a[48:63]
    ds_read_b64_tr_b16 a[4:5], v193 offset:24576
    ds_read_b64_tr_b16 a[6:7], v193 offset:25600
    s_waitcnt lgkmcnt(6)
    v_mfma_f32_32x32x16_bf16 a[32:47], a[24:27], v[60:63], a[32:47]
    ds_read_b64_tr_b16 a[8:9], v192 offset:26624
    ds_read_b64_tr_b16 a[10:11], v192 offset:27648
    s_add_u32 m0, s52, 90112
    s_add_u32 s55, s63, 688128
    buffer_load_dwordx4 v8, s[44:47], s55 offen lds
    s_waitcnt lgkmcnt(6)
    v_mfma_f32_32x32x16_bf16 a[48:63], a[28:31], v[60:63], a[48:63]
    ds_read_b64_tr_b16 a[12:13], v193 offset:26624
    ds_read_b64_tr_b16 a[14:15], v193 offset:27648
    s_waitcnt lgkmcnt(6)
    v_mfma_f32_32x32x16_bf16 a[32:47], a[0:3], v[64:67], a[32:47]
    v_add_u32 v194, 28672, v10
    v_add_u32 v195, 28672, v11
    s_waitcnt vmcnt(13)
    s_barrier
    ds_read_b64_tr_b16 a[16:17], v194 offset:0
    ds_read_b64_tr_b16 a[18:19], v194 offset:1024
    s_add_u32 m0, s52, 91136
    s_add_u32 s55, s63, 709632
    buffer_load_dwordx4 v8, s[44:47], s55 offen lds
    s_waitcnt lgkmcnt(6)
    v_mfma_f32_32x32x16_bf16 a[48:63], a[4:7], v[64:67], a[48:63]
    ds_read_b64_tr_b16 a[20:21], v195 offset:0
    ds_read_b64_tr_b16 a[22:23], v195 offset:1024
    s_waitcnt lgkmcnt(6)
    v_mfma_f32_32x32x16_bf16 a[32:47], a[8:11], v[68:71], a[32:47]
    ds_read_b64_tr_b16 a[24:25], v194 offset:2048
    ds_read_b64_tr_b16 a[26:27], v194 offset:3072
    s_add_u32 m0, s52, 92160
    s_add_u32 s55, s63, 731136
    buffer_load_dwordx4 v8, s[44:47], s55 offen lds
    s_waitcnt lgkmcnt(6)
    v_mfma_f32_32x32x16_bf16 a[48:63], a[12:15], v[68:71], a[48:63]
    ds_read_b64_tr_b16 a[28:29], v195 offset:2048
    ds_read_b64_tr_b16 a[30:31], v195 offset:3072
    s_waitcnt lgkmcnt(6)
    v_mfma_f32_32x32x16_bf16 a[32:47], a[16:19], v[72:75], a[32:47]
    ds_read_b64_tr_b16 a[0:1], v194 offset:4096
    ds_read_b64_tr_b16 a[2:3], v194 offset:5120
    s_sub_u32 s98, s64, s53
    s_add_u32 s98, s98, 602112
    buffer_load_dword v255, v2, s[44:47], s98 offen
    s_waitcnt lgkmcnt(6)
    v_mfma_f32_32x32x16_bf16 a[48:63], a[20:23], v[72:75], a[48:63]
    ds_read_b64_tr_b16 a[4:5], v195 offset:4096
    ds_read_b64_tr_b16 a[6:7], v195 offset:5120
    s_add_u32 m0, s52, 114688
    s_add_u32 s55, s64, 0
    buffer_load_dwordx4 v8, s[44:47], s55 offen lds
    s_waitcnt lgkmcnt(6)
    v_mfma_f32_32x32x16_bf16 a[32:47], a[24:27], v[76:79], a[32:47]
    ds_read_b64_tr_b16 a[8:9], v194 offset:6144
    ds_read_b64_tr_b16 a[10:11], v194 offset:7168
    s_add_u32 m0, s52, 115712
    s_add_u32 s55, s64, 21504
    buffer_load_dwordx4 v8, s[44:47], s55 offen lds
    s_waitcnt lgkmcnt(6)
    v_mfma_f32_32x32x16_bf16 a[48:63], a[28:31], v[76:79], a[48:63]
    ds_read_b64_tr_b16 a[12:13], v195 offset:6144
    ds_read_b64_tr_b16 a[14:15], v195 offset:7168
    s_waitcnt lgkmcnt(6)
    v_mfma_f32_32x32x16_bf16 a[32:47], a[0:3], v[80:83], a[32:47]
    ds_read_b64_tr_b16 a[16:17], v194 offset:8192
    ds_read_b64_tr_b16 a[18:19], v194 offset:9216
    s_add_u32 m0, s52, 116736
    s_add_u32 s55, s64, 43008
    buffer_load_dwordx4 v8, s[44:47], s55 offen lds
    s_waitcnt lgkmcnt(6)
    v_mfma_f32_32x32x16_bf16 a[48:63], a[4:7], v[80:83], a[48:63]
    ds_read_b64_tr_b16 a[20:21], v195 offset:8192
    ds_read_b64_tr_b16 a[22:23], v195 offset:9216
    s_waitcnt lgkmcnt(6)
    v_mfma_f32_32x32x16_bf16 a[32:47], a[8:11], v[84:87], a[32:47]
    ds_read_b64_tr_b16 a[24:25], v194 offset:10240
    ds_read_b64_tr_b16 a[26:27], v194 offset:11264
    s_add_u32 m0, s52, 117760
    s_add_u32 s55, s64, 64512
    buffer_load_dwordx4 v8, s[44:47], s55 offen lds
    s_waitcnt lgkmcnt(6)
    v_mfma_f32_32x32x16_bf16 a[48:63], a[12:15], v[84:87], a[48:63]
    ds_read_b64_tr_b16 a[28:29], v195 offset:10240
    ds_read_b64_tr_b16 a[30:31], v195 offset:11264
    s_waitcnt lgkmcnt(6)
    v_mfma_f32_32x32x16_bf16 a[32:47], a[16:19], v[88:91], a[32:47]
    ds_read_b64_tr_b16 a[0:1], v194 offset:12288
    ds_read_b64_tr_b16 a[2:3], v194 offset:13312
    s_add_u32 m0, s52, 118784
    s_add_u32 s55, s64, 86016
    buffer_load_dwordx4 v8, s[44:47], s55 offen lds
    s_waitcnt lgkmcnt(6)
    v_mfma_f32_32x32x16_bf16 a[48:63], a[20:23], v[88:91], a[48:63]
    ds_read_b64_tr_b16 a[4:5], v195 offset:12288
    ds_read_b64_tr_b16 a[6:7], v195 offset:13312
    s_waitcnt lgkmcnt(6)
    v_mfma_f32_32x32x16_bf16 a[32:47], a[24:27], v[92:95], a[32:47]
    ds_read_b64_tr_b16 a[8:9], v194 offset:14336
    ds_read_b64_tr_b16 a[10:11], v194 offset:15360
    s_add_u32 m0, s52, 119808
    s_add_u32 s55, s64, 107520
    buffer_load_dwordx4 v8, s[44:47], s55 offen lds
    s_waitcnt lgkmcnt(6)
    v_mfma_f32_32x32x16_bf16 a[48:63], a[28:31], v[92:95], a[48:63]
    ds_read_b64_tr_b16 a[12:13], v195 offset:14336
    ds_read_b64_tr_b16 a[14:15], v195 offset:15360
    s_waitcnt lgkmcnt(6)
    v_mfma_f32_32x32x16_bf16 a[32:47], a[0:3], v[96:99], a[32:47]
    ds_read_b64_tr_b16 a[16:17], v194 offset:16384
    ds_read_b64_tr_b16 a[18:19], v194 offset:17408
    s_add_u32 m0, s52, 120832
    s_add_u32 s55, s64, 129024
    buffer_load_dwordx4 v8, s[44:47], s55 offen lds
    s_waitcnt lgkmcnt(6)
    v_mfma_f32_32x32x16_bf16 a[48:63], a[4:7], v[96:99], a[48:63]
    ds_read_b64_tr_b16 a[20:21], v195 offset:16384
    ds_read_b64_tr_b16 a[22:23], v195 offset:17408
    s_waitcnt lgkmcnt(6)
    v_mfma_f32_32x32x16_bf16 a[32:47], a[8:11], v[100:103], a[32:47]
    ds_read_b64_tr_b16 a[24:25], v194 offset:18432
    ds_read_b64_tr_b16 a[26:27], v194 offset:19456
    s_sub_u32 s98, s66, s54
    s_add_u32 s98, s98, 0
    buffer_load_dword v255, v254, s[48:51], s98 offen
    s_waitcnt lgkmcnt(6)
    v_mfma_f32_32x32x16_bf16 a[48:63], a[12:15], v[100:103], a[48:63]
    ds_read_b64_tr_b16 a[28:29], v195 offset:18432
    ds_read_b64_tr_b16 a[30:31], v195 offset:19456
    s_waitcnt lgkmcnt(6)
    v_mfma_f32_32x32x16_bf16 a[32:47], a[16:19], v[104:107], a[32:47]
    ds_read_b64_tr_b16 a[0:1], v194 offset:20480
    ds_read_b64_tr_b16 a[2:3], v194 offset:21504
    s_waitcnt lgkmcnt(6)
    v_mfma_f32_32x32x16_bf16 a[48:63], a[20:23], v[104:107], a[48:63]
    ds_read_b64_tr_b16 a[4:5], v195 offset:20480
    ds_read_b64_tr_b16 a[6:7], v195 offset:21504
    s_waitcnt lgkmcnt(6)
    v_mfma_f32_32x32x16_bf16 a[32:47], a[24:27], v[108:111], a[32:47]
    ds_read_b64_tr_b16 a[8:9], v194 offset:22528
    ds_read_b64_tr_b16 a[10:11], v194 offset:23552
    s_waitcnt lgkmcnt(6)
    v_mfma_f32_32x32x16_bf16 a[48:63], a[28:31], v[108:111], a[48:63]
    ds_read_b64_tr_b16 a[12:13], v195 offset:22528
    ds_read_b64_tr_b16 a[14:15], v195 offset:23552
    s_waitcnt lgkmcnt(6)
    v_mfma_f32_32x32x16_bf16 a[32:47], a[0:3], v[112:115], a[32:47]
    ds_read_b64_tr_b16 a[16:17], v194 offset:24576
    ds_read_b64_tr_b16 a[18:19], v194 offset:25600
    s_waitcnt lgkmcnt(6)
    v_mfma_f32_32x32x16_bf16 a[48:63], a[4:7], v[112:115], a[48:63]
    ds_read_b64_tr_b16 a[20:21], v195 offset:24576
    ds_read_b64_tr_b16 a[22:23], v195 offset:25600
    s_waitcnt lgkmcnt(6)
    v_mfma_f32_32x32x16_bf16 a[32:47], a[8:11], v[116:119], a[32:47]
    ds_read_b64_tr_b16 a[24:25], v194 offset:26624
    ds_read_b64_tr_b16 a[26:27], v194 offset:27648
    s_waitcnt lgkmcnt(6)
    v_mfma_f32_32x32x16_bf16 a[48:63], a[12:15], v[116:119], a[48:63]
    ds_read_b64_tr_b16 a[28:29], v195 offset:26624
    ds_read_b64_tr_b16 a[30:31], v195 offset:27648
    s_waitcnt lgkmcnt(6)
    v_mfma_f32_32x32x16_bf16 a[32:47], a[16:19], v[120:123], a[32:47]
    v_add_u32 v192, 57344, v10
    v_add_u32 v193, 57344, v11
    s_waitcnt vmcnt(16)
    s_barrier
    ds_read_b64_tr_b16 a[0:1], v192 offset:0
    ds_read_b64_tr_b16 a[2:3], v192 offset:1024
    s_add_u32 m0, s52, 0
    s_add_u32 s55, s64, 602112
    buffer_load_dwordx4 v8, s[44:47], s55 offen lds
    s_waitcnt lgkmcnt(6)
    v_mfma_f32_32x32x16_bf16 a[48:63], a[20:23], v[120:123], a[48:63]
    ds_read_b64_tr_b16 a[4:5], v193 offset:0
    ds_read_b64_tr_b16 a[6:7], v193 offset:1024
    s_waitcnt lgkmcnt(6)
    v_mfma_f32_32x32x16_bf16 a[32:47], a[24:27], v[124:127], a[32:47]
    ds_read_b64_tr_b16 a[8:9], v192 offset:2048
    ds_read_b64_tr_b16 a[10:11], v192 offset:3072
    s_add_u32 m0, s52, 1024
    s_add_u32 s55, s64, 623616
    buffer_load_dwordx4 v8, s[44:47], s55 offen lds
    s_waitcnt lgkmcnt(6)
    v_mfma_f32_32x32x16_bf16 a[48:63], a[28:31], v[124:127], a[48:63]
    ds_read_b64_tr_b16 a[12:13], v193 offset:2048
    ds_read_b64_tr_b16 a[14:15], v193 offset:3072
    s_waitcnt lgkmcnt(6)
    v_mfma_f32_32x32x16_bf16 a[64:79], v[16:19], a[0:3], 0
    ds_read_b64_tr_b16 a[16:17], v192 offset:4096
    ds_read_b64_tr_b16 a[18:19], v192 offset:5120
    s_add_u32 m0, s52, 2048
    s_add_u32 s55, s64, 645120
    buffer_load_dwordx4 v8, s[44:47], s55 offen lds
    s_waitcnt lgkmcnt(6)
    v_mfma_f32_32x32x16_bf16 a[80:95], v[16:19], a[4:7], 0
    ds_read_b64_tr_b16 a[20:21], v193 offset:4096
    ds_read_b64_tr_b16 a[22:23], v193 offset:5120
    s_waitcnt lgkmcnt(6)
    v_mfma_f32_32x32x16_bf16 a[64:79], v[20:23], a[8:11], a[64:79]
    ds_read_b64_tr_b16 a[24:25], v192 offset:6144
    ds_read_b64_tr_b16 a[26:27], v192 offset:7168
    s_add_u32 m0, s52, 3072
    s_add_u32 s55, s64, 666624
    buffer_load_dwordx4 v8, s[44:47], s55 offen lds
    s_waitcnt lgkmcnt(6)
    v_mfma_f32_32x32x16_bf16 a[80:95], v[20:23], a[12:15], a[80:95]
    ds_read_b64_tr_b16 a[28:29], v193 offset:6144
    ds_read_b64_tr_b16 a[30:31], v193 offset:7168
    v_accvgpr_read_b32 v236, a32
    v_accvgpr_read_b32 v237, a33
    v_accvgpr_read_b32 v238, a34
    s_waitcnt lgkmcnt(6)
    v_mfma_f32_32x32x16_bf16 a[64:79], v[24:27], a[16:19], a[64:79]
    ds_read_b64_tr_b16 a[0:1], v192 offset:8192
    ds_read_b64_tr_b16 a[2:3], v192 offset:9216
    s_add_u32 m0, s52, 4096
    s_add_u32 s55, s64, 688128
    buffer_load_dwordx4 v8, s[44:47], s55 offen lds
    s_waitcnt lgkmcnt(6)
    v_mfma_f32_32x32x16_bf16 a[80:95], v[24:27], a[20:23], a[80:95]
    ds_read_b64_tr_b16 a[4:5], v193 offset:8192
    ds_read_b64_tr_b16 a[6:7], v193 offset:9216
    v_accvgpr_read_b32 v239, a35
    v_mul_f32 v236, v196, v236
    v_mul_f32 v237, v196, v237
    s_waitcnt lgkmcnt(6)
    v_mfma_f32_32x32x16_bf16 a[64:79], v[28:31], a[24:27], a[64:79]
    ds_read_b64_tr_b16 a[8:9], v192 offset:10240
    ds_read_b64_tr_b16 a[10:11], v192 offset:11264
    s_add_u32 m0, s52, 5120
    s_add_u32 s55, s64, 709632
    buffer_load_dwordx4 v8, s[44:47], s55 offen lds
    s_waitcnt lgkmcnt(6)
    v_mfma_f32_32x32x16_bf16 a[80:95], v[28:31], a[28:31], a[80:95]
    ds_read_b64_tr_b16 a[12:13], v193 offset:10240
    ds_read_b64_tr_b16 a[14:15], v193 offset:11264
    v_mul_f32 v238, v196, v238
    v_mul_f32 v239, v196, v239
    v_cvt_pk_bf16_f32 v220, v236, v237
    s_waitcnt lgkmcnt(6)
    v_mfma_f32_32x32x16_bf16 a[64:79], v[32:35], a[0:3], a[64:79]
    ds_read_b64_tr_b16 a[16:17], v192 offset:12288
    ds_read_b64_tr_b16 a[18:19], v192 offset:13312
    s_add_u32 m0, s52, 6144
    s_add_u32 s55, s64, 731136
    buffer_load_dwordx4 v8, s[44:47], s55 offen lds
    s_waitcnt lgkmcnt(6)
    v_mfma_f32_32x32x16_bf16 a[80:95], v[32:35], a[4:7], a[80:95]
    ds_read_b64_tr_b16 a[20:21], v193 offset:12288
    ds_read_b64_tr_b16 a[22:23], v193 offset:13312
    v_cvt_pk_bf16_f32 v221, v238, v239
    v_accvgpr_read_b32 v240, a36
    v_accvgpr_read_b32 v241, a37
    s_waitcnt lgkmcnt(6)
    v_mfma_f32_32x32x16_bf16 a[64:79], v[36:39], a[8:11], a[64:79]
    ds_read_b64_tr_b16 a[24:25], v192 offset:14336
    ds_read_b64_tr_b16 a[26:27], v192 offset:15360
    s_sub_u32 s98, s66, s54
    s_add_u32 s98, s98, 401408
    buffer_load_dword v255, v254, s[48:51], s98 offen
    s_waitcnt lgkmcnt(6)
    v_mfma_f32_32x32x16_bf16 a[80:95], v[36:39], a[12:15], a[80:95]
    ds_read_b64_tr_b16 a[28:29], v193 offset:14336
    ds_read_b64_tr_b16 a[30:31], v193 offset:15360
    v_accvgpr_read_b32 v242, a38
    v_accvgpr_read_b32 v243, a39
    v_mul_f32 v240, v196, v240
    s_waitcnt lgkmcnt(6)
    v_mfma_f32_32x32x16_bf16 a[64:79], v[40:43], a[16:19], a[64:79]
    ds_read_b64_tr_b16 a[0:1], v192 offset:16384
    ds_read_b64_tr_b16 a[2:3], v192 offset:17408
    v_mul_f32 v241, v196, v241
    v_mul_f32 v242, v196, v242
    v_mul_f32 v243, v196, v243
    s_waitcnt lgkmcnt(6)
    v_mfma_f32_32x32x16_bf16 a[80:95], v[40:43], a[20:23], a[80:95]
    ds_read_b64_tr_b16 a[4:5], v193 offset:16384
    ds_read_b64_tr_b16 a[6:7], v193 offset:17408
    v_cvt_pk_bf16_f32 v222, v240, v241
    v_cvt_pk_bf16_f32 v223, v242, v243
    s_waitcnt lgkmcnt(6)
    v_mfma_f32_32x32x16_bf16 a[64:79], v[44:47], a[24:27], a[64:79]
    ds_read_b64_tr_b16 a[8:9], v192 offset:18432
    ds_read_b64_tr_b16 a[10:11], v192 offset:19456
    global_store_dwordx4 v198, v[220:223], s[34:35] offset:0 sc1
    s_waitcnt lgkmcnt(6)
    v_mfma_f32_32x32x16_bf16 a[80:95], v[44:47], a[28:31], a[80:95]
    ds_read_b64_tr_b16 a[12:13], v193 offset:18432
    ds_read_b64_tr_b16 a[14:15], v193 offset:19456
    v_accvgpr_read_b32 v236, a40
    v_accvgpr_read_b32 v237, a41
    v_accvgpr_read_b32 v238, a42
    s_waitcnt lgkmcnt(6)
    v_mfma_f32_32x32x16_bf16 a[64:79], v[48:51], a[0:3], a[64:79]
    ds_read_b64_tr_b16 a[16:17], v192 offset:20480
    ds_read_b64_tr_b16 a[18:19], v192 offset:21504
    v_accvgpr_read_b32 v239, a43
    v_mul_f32 v236, v196, v236
    v_mul_f32 v237, v196, v237
    s_waitcnt lgkmcnt(6)
    v_mfma_f32_32x32x16_bf16 a[80:95], v[48:51], a[4:7], a[80:95]
    ds_read_b64_tr_b16 a[20:21], v193 offset:20480
    ds_read_b64_tr_b16 a[22:23], v193 offset:21504
    v_mul_f32 v238, v196, v238
    v_mul_f32 v239, v196, v239
    v_cvt_pk_bf16_f32 v224, v236, v237
    s_waitcnt lgkmcnt(6)
    v_mfma_f32_32x32x16_bf16 a[64:79], v[52:55], a[8:11], a[64:79]
    ds_read_b64_tr_b16 a[24:25], v192 offset:22528
    ds_read_b64_tr_b16 a[26:27], v192 offset:23552
    v_cvt_pk_bf16_f32 v225, v238, v239
    v_accvgpr_read_b32 v240, a44
    v_accvgpr_read_b32 v241, a45
    s_waitcnt lgkmcnt(6)
    v_mfma_f32_32x32x16_bf16 a[80:95], v[52:55], a[12:15], a[80:95]
    ds_read_b64_tr_b16 a[28:29], v193 offset:22528
    ds_read_b64_tr_b16 a[30:31], v193 offset:23552
    v_accvgpr_read_b32 v242, a46
    v_accvgpr_read_b32 v243, a47
    v_mul_f32 v240, v196, v240
    s_waitcnt lgkmcnt(6)
    v_mfma_f32_32x32x16_bf16 a[64:79], v[56:59], a[16:19], a[64:79]
    ds_read_b64_tr_b16 a[0:1], v192 offset:24576
    ds_read_b64_tr_b16 a[2:3], v192 offset:25600
    v_mul_f32 v241, v196, v241
    v_mul_f32 v242, v196, v242
    v_mul_f32 v243, v196, v243
    s_waitcnt lgkmcnt(6)
    v_mfma_f32_32x32x16_bf16 a[80:95], v[56:59], a[20:23], a[80:95]
    ds_read_b64_tr_b16 a[4:5], v193 offset:24576
    ds_read_b64_tr_b16 a[6:7], v193 offset:25600
    v_cvt_pk_bf16_f32 v226, v240, v241
    v_cvt_pk_bf16_f32 v227, v242, v243
    v_cndmask_b32 v226, v226, 0, s[56:57]
    s_waitcnt lgkmcnt(6)
    v_mfma_f32_32x32x16_bf16 a[64:79], v[60:63], a[24:27], a[64:79]
    ds_read_b64_tr_b16 a[8:9], v192 offset:26624
    ds_read_b64_tr_b16 a[10:11], v192 offset:27648
    v_cndmask_b32 v227, v227, 0, s[56:57]
    s_waitcnt lgkmcnt(6)
    v_mfma_f32_32x32x16_bf16 a[80:95], v[60:63], a[28:31], a[80:95]
    ds_read_b64_tr_b16 a[12:13], v193 offset:26624
    ds_read_b64_tr_b16 a[14:15], v193 offset:27648
    global_store_dwordx4 v198, v[224:227], s[34:35] offset:1024 sc1
    s_waitcnt lgkmcnt(6)
    v_mfma_f32_32x32x16_bf16 a[64:79], v[64:67], a[0:3], a[64:79]
    v_add_u32 v194, 86016, v10
    v_add_u32 v195, 86016, v11
    s_waitcnt vmcnt(19)
    s_barrier
    ds_read_b64_tr_b16 a[16:17], v194 offset:0
    ds_read_b64_tr_b16 a[18:19], v194 offset:1024
    s_add_u32 m0, s52, 28672
    s_add_u32 s55, s66, 0
    buffer_load_dwordx4 v9, s[48:51], s55 offen lds
    s_waitcnt lgkmcnt(6)
    v_mfma_f32_32x32x16_bf16 a[80:95], v[64:67], a[4:7], a[80:95]
    ds_read_b64_tr_b16 a[20:21], v195 offset:0
    ds_read_b64_tr_b16 a[22:23], v195 offset:1024
    v_accvgpr_read_b32 v236, a48
    v_accvgpr_read_b32 v237, a49
    v_accvgpr_read_b32 v238, a50
    s_waitcnt lgkmcnt(6)
    v_mfma_f32_32x32x16_bf16 a[64:79], v[68:71], a[8:11], a[64:79]
    ds_read_b64_tr_b16 a[24:25], v194 offset:2048
    ds_read_b64_tr_b16 a[26:27], v194 offset:3072
    s_add_u32 m0, s52, 29696
    s_add_u32 s55, s66, 28672
    buffer_load_dwordx4 v9, s[48:51], s55 offen lds
    s_waitcnt lgkmcnt(6)
    v_mfma_f32_32x32x16_bf16 a[80:95], v[68:71], a[12:15], a[80:95]
    ds_read_b64_tr_b16 a[28:29], v195 offset:2048
    ds_read_b64_tr_b16 a[30:31], v195 offset:3072
    v_accvgpr_read_b32 v239, a51
    v_mul_f32 v236, v196, v236
    v_mul_f32 v237, v196, v237
    s_waitcnt lgkmcnt(6)
    v_mfma_f32_32x32x16_bf16 a[64:79], v[72:75], a[16:19], a[64:79]
    ds_read_b64_tr_b16 a[0:1], v194 offset:4096
    ds_read_b64_tr_b16 a[2:3], v194 offset:5120
    s_add_u32 m0, s52, 30720
    s_add_u32 s55, s66, 57344
    buffer_load_dwordx4 v9, s[48:51], s55 offen lds
    s_waitcnt lgkmcnt(6)
    v_mfma_f32_32x32x16_bf16 a[80:95], v[72:75], a[20:23], a[80:95]
    ds_read_b64_tr_b16 a[4:5], v195 offset:4096
    ds_read_b64_tr_b16 a[6:7], v195 offset:5120
    v_mul_f32 v238, v196, v238
    v_mul_f32 v239, v196, v239
    v_cvt_pk_bf16_f32 v228, v236, v237
    s_waitcnt lgkmcnt(6)
    v_mfma_f32_32x32x16_bf16 a[64:79], v[76:79], a[24:27], a[64:79]
    ds_read_b64_tr_b16 a[8:9], v194 offset:6144
    ds_read_b64_tr_b16 a[10:11], v194 offset:7168
    s_add_u32 m0, s52, 31744
    s_add_u32 s55, s66, 86016
    buffer_load_dwordx4 v9, s[48:51], s55 offen lds
    s_waitcnt lgkmcnt(6)
    v_mfma_f32_32x32x16_bf16 a[80:95], v[76:79], a[28:31], a[80:95]
    ds_read_b64_tr_b16 a[12:13], v195 offset:6144
    ds_read_b64_tr_b16 a[14:15], v195 offset:7168
    v_cvt_pk_bf16_f32 v229, v238, v239
    v_accvgpr_read_b32 v240, a52
    v_accvgpr_read_b32 v241, a53
    s_waitcnt lgkmcnt(6)
    v_mfma_f32_32x32x16_bf16 a[64:79], v[80:83], a[0:3], a[64:79]
    ds_read_b64_tr_b16 a[16:17], v194 offset:8192
    ds_read_b64_tr_b16 a[18:19], v194 offset:9216
    s_add_u32 m0, s52, 32768
    s_add_u32 s55, s66, 114688
    buffer_load_dwordx4 v9, s[48:51], s55 offen lds
    s_waitcnt lgkmcnt(6)
    v_mfma_f32_32x32x16_bf16 a[80:95], v[80:83], a[4:7], a[80:95]
    ds_read_b64_tr_b16 a[20:21], v195 offset:8192
    ds_read_b64_tr_b16 a[22:23], v195 offset:9216
    v_accvgpr_read_b32 v242, a54
    v_accvgpr_read_b32 v243, a55
    v_mul_f32 v240, v196, v240
    s_waitcnt lgkmcnt(6)
    v_mfma_f32_32x32x16_bf16 a[64:79], v[84:87], a[8:11], a[64:79]
    ds_read_b64_tr_b16 a[24:25], v194 offset:10240
    ds_read_b64_tr_b16 a[26:27], v194 offset:11264
    s_add_u32 m0, s52, 33792
    s_add_u32 s55, s66, 143360
    buffer_load_dwordx4 v9, s[48:51], s55 offen lds
    s_waitcnt lgkmcnt(6)
    v_mfma_f32_32x32x16_bf16 a[80:95], v[84:87], a[12:15], a[80:95]
    ds_read_b64_tr_b16 a[28:29], v195 offset:10240
    ds_read_b64_tr_b16 a[30:31], v195 offset:11264
    v_mul_f32 v241, v196, v241
    v_mul_f32 v242, v196, v242
    v_mul_f32 v243, v196, v243
    s_waitcnt lgkmcnt(6)
    v_mfma_f32_32x32x16_bf16 a[64:79], v[88:91], a[16:19], a[64:79]
    ds_read_b64_tr_b16 a[0:1], v194 offset:12288
    ds_read_b64_tr_b16 a[2:3], v194 offset:13312
    s_add_u32 m0, s52, 34816
    s_add_u32 s55, s66, 172032
    buffer_load_dwordx4 v9, s[48:51], s55 offen lds
    s_waitcnt lgkmcnt(6)
    v_mfma_f32_32x32x16_bf16 a[80:95], v[88:91], a[20:23], a[80:95]
    ds_read_b64_tr_b16 a[4:5], v195 offset:12288
    ds_read_b64_tr_b16 a[6:7], v195 offset:13312
    v_cvt_pk_bf16_f32 v230, v240, v241
    v_cvt_pk_bf16_f32 v231, v242, v243
    s_waitcnt lgkmcnt(6)
    v_mfma_f32_32x32x16_bf16 a[64:79], v[92:95], a[24:27], a[64:79]
    ds_read_b64_tr_b16 a[8:9], v194 offset:14336
    ds_read_b64_tr_b16 a[10:11], v194 offset:15360
    s_sub_u32 s98, s66, s54
    s_add_u32 s98, s98, 802816
    buffer_load_dword v255, v254, s[48:51], s98 offen
    s_waitcnt lgkmcnt(6)
    v_mfma_f32_32x32x16_bf16 a[80:95], v[92:95], a[28:31], a[80:95]
    ds_read_b64_tr_b16 a[12:13], v195 offset:14336
    ds_read_b64_tr_b16 a[14:15], v195 offset:15360
    global_store_dwordx4 v199, v[228:231], s[34:35] offset:0 sc1
    s_waitcnt lgkmcnt(6)
    v_mfma_f32_32x32x16_bf16 a[64:79], v[96:99], a[0:3], a[64:79]
    ds_read_b64_tr_b16 a[16:17], v194 offset:16384
    ds_read_b64_tr_b16 a[18:19], v194 offset:17408
    v_accvgpr_read_b32 v236, a56
    v_accvgpr_read_b32 v237, a57
    v_accvgpr_read_b32 v238, a58
    s_waitcnt lgkmcnt(6)
    v_mfma_f32_32x32x16_bf16 a[80:95], v[96:99], a[4:7], a[80:95]
    ds_read_b64_tr_b16 a[20:21], v195 offset:16384
    ds_read_b64_tr_b16 a[22:23], v195 offset:17408
    v_accvgpr_read_b32 v239, a59
    v_mul_f32 v236, v196, v236
    v_mul_f32 v237, v196, v237
    s_waitcnt lgkmcnt(6)
    v_mfma_f32_32x32x16_bf16 a[64:79], v[100:103], a[8:11], a[64:79]
    ds_read_b64_tr_b16 a[24:25], v194 offset:18432
    ds_read_b64_tr_b16 a[26:27], v194 offset:19456
    v_mul_f32 v238, v196, v238
    v_mul_f32 v239, v196, v239
    v_cvt_pk_bf16_f32 v232, v236, v237
    s_waitcnt lgkmcnt(6)
    v_mfma_f32_32x32x16_bf16 a[80:95], v[100:103], a[12:15], a[80:95]
    ds_read_b64_tr_b16 a[28:29], v195 offset:18432
    ds_read_b64_tr_b16 a[30:31], v195 offset:19456
    v_cvt_pk_bf16_f32 v233, v238, v239
    v_accvgpr_read_b32 v240, a60
    v_accvgpr_read_b32 v241, a61
    s_waitcnt lgkmcnt(6)
    v_mfma_f32_32x32x16_bf16 a[64:79], v[104:107], a[16:19], a[64:79]
    ds_read_b64_tr_b16 a[0:1], v194 offset:20480
    ds_read_b64_tr_b16 a[2:3], v194 offset:21504
    v_accvgpr_read_b32 v242, a62
    v_accvgpr_read_b32 v243, a63
    v_mul_f32 v240, v196, v240
    s_waitcnt lgkmcnt(6)
    v_mfma_f32_32x32x16_bf16 a[80:95], v[104:107], a[20:23], a[80:95]
    ds_read_b64_tr_b16 a[4:5], v195 offset:20480
    ds_read_b64_tr_b16 a[6:7], v195 offset:21504
    v_mul_f32 v241, v196, v241
    v_mul_f32 v242, v196, v242
    v_mul_f32 v243, v196, v243
    s_waitcnt lgkmcnt(6)
    v_mfma_f32_32x32x16_bf16 a[64:79], v[108:111], a[24:27], a[64:79]
    ds_read_b64_tr_b16 a[8:9], v194 offset:22528
    ds_read_b64_tr_b16 a[10:11], v194 offset:23552
    v_cvt_pk_bf16_f32 v234, v240, v241
    v_cvt_pk_bf16_f32 v235, v242, v243
    v_cndmask_b32 v234, v234, 0, s[56:57]
    s_waitcnt lgkmcnt(6)
    v_mfma_f32_32x32x16_bf16 a[80:95], v[108:111], a[28:31], a[80:95]
    ds_read_b64_tr_b16 a[12:13], v195 offset:22528
    ds_read_b64_tr_b16 a[14:15], v195 offset:23552
    v_cndmask_b32 v235, v235, 0, s[56:57]
    s_waitcnt lgkmcnt(6)
    v_mfma_f32_32x32x16_bf16 a[64:79], v[112:115], a[0:3], a[64:79]
    ds_read_b64_tr_b16 a[16:17], v194 offset:24576
    ds_read_b64_tr_b16 a[18:19], v194 offset:25600
    global_store_dwordx4 v199, v[232:235], s[34:35] offset:1024 sc1
    s_waitcnt lgkmcnt(6)
    v_mfma_f32_32x32x16_bf16 a[80:95], v[112:115], a[4:7], a[80:95]
    ds_read_b64_tr_b16 a[20:21], v195 offset:24576
    ds_read_b64_tr_b16 a[22:23], v195 offset:25600
    s_waitcnt lgkmcnt(6)
    v_mfma_f32_32x32x16_bf16 a[64:79], v[116:119], a[8:11], a[64:79]
    ds_read_b64_tr_b16 a[24:25], v194 offset:26624
    ds_read_b64_tr_b16 a[26:27], v194 offset:27648
    s_waitcnt lgkmcnt(6)
    v_mfma_f32_32x32x16_bf16 a[80:95], v[116:119], a[12:15], a[80:95]
    ds_read_b64_tr_b16 a[28:29], v195 offset:26624
    ds_read_b64_tr_b16 a[30:31], v195 offset:27648
    s_waitcnt lgkmcnt(6)
    v_mfma_f32_32x32x16_bf16 a[64:79], v[120:123], a[16:19], a[64:79]
    v_add_u32 v192, 114688, v10
    v_add_u32 v193, 114688, v11
    s_waitcnt vmcnt(21)
    s_barrier
    ds_read_b64_tr_b16 a[0:1], v192 offset:0
    ds_read_b64_tr_b16 a[2:3], v192 offset:1024
    s_add_u32 m0, s52, 57344
    s_add_u32 s55, s66, 401408
    buffer_load_dwordx4 v9, s[48:51], s55 offen lds
    s_waitcnt lgkmcnt(6)
    v_mfma_f32_32x32x16_bf16 a[80:95], v[120:123], a[20:23], a[80:95]
    ds_read_b64_tr_b16 a[4:5], v193 offset:0
    ds_read_b64_tr_b16 a[6:7], v193 offset:1024
    s_waitcnt lgkmcnt(6)
    v_mfma_f32_32x32x16_bf16 a[64:79], v[124:127], a[24:27], a[64:79]
    ds_read_b64_tr_b16 a[8:9], v192 offset:2048
    ds_read_b64_tr_b16 a[10:11], v192 offset:3072
    s_add_u32 m0, s52, 58368
    s_add_u32 s55, s66, 430080
    buffer_load_dwordx4 v9, s[48:51], s55 offen lds
    s_waitcnt lgkmcnt(6)
    v_mfma_f32_32x32x16_bf16 a[80:95], v[124:127], a[28:31], a[80:95]
    ds_read_b64_tr_b16 a[12:13], v193 offset:2048
    ds_read_b64_tr_b16 a[14:15], v193 offset:3072
    s_waitcnt lgkmcnt(6)
    v_mfma_f32_32x32x16_bf16 a[32:47], v[16:19], a[0:3], 0
    ds_read_b64_tr_b16 a[16:17], v192 offset:4096
    ds_read_b64_tr_b16 a[18:19], v192 offset:5120
    s_add_u32 m0, s52, 59392
    s_add_u32 s55, s66, 458752
    buffer_load_dwordx4 v9, s[48:51], s55 offen lds
    s_waitcnt lgkmcnt(6)
    v_mfma_f32_32x32x16_bf16 a[48:63], v[16:19], a[4:7], 0
    ds_read_b64_tr_b16 a[20:21], v193 offset:4096
    ds_read_b64_tr_b16 a[22:23], v193 offset:5120
    s_waitcnt lgkmcnt(6)
    v_mfma_f32_32x32x16_bf16 a[32:47], v[20:23], a[8:11], a[32:47]
    ds_read_b64_tr_b16 a[24:25], v192 offset:6144
    ds_read_b64_tr_b16 a[26:27], v192 offset:7168
    s_add_u32 m0, s52, 60416
    s_add_u32 s55, s66, 487424
    buffer_load_dwordx4 v9, s[48:51], s55 offen lds
    s_waitcnt lgkmcnt(6)
    v_mfma_f32_32x32x16_bf16 a[48:63], v[20:23], a[12:15], a[48:63]
    ds_read_b64_tr_b16 a[28:29], v193 offset:6144
    ds_read_b64_tr_b16 a[30:31], v193 offset:7168
    v_add_u32 v202, 0, v201
    v_accvgpr_read_b32 v236, a64
    v_accvgpr_read_b32 v237, a65
    s_waitcnt lgkmcnt(6)
    v_mfma_f32_32x32x16_bf16 a[32:47], v[24:27], a[16:19], a[32:47]
    ds_read_b64_tr_b16 a[0:1], v192 offset:8192
    ds_read_b64_tr_b16 a[2:3], v192 offset:9216
    s_add_u32 m0, s52, 61440
    s_add_u32 s55, s66, 516096
    buffer_load_dwordx4 v9, s[48:51], s55 offen lds
    s_waitcnt lgkmcnt(6)
    v_mfma_f32_32x32x16_bf16 a[48:63], v[24:27], a[20:23], a[48:63]
    ds_read_b64_tr_b16 a[4:5], v193 offset:8192
    ds_read_b64_tr_b16 a[6:7], v193 offset:9216
    v_accvgpr_read_b32 v238, a66
    v_accvgpr_read_b32 v239, a67
    v_mul_f32 v236, v204, v236
    s_waitcnt lgkmcnt(6)
    v_mfma_f32_32x32x16_bf16 a[32:47], v[28:31], a[24:27], a[32:47]
    ds_read_b64_tr_b16 a[8:9], v192 offset:10240
    ds_read_b64_tr_b16 a[10:11], v192 offset:11264
    s_add_u32 m0, s52, 62464
    s_add_u32 s55, s66, 544768
    buffer_load_dwordx4 v9, s[48:51], s55 offen lds
    s_waitcnt lgkmcnt(6)
    v_mfma_f32_32x32x16_bf16 a[48:63], v[28:31], a[28:31], a[48:63]
    ds_read_b64_tr_b16 a[12:13], v193 offset:10240
    ds_read_b64_tr_b16 a[14:15], v193 offset:11264
    v_mul_f32 v237, v205, v237
    v_mul_f32 v238, v206, v238
    v_mul_f32 v239, v207, v239
    s_waitcnt lgkmcnt(6)
    v_mfma_f32_32x32x16_bf16 a[32:47], v[32:35], a[0:3], a[32:47]
    ds_read_b64_tr_b16 a[16:17], v192 offset:12288
    ds_read_b64_tr_b16 a[18:19], v192 offset:13312
    s_add_u32 m0, s52, 63488
    s_add_u32 s55, s66, 573440
    buffer_load_dwordx4 v9, s[48:51], s55 offen lds
    s_waitcnt lgkmcnt(6)
    v_mfma_f32_32x32x16_bf16 a[48:63], v[32:35], a[4:7], a[48:63]
    ds_read_b64_tr_b16 a[20:21], v193 offset:12288
    ds_read_b64_tr_b16 a[22:23], v193 offset:13312
    v_cvt_pk_bf16_f32 v220, v236, v237
    v_cvt_pk_bf16_f32 v221, v238, v239
    v_cndmask_b32 v220, v220, v197, s[58:59]
    s_waitcnt lgkmcnt(6)
    v_mfma_f32_32x32x16_bf16 a[32:47], v[36:39], a[8:11], a[32:47]
    ds_read_b64_tr_b16 a[24:25], v192 offset:14336
    ds_read_b64_tr_b16 a[26:27], v192 offset:15360
    s_sub_u32 s98, s66, s54
    s_add_u32 s98, s98, 1204224
    buffer_load_dword v255, v254, s[48:51], s98 offen
    s_waitcnt lgkmcnt(6)
    v_mfma_f32_32x32x16_bf16 a[48:63], v[36:39], a[12:15], a[48:63]
    ds_read_b64_tr_b16 a[28:29], v193 offset:14336
    ds_read_b64_tr_b16 a[30:31], v193 offset:15360
    v_cndmask_b32 v221, v221, v197, s[58:59]
    v_accvgpr_read_b32 v240, a68
    v_accvgpr_read_b32 v241, a69
    s_waitcnt lgkmcnt(6)
    v_mfma_f32_32x32x16_bf16 a[32:47], v[40:43], a[16:19], a[32:47]
    ds_read_b64_tr_b16 a[0:1], v192 offset:16384
    ds_read_b64_tr_b16 a[2:3], v192 offset:17408
    v_accvgpr_read_b32 v242, a70
    v_accvgpr_read_b32 v243, a71
    v_mul_f32 v240, v208, v240
    s_waitcnt lgkmcnt(6)
    v_mfma_f32_32x32x16_bf16 a[48:63], v[40:43], a[20:23], a[48:63]
    ds_read_b64_tr_b16 a[4:5], v193 offset:16384
    ds_read_b64_tr_b16 a[6:7], v193 offset:17408
    v_mul_f32 v241, v209, v241
    v_mul_f32 v242, v210, v242
    v_mul_f32 v243, v211, v243
    s_waitcnt lgkmcnt(6)
    v_mfma_f32_32x32x16_bf16 a[32:47], v[44:47], a[24:27], a[32:47]
    ds_read_b64_tr_b16 a[8:9], v192 offset:18432
    ds_read_b64_tr_b16 a[10:11], v192 offset:19456
    v_cvt_pk_bf16_f32 v222, v240, v241
    v_cvt_pk_bf16_f32 v223, v242, v243
    v_cndmask_b32 v222, v222, v197, s[58:59]
    s_waitcnt lgkmcnt(6)
    v_mfma_f32_32x32x16_bf16 a[48:63], v[44:47], a[28:31], a[48:63]
    ds_read_b64_tr_b16 a[12:13], v193 offset:18432
    ds_read_b64_tr_b16 a[14:15], v193 offset:19456
    v_cndmask_b32 v223, v223, v197, s[58:59]
    s_waitcnt lgkmcnt(6)
    v_mfma_f32_32x32x16_bf16 a[32:47], v[48:51], a[0:3], a[32:47]
    ds_read_b64_tr_b16 a[16:17], v192 offset:20480
    ds_read_b64_tr_b16 a[18:19], v192 offset:21504
    global_store_dwordx4 v202, v[220:223], s[34:35] offset:0 sc1
    s_waitcnt lgkmcnt(6)
    v_mfma_f32_32x32x16_bf16 a[48:63], v[48:51], a[4:7], a[48:63]
    ds_read_b64_tr_b16 a[20:21], v193 offset:20480
    ds_read_b64_tr_b16 a[22:23], v193 offset:21504
    v_accvgpr_read_b32 v236, a72
    v_accvgpr_read_b32 v237, a73
    v_accvgpr_read_b32 v238, a74
    s_waitcnt lgkmcnt(6)
    v_mfma_f32_32x32x16_bf16 a[32:47], v[52:55], a[8:11], a[32:47]
    ds_read_b64_tr_b16 a[24:25], v192 offset:22528
    ds_read_b64_tr_b16 a[26:27], v192 offset:23552
    v_accvgpr_read_b32 v239, a75
    v_mul_f32 v236, v212, v236
    v_mul_f32 v237, v213, v237
    s_waitcnt lgkmcnt(6)
    v_mfma_f32_32x32x16_bf16 a[48:63], v[52:55], a[12:15], a[48:63]
    ds_read_b64_tr_b16 a[28:29], v193 offset:22528
    ds_read_b64_tr_b16 a[30:31], v193 offset:23552
    v_mul_f32 v238, v214, v238
    v_mul_f32 v239, v215, v239
    v_cvt_pk_bf16_f32 v224, v236, v237
    s_waitcnt lgkmcnt(6)
    v_mfma_f32_32x32x16_bf16 a[32:47], v[56:59], a[16:19], a[32:47]
    ds_read_b64_tr_b16 a[0:1], v192 offset:24576
    ds_read_b64_tr_b16 a[2:3], v192 offset:25600
    v_cvt_pk_bf16_f32 v225, v238, v239
    v_cndmask_b32 v224, v224, v197, s[58:59]
    v_cndmask_b32 v225, v225, v197, s[58:59]
    s_waitcnt lgkmcnt(6)
    v_mfma_f32_32x32x16_bf16 a[48:63], v[56:59], a[20:23], a[48:63]
    ds_read_b64_tr_b16 a[4:5], v193 offset:24576
    ds_read_b64_tr_b16 a[6:7], v193 offset:25600
    v_accvgpr_read_b32 v240, a76
    v_accvgpr_read_b32 v241, a77
    v_accvgpr_read_b32 v242, a78
    s_waitcnt lgkmcnt(6)
    v_mfma_f32_32x32x16_bf16 a[32:47], v[60:63], a[24:27], a[32:47]
    ds_read_b64_tr_b16 a[8:9], v192 offset:26624
    ds_read_b64_tr_b16 a[10:11], v192 offset:27648
    v_accvgpr_read_b32 v243, a79
    v_mul_f32 v240, v216, v240
    v_mul_f32 v241, v217, v241
    s_waitcnt lgkmcnt(6)
    v_mfma_f32_32x32x16_bf16 a[48:63], v[60:63], a[28:31], a[48:63]
    ds_read_b64_tr_b16 a[12:13], v193 offset:26624
    ds_read_b64_tr_b16 a[14:15], v193 offset:27648
    v_mul_f32 v242, v218, v242
    v_mul_f32 v243, v219, v243
    v_cvt_pk_bf16_f32 v226, v240, v241
    s_waitcnt lgkmcnt(6)
    v_mfma_f32_32x32x16_bf16 a[32:47], v[64:67], a[0:3], a[32:47]
    v_add_u32 v194, 0, v10
    v_add_u32 v195, 0, v11
    s_waitcnt vmcnt(22)
    s_barrier
    ds_read_b64_tr_b16 a[16:17], v194 offset:0
    ds_read_b64_tr_b16 a[18:19], v194 offset:1024
    s_add_u32 m0, s52, 86016
    s_add_u32 s55, s66, 802816
    buffer_load_dwordx4 v9, s[48:51], s55 offen lds
    s_waitcnt lgkmcnt(6)
    v_mfma_f32_32x32x16_bf16 a[48:63], v[64:67], a[4:7], a[48:63]
    ds_read_b64_tr_b16 a[20:21], v195 offset:0
    ds_read_b64_tr_b16 a[22:23], v195 offset:1024
    v_cvt_pk_bf16_f32 v227, v242, v243
    v_cndmask_b32 v226, v226, v197, s[58:59]
    v_cndmask_b32 v227, v227, v197, s[58:59]
    s_waitcnt lgkmcnt(6)
    v_mfma_f32_32x32x16_bf16 a[32:47], v[68:71], a[8:11], a[32:47]
    ds_read_b64_tr_b16 a[24:25], v194 offset:2048
    ds_read_b64_tr_b16 a[26:27], v194 offset:3072
    s_add_u32 m0, s52, 87040
    s_add_u32 s55, s66, 831488
    buffer_load_dwordx4 v9, s[48:51], s55 offen lds
    s_waitcnt lgkmcnt(6)
    v_mfma_f32_32x32x16_bf16 a[48:63], v[68:71], a[12:15], a[48:63]
    ds_read_b64_tr_b16 a[28:29], v195 offset:2048
    ds_read_b64_tr_b16 a[30:31], v195 offset:3072
    global_store_dwordx4 v202, v[224:227], s[34:35] offset:1024 sc1
    s_waitcnt lgkmcnt(6)
    v_mfma_f32_32x32x16_bf16 a[32:47], v[72:75], a[16:19], a[32:47]
    ds_read_b64_tr_b16 a[0:1], v194 offset:4096
    ds_read_b64_tr_b16 a[2:3], v194 offset:5120
    s_add_u32 m0, s52, 88064
    s_add_u32 s55, s66, 860160
    buffer_load_dwordx4 v9, s[48:51], s55 offen lds
    s_waitcnt lgkmcnt(6)
    v_mfma_f32_32x32x16_bf16 a[48:63], v[72:75], a[20:23], a[48:63]
    ds_read_b64_tr_b16 a[4:5], v195 offset:4096
    ds_read_b64_tr_b16 a[6:7], v195 offset:5120
    v_add_u32 v202, 262144, v201
    v_accvgpr_read_b32 v236, a80
    v_accvgpr_read_b32 v237, a81
    s_waitcnt lgkmcnt(6)
    v_mfma_f32_32x32x16_bf16 a[32:47], v[76:79], a[24:27], a[32:47]
    ds_read_b64_tr_b16 a[8:9], v194 offset:6144
    ds_read_b64_tr_b16 a[10:11], v194 offset:7168
    s_add_u32 m0, s52, 89088
    s_add_u32 s55, s66, 888832
    buffer_load_dwordx4 v9, s[48:51], s55 offen lds
    s_waitcnt lgkmcnt(6)
    v_mfma_f32_32x32x16_bf16 a[48:63], v[76:79], a[28:31], a[48:63]
    ds_read_b64_tr_b16 a[12:13], v195 offset:6144
    ds_read_b64_tr_b16 a[14:15], v195 offset:7168
    v_accvgpr_read_b32 v238, a82
    v_accvgpr_read_b32 v239, a83
    v_mul_f32 v236, v204, v236
    s_waitcnt lgkmcnt(6)
    v_mfma_f32_32x32x16_bf16 a[32:47], v[80:83], a[0:3], a[32:47]
    ds_read_b64_tr_b16 a[16:17], v194 offset:8192
    ds_read_b64_tr_b16 a[18:19], v194 offset:9216
    s_add_u32 m0, s52, 90112
    s_add_u32 s55, s66, 917504
    buffer_load_dwordx4 v9, s[48:51], s55 offen lds
    s_waitcnt lgkmcnt(6)
    v_mfma_f32_32x32x16_bf16 a[48:63], v[80:83], a[4:7], a[48:63]
    ds_read_b64_tr_b16 a[20:21], v195 offset:8192
    ds_read_b64_tr_b16 a[22:23], v195 offset:9216
    v_mul_f32 v237, v205, v237
    v_mul_f32 v238, v206, v238
    v_mul_f32 v239, v207, v239
    s_waitcnt lgkmcnt(6)
    v_mfma_f32_32x32x16_bf16 a[32:47], v[84:87], a[8:11], a[32:47]
    ds_read_b64_tr_b16 a[24:25], v194 offset:10240
    ds_read_b64_tr_b16 a[26:27], v194 offset:11264
    s_add_u32 m0, s52, 91136
    s_add_u32 s55, s66, 946176
    buffer_load_dwordx4 v9, s[48:51], s55 offen lds
    s_waitcnt lgkmcnt(6)
    v_mfma_f32_32x32x16_bf16 a[48:63], v[84:87], a[12:15], a[48:63]
    ds_read_b64_tr_b16 a[28:29], v195 offset:10240
    ds_read_b64_tr_b16 a[30:31], v195 offset:11264
    v_cvt_pk_bf16_f32 v228, v236, v237
    v_cvt_pk_bf16_f32 v229, v238, v239
    v_cndmask_b32 v228, v228, v197, s[58:59]
    s_waitcnt lgkmcnt(6)
    v_mfma_f32_32x32x16_bf16 a[32:47], v[88:91], a[16:19], a[32:47]
    ds_read_b64_tr_b16 a[0:1], v194 offset:12288
    ds_read_b64_tr_b16 a[2:3], v194 offset:13312
    s_add_u32 m0, s52, 92160
    s_add_u32 s55, s66, 974848
    buffer_load_dwordx4 v9, s[48:51], s55 offen lds
    s_waitcnt lgkmcnt(6)
    v_mfma_f32_32x32x16_bf16 a[48:63], v[88:91], a[20:23], a[48:63]
    ds_read_b64_tr_b16 a[4:5], v195 offset:12288
    ds_read_b64_tr_b16 a[6:7], v195 offset:13312
    v_cndmask_b32 v229, v229, v197, s[58:59]
    v_accvgpr_read_b32 v240, a84
    v_accvgpr_read_b32 v241, a85
    s_waitcnt lgkmcnt(6)
    v_mfma_f32_32x32x16_bf16 a[32:47], v[92:95], a[24:27], a[32:47]
    ds_read_b64_tr_b16 a[8:9], v194 offset:14336
    ds_read_b64_tr_b16 a[10:11], v194 offset:15360
    v_accvgpr_read_b32 v242, a86
    v_accvgpr_read_b32 v243, a87
    v_mul_f32 v240, v208, v240
    s_waitcnt lgkmcnt(6)
    v_mfma_f32_32x32x16_bf16 a[48:63], v[92:95], a[28:31], a[48:63]
    ds_read_b64_tr_b16 a[12:13], v195 offset:14336
    ds_read_b64_tr_b16 a[14:15], v195 offset:15360
    v_mul_f32 v241, v209, v241
    v_mul_f32 v242, v210, v242
    v_mul_f32 v243, v211, v243
    s_waitcnt lgkmcnt(6)
    v_mfma_f32_32x32x16_bf16 a[32:47], v[96:99], a[0:3], a[32:47]
    ds_read_b64_tr_b16 a[16:17], v194 offset:16384
    ds_read_b64_tr_b16 a[18:19], v194 offset:17408
    v_cvt_pk_bf16_f32 v230, v240, v241
    v_cvt_pk_bf16_f32 v231, v242, v243
    v_cndmask_b32 v230, v230, v197, s[58:59]
    s_waitcnt lgkmcnt(6)
    v_mfma_f32_32x32x16_bf16 a[48:63], v[96:99], a[4:7], a[48:63]
    ds_read_b64_tr_b16 a[20:21], v195 offset:16384
    ds_read_b64_tr_b16 a[22:23], v195 offset:17408
    v_cndmask_b32 v231, v231, v197, s[58:59]
    s_waitcnt lgkmcnt(6)
    v_mfma_f32_32x32x16_bf16 a[32:47], v[100:103], a[8:11], a[32:47]
    ds_read_b64_tr_b16 a[24:25], v194 offset:18432
    ds_read_b64_tr_b16 a[26:27], v194 offset:19456
    global_store_dwordx4 v202, v[228:231], s[34:35] offset:0 sc1
    s_waitcnt lgkmcnt(6)
    v_mfma_f32_32x32x16_bf16 a[48:63], v[100:103], a[12:15], a[48:63]
    ds_read_b64_tr_b16 a[28:29], v195 offset:18432
    ds_read_b64_tr_b16 a[30:31], v195 offset:19456
    v_accvgpr_read_b32 v236, a88
    v_accvgpr_read_b32 v237, a89
    v_accvgpr_read_b32 v238, a90
    s_waitcnt lgkmcnt(6)
    v_mfma_f32_32x32x16_bf16 a[32:47], v[104:107], a[16:19], a[32:47]
    ds_read_b64_tr_b16 a[0:1], v194 offset:20480
    ds_read_b64_tr_b16 a[2:3], v194 offset:21504
    v_accvgpr_read_b32 v239, a91
    v_mul_f32 v236, v212, v236
    v_mul_f32 v237, v213, v237
    s_waitcnt lgkmcnt(6)
    v_mfma_f32_32x32x16_bf16 a[48:63], v[104:107], a[20:23], a[48:63]
    ds_read_b64_tr_b16 a[4:5], v195 offset:20480
    ds_read_b64_tr_b16 a[6:7], v195 offset:21504
    v_mul_f32 v238, v214, v238
    v_mul_f32 v239, v215, v239
    v_cvt_pk_bf16_f32 v232, v236, v237
    s_waitcnt lgkmcnt(6)
    v_mfma_f32_32x32x16_bf16 a[32:47], v[108:111], a[24:27], a[32:47]
    ds_read_b64_tr_b16 a[8:9], v194 offset:22528
    ds_read_b64_tr_b16 a[10:11], v194 offset:23552
    v_cvt_pk_bf16_f32 v233, v238, v239
    v_cndmask_b32 v232, v232, v197, s[58:59]
    v_cndmask_b32 v233, v233, v197, s[58:59]
    s_waitcnt lgkmcnt(6)
    v_mfma_f32_32x32x16_bf16 a[48:63], v[108:111], a[28:31], a[48:63]
    ds_read_b64_tr_b16 a[12:13], v195 offset:22528
    ds_read_b64_tr_b16 a[14:15], v195 offset:23552
    v_accvgpr_read_b32 v240, a92
    v_accvgpr_read_b32 v241, a93
    v_accvgpr_read_b32 v242, a94
    s_waitcnt lgkmcnt(6)
    v_mfma_f32_32x32x16_bf16 a[32:47], v[112:115], a[0:3], a[32:47]
    ds_read_b64_tr_b16 a[16:17], v194 offset:24576
    ds_read_b64_tr_b16 a[18:19], v194 offset:25600
    v_accvgpr_read_b32 v243, a95
    v_mul_f32 v240, v216, v240
    v_mul_f32 v241, v217, v241
    s_waitcnt lgkmcnt(6)
    v_mfma_f32_32x32x16_bf16 a[48:63], v[112:115], a[4:7], a[48:63]
    ds_read_b64_tr_b16 a[20:21], v195 offset:24576
    ds_read_b64_tr_b16 a[22:23], v195 offset:25600
    v_mul_f32 v242, v218, v242
    v_mul_f32 v243, v219, v243
    v_cvt_pk_bf16_f32 v234, v240, v241
    s_waitcnt lgkmcnt(6)
    v_mfma_f32_32x32x16_bf16 a[32:47], v[116:119], a[8:11], a[32:47]
    ds_read_b64_tr_b16 a[24:25], v194 offset:26624
    ds_read_b64_tr_b16 a[26:27], v194 offset:27648
    v_cvt_pk_bf16_f32 v235, v242, v243
    v_cndmask_b32 v234, v234, v197, s[58:59]
    v_cndmask_b32 v235, v235, v197, s[58:59]
    s_waitcnt lgkmcnt(6)
    v_mfma_f32_32x32x16_bf16 a[48:63], v[116:119], a[12:15], a[48:63]
    ds_read_b64_tr_b16 a[28:29], v195 offset:26624
    ds_read_b64_tr_b16 a[30:31], v195 offset:27648
    global_store_dwordx4 v202, v[232:235], s[34:35] offset:1024 sc1
    s_waitcnt lgkmcnt(6)
    v_mfma_f32_32x32x16_bf16 a[32:47], v[120:123], a[16:19], a[32:47]
    v_add_u32 v192, 28672, v12
    v_add_u32 v193, 28672, v13
    s_waitcnt vmcnt(22)
    s_barrier
    s_waitcnt vmcnt(62)
    s_mov_b32 s4, 0
tagspin_8:
    v_readfirstlane_b32 s39, v203
    s_add_u32 s4, s4, 1
    s_cmp_lg_u32 s39, 0
    s_cbranch_scc1 tagok_9
    s_cmp_lt_u32 s4, 40000
    s_cbranch_scc0 tagok_9
    v_mov_b32 v252, 0
    global_load_dword v203, v252, s[32:33] sc1
    s_waitcnt vmcnt(0)
    s_nop 0
    s_branch tagspin_8
tagok_9:
    s_waitcnt vmcnt(19)
    s_mov_b64 exec, 1
    global_store_dword v5, v203, s[34:35] sc1
    s_mov_b64 exec, -1
    ds_read_b64_tr_b16 a[0:1], v192 offset:0
    ds_read_b64_tr_b16 a[2:3], v192 offset:1024
    s_add_u32 m0, s52, 114688
    s_add_u32 s55, s66, 1204224
    buffer_load_dwordx4 v9, s[48:51], s55 offen lds
    s_waitcnt lgkmcnt(6)
    v_mfma_f32_32x32x16_bf16 a[48:63], v[120:123], a[20:23], a[48:63]
    ds_read_b64_tr_b16 a[4:5], v193 offset:0
    ds_read_b64_tr_b16 a[6:7], v193 offset:1024
    s_waitcnt lgkmcnt(6)
    v_mfma_f32_32x32x16_bf16 a[32:47], v[124:127], a[24:27], a[32:47]
    ds_read_b64_tr_b16 a[8:9], v192 offset:14336
    ds_read_b64_tr_b16 a[10:11], v192 offset:15360
    s_add_u32 m0, s52, 115712
    s_add_u32 s55, s66, 1232896
    buffer_load_dwordx4 v9, s[48:51], s55 offen lds
    s_waitcnt lgkmcnt(6)
    v_mfma_f32_32x32x16_bf16 a[48:63], v[124:127], a[28:31], a[48:63]
    ds_read_b64_tr_b16 a[12:13], v193 offset:14336
    ds_read_b64_tr_b16 a[14:15], v193 offset:15360
    s_waitcnt lgkmcnt(6)
    v_mfma_f32_32x32x16_bf16 v[128:143], a[0:3], v[16:19], 0
    ds_read_b64_tr_b16 a[16:17], v192 offset:2048
    ds_read_b64_tr_b16 a[18:19], v192 offset:3072
    s_add_u32 m0, s52, 116736
    s_add_u32 s55, s66, 1261568
    buffer_load_dwordx4 v9, s[48:51], s55 offen lds
    s_waitcnt lgkmcnt(6)
    v_mfma_f32_32x32x16_bf16 v[144:159], a[4:7], v[16:19], 0
    ds_read_b64_tr_b16 a[20:21], v193 offset:2048
    ds_read_b64_tr_b16 a[22:23], v193 offset:3072
    s_waitcnt lgkmcnt(6)
    v_mfma_f32_32x32x16_bf16 v[160:175], a[8:11], v[16:19], 0
    ds_read_b64_tr_b16 a[24:25], v192 offset:16384
    ds_read_b64_tr_b16 a[26:27], v192 offset:17408
    s_add_u32 m0, s52, 117760
    s_add_u32 s55, s66, 1290240
    buffer_load_dwordx4 v9, s[48:51], s55 offen lds
    s_waitcnt lgkmcnt(6)
    v_mfma_f32_32x32x16_bf16 v[176:191], a[12:15], v[16:19], 0
    ds_read_b64_tr_b16 a[28:29], v193 offset:16384
    ds_read_b64_tr_b16 a[30:31], v193 offset:17408
    v_add_u32 v202, 524288, v201
    v_accvgpr_read_b32 v236, a32
    v_accvgpr_read_b32 v237, a33
    s_waitcnt lgkmcnt(6)
    v_mfma_f32_32x32x16_bf16 v[128:143], a[16:19], v[20:23], v[128:143]
    ds_read_b64_tr_b16 a[0:1], v192 offset:4096
    ds_read_b64_tr_b16 a[2:3], v192 offset:5120
    s_add_u32 m0, s52, 118784
    s_add_u32 s55, s66, 1318912
    buffer_load_dwordx4 v9, s[48:51], s55 offen lds
    s_waitcnt lgkmcnt(6)
    v_mfma_f32_32x32x16_bf16 v[144:159], a[20:23], v[20:23], v[144:159]
    ds_read_b64_tr_b16 a[4:5], v193 offset:4096
    ds_read_b64_tr_b16 a[6:7], v193 offset:5120
    v_accvgpr_read_b32 v238, a34
    v_accvgpr_read_b32 v239, a35
    v_mul_f32 v236, v204, v236
    s_waitcnt lgkmcnt(6)
    v_mfma_f32_32x32x16_bf16 v[160:175], a[24:27], v[20:23], v[160:175]
    ds_read_b64_tr_b16 a[8:9], v192 offset:18432
    ds_read_b64_tr_b16 a[10:11], v192 offset:19456
    s_add_u32 m0, s52, 119808
    s_add_u32 s55, s66, 1347584
    buffer_load_dwordx4 v9, s[48:51], s55 offen lds
    s_waitcnt lgkmcnt(6)
    v_mfma_f32_32x32x16_bf16 v[176:191], a[28:31], v[20:23], v[176:191]
    ds_read_b64_tr_b16 a[12:13], v193 offset:18432
    ds_read_b64_tr_b16 a[14:15], v193 offset:19456
    v_mul_f32 v237, v205, v237
    v_mul_f32 v238, v206, v238
    v_mul_f32 v239, v207, v239
    s_waitcnt lgkmcnt(6)
    v_mfma_f32_32x32x16_bf16 v[128:143], a[0:3], v[24:27], v[128:143]
    ds_read_b64_tr_b16 a[16:17], v192 offset:6144
    ds_read_b64_tr_b16 a[18:19], v192 offset:7168
    s_add_u32 m0, s52, 120832
    s_add_u32 s55, s66, 1376256
    buffer_load_dwordx4 v9, s[48:51], s55 offen lds
    s_waitcnt lgkmcnt(6)
    v_mfma_f32_32x32x16_bf16 v[144:159], a[4:7], v[24:27], v[144:159]
    ds_read_b64_tr_b16 a[20:21], v193 offset:6144
    ds_read_b64_tr_b16 a[22:23], v193 offset:7168
    v_cvt_pk_bf16_f32 v220, v236, v237
    v_cvt_pk_bf16_f32 v221, v238, v239
    v_cndmask_b32 v220, v220, v197, s[58:59]
    s_waitcnt lgkmcnt(6)
    v_mfma_f32_32x32x16_bf16 v[160:175], a[8:11], v[24:27], v[160:175]
    ds_read_b64_tr_b16 a[24:25], v192 offset:20480
    ds_read_b64_tr_b16 a[26:27], v192 offset:21504
    v_cndmask_b32 v221, v221, v197, s[58:59]
    v_accvgpr_read_b32 v240, a36
    v_accvgpr_read_b32 v241, a37
    s_waitcnt lgkmcnt(6)
    v_mfma_f32_32x32x16_bf16 v[176:191], a[12:15], v[24:27], v[176:191]
    ds_read_b64_tr_b16 a[28:29], v193 offset:20480
    ds_read_b64_tr_b16 a[30:31], v193 offset:21504
    v_accvgpr_read_b32 v242, a38
    v_accvgpr_read_b32 v243, a39
    v_mul_f32 v240, v208, v240
    s_waitcnt lgkmcnt(6)
    v_mfma_f32_32x32x16_bf16 v[128:143], a[16:19], v[28:31], v[128:143]
    ds_read_b64_tr_b16 a[0:1], v192 offset:8192
    ds_read_b64_tr_b16 a[2:3], v192 offset:9216
    v_mul_f32 v241, v209, v241
    v_mul_f32 v242, v210, v242
    v_mul_f32 v243, v211, v243
    s_waitcnt lgkmcnt(6)
    v_mfma_f32_32x32x16_bf16 v[144:159], a[20:23], v[28:31], v[144:159]
    ds_read_b64_tr_b16 a[4:5], v193 offset:8192
    ds_read_b64_tr_b16 a[6:7], v193 offset:9216
    v_cvt_pk_bf16_f32 v222, v240, v241
    v_cvt_pk_bf16_f32 v223, v242, v243
    v_cndmask_b32 v222, v222, v197, s[58:59]
    s_waitcnt lgkmcnt(6)
    v_mfma_f32_32x32x16_bf16 v[160:175], a[24:27], v[28:31], v[160:175]
    ds_read_b64_tr_b16 a[8:9], v192 offset:22528
    ds_read_b64_tr_b16 a[10:11], v192 offset:23552
    v_cndmask_b32 v223, v223, v197, s[58:59]
    s_waitcnt lgkmcnt(6)
    v_mfma_f32_32x32x16_bf16 v[176:191], a[28:31], v[28:31], v[176:191]
    ds_read_b64_tr_b16 a[12:13], v193 offset:22528
    ds_read_b64_tr_b16 a[14:15], v193 offset:23552
    global_store_dwordx4 v202, v[220:223], s[34:35] offset:0 sc1
    s_waitcnt lgkmcnt(6)
    v_mfma_f32_32x32x16_bf16 v[128:143], a[0:3], v[32:35], v[128:143]
    ds_read_b64_tr_b16 a[16:17], v192 offset:10240
    ds_read_b64_tr_b16 a[18:19], v192 offset:11264
    v_accvgpr_read_b32 v236, a40
    v_accvgpr_read_b32 v237, a41
    v_accvgpr_read_b32 v238, a42
    s_waitcnt lgkmcnt(6)
    v_mfma_f32_32x32x16_bf16 v[144:159], a[4:7], v[32:35], v[144:159]
    ds_read_b64_tr_b16 a[20:21], v193 offset:10240
    ds_read_b64_tr_b16 a[22:23], v193 offset:11264
    v_accvgpr_read_b32 v239, a43
    v_mul_f32 v236, v212, v236
    v_mul_f32 v237, v213, v237
    s_waitcnt lgkmcnt(6)
    v_mfma_f32_32x32x16_bf16 v[160:175], a[8:11], v[32:35], v[160:175]
    ds_read_b64_tr_b16 a[24:25], v192 offset:24576
    ds_read_b64_tr_b16 a[26:27], v192 offset:25600
    v_mul_f32 v238, v214, v238
    v_mul_f32 v239, v215, v239
    v_cvt_pk_bf16_f32 v224, v236, v237
    s_waitcnt lgkmcnt(6)
    v_mfma_f32_32x32x16_bf16 v[176:191], a[12:15], v[32:35], v[176:191]
    ds_read_b64_tr_b16 a[28:29], v193 offset:24576
    ds_read_b64_tr_b16 a[30:31], v193 offset:25600
    v_cvt_pk_bf16_f32 v225, v238, v239
    v_cndmask_b32 v224, v224, v197, s[58:59]
    v_cndmask_b32 v225, v225, v197, s[58:59]
    s_waitcnt lgkmcnt(6)
    v_mfma_f32_32x32x16_bf16 v[128:143], a[16:19], v[36:39], v[128:143]
    ds_read_b64_tr_b16 a[0:1], v192 offset:12288
    ds_read_b64_tr_b16 a[2:3], v192 offset:13312
    v_accvgpr_read_b32 v240, a44
    v_accvgpr_read_b32 v241, a45
    v_accvgpr_read_b32 v242, a46
    s_waitcnt lgkmcnt(6)
    v_mfma_f32_32x32x16_bf16 v[144:159], a[20:23], v[36:39], v[144:159]
    ds_read_b64_tr_b16 a[4:5], v193 offset:12288
    ds_read_b64_tr_b16 a[6:7], v193 offset:13312
    v_accvgpr_read_b32 v243, a47
    v_mul_f32 v240, v216, v240
    v_mul_f32 v241, v217, v241
    s_waitcnt lgkmcnt(6)
    v_mfma_f32_32x32x16_bf16 v[160:175], a[24:27], v[36:39], v[160:175]
    ds_read_b64_tr_b16 a[8:9], v192 offset:26624
    ds_read_b64_tr_b16 a[10:11], v192 offset:27648
    v_mul_f32 v242, v218, v242
    v_mul_f32 v243, v219, v243
    v_cvt_pk_bf16_f32 v226, v240, v241
    s_waitcnt lgkmcnt(6)
    v_mfma_f32_32x32x16_bf16 v[176:191], a[28:31], v[36:39], v[176:191]
    ds_read_b64_tr_b16 a[12:13], v193 offset:26624
    ds_read_b64_tr_b16 a[14:15], v193 offset:27648
    v_cvt_pk_bf16_f32 v227, v242, v243
    v_cndmask_b32 v226, v226, v197, s[58:59]
    v_cndmask_b32 v227, v227, v197, s[58:59]
    s_waitcnt lgkmcnt(6)
    v_mfma_f32_32x32x16_bf16 v[128:143], a[0:3], v[40:43], v[128:143]
    v_add_u32 v194, 57344, v12
    v_add_u32 v195, 57344, v13
    s_waitcnt vmcnt(21)
    s_barrier
    ds_read_b64_tr_b16 a[16:17], v194 offset:0
    ds_read_b64_tr_b16 a[18:19], v194 offset:1024
    global_store_dwordx4 v202, v[224:227], s[34:35] offset:1024 sc1
    s_waitcnt lgkmcnt(6)
    v_mfma_f32_32x32x16_bf16 v[144:159], a[4:7], v[40:43], v[144:159]
    ds_read_b64_tr_b16 a[20:21], v195 offset:0
    ds_read_b64_tr_b16 a[22:23], v195 offset:1024
    v_add_u32 v202, 786432, v201
    v_accvgpr_read_b32 v236, a48
    v_accvgpr_read_b32 v237, a49
    s_waitcnt lgkmcnt(6)
    v_mfma_f32_32x32x16_bf16 v[160:175], a[8:11], v[40:43], v[160:175]
    ds_read_b64_tr_b16 a[24:25], v194 offset:14336
    ds_read_b64_tr_b16 a[26:27], v194 offset:15360
    v_accvgpr_read_b32 v238, a50
    v_accvgpr_read_b32 v239, a51
    v_mul_f32 v236, v204, v236
    s_waitcnt lgkmcnt(6)
    v_mfma_f32_32x32x16_bf16 v[176:191], a[12:15], v[40:43], v[176:191]
    ds_read_b64_tr_b16 a[28:29], v195 offset:14336
    ds_read_b64_tr_b16 a[30:31], v195 offset:15360
    v_mul_f32 v237, v205, v237
    v_mul_f32 v238, v206, v238
    v_mul_f32 v239, v207, v239
    s_waitcnt lgkmcnt(6)
    v_mfma_f32_32x32x16_bf16 v[128:143], a[16:19], v[44:47], v[128:143]
    ds_read_b64_tr_b16 a[0:1], v194 offset:2048
    ds_read_b64_tr_b16 a[2:3], v194 offset:3072
    v_cvt_pk_bf16_f32 v228, v236, v237
    v_cvt_pk_bf16_f32 v229, v238, v239
    v_cndmask_b32 v228, v228, v197, s[58:59]
    s_waitcnt lgkmcnt(6)
    v_mfma_f32_32x32x16_bf16 v[144:159], a[20:23], v[44:47], v[144:159]
    ds_read_b64_tr_b16 a[4:5], v195 offset:2048
    ds_read_b64_tr_b16 a[6:7], v195 offset:3072
    v_cndmask_b32 v229, v229, v197, s[58:59]
    v_accvgpr_read_b32 v240, a52
    v_accvgpr_read_b32 v241, a53
    s_waitcnt lgkmcnt(6)
    v_mfma_f32_32x32x16_bf16 v[160:175], a[24:27], v[44:47], v[160:175]
    ds_read_b64_tr_b16 a[8:9], v194 offset:16384
    ds_read_b64_tr_b16 a[10:11], v194 offset:17408
    v_accvgpr_read_b32 v242, a54
    v_accvgpr_read_b32 v243, a55
    v_mul_f32 v240, v208, v240
    s_waitcnt lgkmcnt(6)
    v_mfma_f32_32x32x16_bf16 v[176:191], a[28:31], v[44:47], v[176:191]
    ds_read_b64_tr_b16 a[12:13], v195 offset:16384
    ds_read_b64_tr_b16 a[14:15], v195 offset:17408
    v_mul_f32 v241, v209, v241
    v_mul_f32 v242, v210, v242
    v_mul_f32 v243, v211, v243
    s_waitcnt lgkmcnt(6)
    v_mfma_f32_32x32x16_bf16 v[128:143], a[0:3], v[48:51], v[128:143]
    ds_read_b64_tr_b16 a[16:17], v194 offset:4096
    ds_read_b64_tr_b16 a[18:19], v194 offset:5120
    v_cvt_pk_bf16_f32 v230, v240, v241
    v_cvt_pk_bf16_f32 v231, v242, v243
    v_cndmask_b32 v230, v230, v197, s[58:59]
    s_waitcnt lgkmcnt(6)
    v_mfma_f32_32x32x16_bf16 v[144:159], a[4:7], v[48:51], v[144:159]
    ds_read_b64_tr_b16 a[20:21], v195 offset:4096
    ds_read_b64_tr_b16 a[22:23], v195 offset:5120
    v_cndmask_b32 v231, v231, v197, s[58:59]
    s_waitcnt lgkmcnt(6)
    v_mfma_f32_32x32x16_bf16 v[160:175], a[8:11], v[48:51], v[160:175]
    ds_read_b64_tr_b16 a[24:25], v194 offset:18432
    ds_read_b64_tr_b16 a[26:27], v194 offset:19456
    global_store_dwordx4 v202, v[228:231], s[34:35] offset:0 sc1
    s_waitcnt lgkmcnt(6)
    v_mfma_f32_32x32x16_bf16 v[176:191], a[12:15], v[48:51], v[176:191]
    ds_read_b64_tr_b16 a[28:29], v195 offset:18432
    ds_read_b64_tr_b16 a[30:31], v195 offset:19456
    v_accvgpr_read_b32 v236, a56
    v_accvgpr_read_b32 v237, a57
    v_accvgpr_read_b32 v238, a58
    s_waitcnt lgkmcnt(6)
    v_mfma_f32_32x32x16_bf16 v[128:143], a[16:19], v[52:55], v[128:143]
    ds_read_b64_tr_b16 a[0:1], v194 offset:6144
    ds_read_b64_tr_b16 a[2:3], v194 offset:7168
    v_accvgpr_read_b32 v239, a59
    v_mul_f32 v236, v212, v236
    v_mul_f32 v237, v213, v237
    s_waitcnt lgkmcnt(6)
    v_mfma_f32_32x32x16_bf16 v[144:159], a[20:23], v[52:55], v[144:159]
    ds_read_b64_tr_b16 a[4:5], v195 offset:6144
    ds_read_b64_tr_b16 a[6:7], v195 offset:7168
    v_mul_f32 v238, v214, v238
    v_mul_f32 v239, v215, v239
    v_cvt_pk_bf16_f32 v232, v236, v237
    s_waitcnt lgkmcnt(6)
    v_mfma_f32_32x32x16_bf16 v[160:175], a[24:27], v[52:55], v[160:175]
    ds_read_b64_tr_b16 a[8:9], v194 offset:20480
    ds_read_b64_tr_b16 a[10:11], v194 offset:21504
    v_cvt_pk_bf16_f32 v233, v238, v239
    v_cndmask_b32 v232, v232, v197, s[58:59]
    v_cndmask_b32 v233, v233, v197, s[58:59]
    s_waitcnt lgkmcnt(6)
    v_mfma_f32_32x32x16_bf16 v[176:191], a[28:31], v[52:55], v[176:191]
    ds_read_b64_tr_b16 a[12:13], v195 offset:20480
    ds_read_b64_tr_b16 a[14:15], v195 offset:21504
    v_accvgpr_read_b32 v240, a60
    v_accvgpr_read_b32 v241, a61
    v_accvgpr_read_b32 v242, a62
    s_waitcnt lgkmcnt(6)
    v_mfma_f32_32x32x16_bf16 v[128:143], a[0:3], v[56:59], v[128:143]
    ds_read_b64_tr_b16 a[16:17], v194 offset:8192
    ds_read_b64_tr_b16 a[18:19], v194 offset:9216
    v_accvgpr_read_b32 v243, a63
    v_mul_f32 v240, v216, v240
    v_mul_f32 v241, v217, v241
    s_waitcnt lgkmcnt(6)
    v_mfma_f32_32x32x16_bf16 v[144:159], a[4:7], v[56:59], v[144:159]
    ds_read_b64_tr_b16 a[20:21], v195 offset:8192
    ds_read_b64_tr_b16 a[22:23], v195 offset:9216
    v_mul_f32 v242, v218, v242
    v_mul_f32 v243, v219, v243
    v_cvt_pk_bf16_f32 v234, v240, v241
    s_waitcnt lgkmcnt(6)
    v_mfma_f32_32x32x16_bf16 v[160:175], a[8:11], v[56:59], v[160:175]
    ds_read_b64_tr_b16 a[24:25], v194 offset:22528
    ds_read_b64_tr_b16 a[26:27], v194 offset:23552
    v_cvt_pk_bf16_f32 v235, v242, v243
    v_cndmask_b32 v234, v234, v197, s[58:59]
    v_cndmask_b32 v235, v235, v197, s[58:59]
    s_waitcnt lgkmcnt(6)
    v_mfma_f32_32x32x16_bf16 v[176:191], a[12:15], v[56:59], v[176:191]
    ds_read_b64_tr_b16 a[28:29], v195 offset:22528
    ds_read_b64_tr_b16 a[30:31], v195 offset:23552
    global_store_dwordx4 v202, v[232:235], s[34:35] offset:1024 sc1
    s_waitcnt lgkmcnt(6)
    v_mfma_f32_32x32x16_bf16 v[128:143], a[16:19], v[60:63], v[128:143]
    ds_read_b64_tr_b16 a[0:1], v194 offset:10240
    ds_read_b64_tr_b16 a[2:3], v194 offset:11264
    s_waitcnt lgkmcnt(6)
    v_mfma_f32_32x32x16_bf16 v[144:159], a[20:23], v[60:63], v[144:159]
    ds_read_b64_tr_b16 a[4:5], v195 offset:10240
    ds_read_b64_tr_b16 a[6:7], v195 offset:11264
    s_waitcnt lgkmcnt(6)
    v_mfma_f32_32x32x16_bf16 v[160:175], a[24:27], v[60:63], v[160:175]
    ds_read_b64_tr_b16 a[8:9], v194 offset:24576
    ds_read_b64_tr_b16 a[10:11], v194 offset:25600
    s_waitcnt lgkmcnt(6)
    v_mfma_f32_32x32x16_bf16 v[176:191], a[28:31], v[60:63], v[176:191]
    ds_read_b64_tr_b16 a[12:13], v195 offset:24576
    ds_read_b64_tr_b16 a[14:15], v195 offset:25600
    s_waitcnt lgkmcnt(6)
    v_mfma_f32_32x32x16_bf16 v[128:143], a[0:3], v[64:67], v[128:143]
    ds_read_b64_tr_b16 a[16:17], v194 offset:12288
    ds_read_b64_tr_b16 a[18:19], v194 offset:13312
    s_waitcnt lgkmcnt(6)
    v_mfma_f32_32x32x16_bf16 v[144:159], a[4:7], v[64:67], v[144:159]
    ds_read_b64_tr_b16 a[20:21], v195 offset:12288
    ds_read_b64_tr_b16 a[22:23], v195 offset:13312
    s_waitcnt lgkmcnt(6)
    v_mfma_f32_32x32x16_bf16 v[160:175], a[8:11], v[64:67], v[160:175]
    ds_read_b64_tr_b16 a[24:25], v194 offset:26624
    ds_read_b64_tr_b16 a[26:27], v194 offset:27648
    s_waitcnt lgkmcnt(6)
    v_mfma_f32_32x32x16_bf16 v[176:191], a[12:15], v[64:67], v[176:191]
    ds_read_b64_tr_b16 a[28:29], v195 offset:26624
    ds_read_b64_tr_b16 a[30:31], v195 offset:27648
    s_waitcnt lgkmcnt(6)
    v_mfma_f32_32x32x16_bf16 v[128:143], a[16:19], v[68:71], v[128:143]
    v_add_u32 v192, 86016, v12
    v_add_u32 v193, 86016, v13
    s_waitcnt vmcnt(14)
    s_barrier
    ds_read_b64_tr_b16 a[0:1], v192 offset:0
    ds_read_b64_tr_b16 a[2:3], v192 offset:1024
    s_waitcnt lgkmcnt(6)
    v_mfma_f32_32x32x16_bf16 v[144:159], a[20:23], v[68:71], v[144:159]
    ds_read_b64_tr_b16 a[4:5], v193 offset:0
    ds_read_b64_tr_b16 a[6:7], v193 offset:1024
    s_waitcnt lgkmcnt(6)
    v_mfma_f32_32x32x16_bf16 v[160:175], a[24:27], v[68:71], v[160:175]
    ds_read_b64_tr_b16 a[8:9], v192 offset:14336
    ds_read_b64_tr_b16 a[10:11], v192 offset:15360
    s_waitcnt lgkmcnt(6)
    v_mfma_f32_32x32x16_bf16 v[176:191], a[28:31], v[68:71], v[176:191]
    ds_read_b64_tr_b16 a[12:13], v193 offset:14336
    ds_read_b64_tr_b16 a[14:15], v193 offset:15360
    s_waitcnt lgkmcnt(6)
    v_mfma_f32_32x32x16_bf16 v[128:143], a[0:3], v[72:75], v[128:143]
    ds_read_b64_tr_b16 a[16:17], v192 offset:2048
    ds_read_b64_tr_b16 a[18:19], v192 offset:3072
    s_waitcnt lgkmcnt(6)
    v_mfma_f32_32x32x16_bf16 v[144:159], a[4:7], v[72:75], v[144:159]
    ds_read_b64_tr_b16 a[20:21], v193 offset:2048
    ds_read_b64_tr_b16 a[22:23], v193 offset:3072
    s_waitcnt lgkmcnt(6)
    v_mfma_f32_32x32x16_bf16 v[160:175], a[8:11], v[72:75], v[160:175]
    ds_read_b64_tr_b16 a[24:25], v192 offset:16384
    ds_read_b64_tr_b16 a[26:27], v192 offset:17408
    s_waitcnt lgkmcnt(6)
    v_mfma_f32_32x32x16_bf16 v[176:191], a[12:15], v[72:75], v[176:191]
    ds_read_b64_tr_b16 a[28:29], v193 offset:16384
    ds_read_b64_tr_b16 a[30:31], v193 offset:17408
    s_waitcnt lgkmcnt(6)
    v_mfma_f32_32x32x16_bf16 v[128:143], a[16:19], v[76:79], v[128:143]
    ds_read_b64_tr_b16 a[0:1], v192 offset:4096
    ds_read_b64_tr_b16 a[2:3], v192 offset:5120
    s_waitcnt lgkmcnt(6)
    v_mfma_f32_32x32x16_bf16 v[144:159], a[20:23], v[76:79], v[144:159]
    ds_read_b64_tr_b16 a[4:5], v193 offset:4096
    ds_read_b64_tr_b16 a[6:7], v193 offset:5120
    s_waitcnt lgkmcnt(6)
    v_mfma_f32_32x32x16_bf16 v[160:175], a[24:27], v[76:79], v[160:175]
    ds_read_b64_tr_b16 a[8:9], v192 offset:18432
    ds_read_b64_tr_b16 a[10:11], v192 offset:19456
    s_waitcnt lgkmcnt(6)
    v_mfma_f32_32x32x16_bf16 v[176:191], a[28:31], v[76:79], v[176:191]
    ds_read_b64_tr_b16 a[12:13], v193 offset:18432
    ds_read_b64_tr_b16 a[14:15], v193 offset:19456
    s_waitcnt lgkmcnt(6)
    v_mfma_f32_32x32x16_bf16 v[128:143], a[0:3], v[80:83], v[128:143]
    ds_read_b64_tr_b16 a[16:17], v192 offset:6144
    ds_read_b64_tr_b16 a[18:19], v192 offset:7168
    s_waitcnt lgkmcnt(6)
    v_mfma_f32_32x32x16_bf16 v[144:159], a[4:7], v[80:83], v[144:159]
    ds_read_b64_tr_b16 a[20:21], v193 offset:6144
    ds_read_b64_tr_b16 a[22:23], v193 offset:7168
    s_waitcnt lgkmcnt(6)
    v_mfma_f32_32x32x16_bf16 v[160:175], a[8:11], v[80:83], v[160:175]
    ds_read_b64_tr_b16 a[24:25], v192 offset:20480
    ds_read_b64_tr_b16 a[26:27], v192 offset:21504
    s_waitcnt lgkmcnt(6)
    v_mfma_f32_32x32x16_bf16 v[176:191], a[12:15], v[80:83], v[176:191]
    ds_read_b64_tr_b16 a[28:29], v193 offset:20480
    ds_read_b64_tr_b16 a[30:31], v193 offset:21504
    s_waitcnt lgkmcnt(6)
    v_mfma_f32_32x32x16_bf16 v[128:143], a[16:19], v[84:87], v[128:143]
    ds_read_b64_tr_b16 a[0:1], v192 offset:8192
    ds_read_b64_tr_b16 a[2:3], v192 offset:9216
    s_waitcnt lgkmcnt(6)
    v_mfma_f32_32x32x16_bf16 v[144:159], a[20:23], v[84:87], v[144:159]
    ds_read_b64_tr_b16 a[4:5], v193 offset:8192
    ds_read_b64_tr_b16 a[6:7], v193 offset:9216
    s_waitcnt lgkmcnt(6)
    v_mfma_f32_32x32x16_bf16 v[160:175], a[24:27], v[84:87], v[160:175]
    ds_read_b64_tr_b16 a[8:9], v192 offset:22528
    ds_read_b64_tr_b16 a[10:11], v192 offset:23552
    s_waitcnt lgkmcnt(6)
    v_mfma_f32_32x32x16_bf16 v[176:191], a[28:31], v[84:87], v[176:191]
    ds_read_b64_tr_b16 a[12:13], v193 offset:22528
    ds_read_b64_tr_b16 a[14:15], v193 offset:23552
    s_waitcnt lgkmcnt(6)
    v_mfma_f32_32x32x16_bf16 v[128:143], a[0:3], v[88:91], v[128:143]
    ds_read_b64_tr_b16 a[16:17], v192 offset:10240
    ds_read_b64_tr_b16 a[18:19], v192 offset:11264
    s_waitcnt lgkmcnt(6)
    v_mfma_f32_32x32x16_bf16 v[144:159], a[4:7], v[88:91], v[144:159]
    ds_read_b64_tr_b16 a[20:21], v193 offset:10240
    ds_read_b64_tr_b16 a[22:23], v193 offset:11264
    s_waitcnt lgkmcnt(6)
    v_mfma_f32_32x32x16_bf16 v[160:175], a[8:11], v[88:91], v[160:175]
    ds_read_b64_tr_b16 a[24:25], v192 offset:24576
    ds_read_b64_tr_b16 a[26:27], v192 offset:25600
    s_waitcnt lgkmcnt(6)
    v_mfma_f32_32x32x16_bf16 v[176:191], a[12:15], v[88:91], v[176:191]
    ds_read_b64_tr_b16 a[28:29], v193 offset:24576
    ds_read_b64_tr_b16 a[30:31], v193 offset:25600
    s_waitcnt lgkmcnt(6)
    v_mfma_f32_32x32x16_bf16 v[128:143], a[16:19], v[92:95], v[128:143]
    ds_read_b64_tr_b16 a[0:1], v192 offset:12288
    ds_read_b64_tr_b16 a[2:3], v192 offset:13312
    s_waitcnt lgkmcnt(6)
    v_mfma_f32_32x32x16_bf16 v[144:159], a[20:23], v[92:95], v[144:159]
    ds_read_b64_tr_b16 a[4:5], v193 offset:12288
    ds_read_b64_tr_b16 a[6:7], v193 offset:13312
    s_waitcnt lgkmcnt(6)
    v_mfma_f32_32x32x16_bf16 v[160:175], a[24:27], v[92:95], v[160:175]
    ds_read_b64_tr_b16 a[8:9], v192 offset:26624
    ds_read_b64_tr_b16 a[10:11], v192 offset:27648
    s_waitcnt lgkmcnt(6)
    v_mfma_f32_32x32x16_bf16 v[176:191], a[28:31], v[92:95], v[176:191]
    ds_read_b64_tr_b16 a[12:13], v193 offset:26624
    ds_read_b64_tr_b16 a[14:15], v193 offset:27648
    s_waitcnt lgkmcnt(6)
    v_mfma_f32_32x32x16_bf16 v[128:143], a[0:3], v[96:99], v[128:143]
    v_add_u32 v194, 114688, v12
    v_add_u32 v195, 114688, v13
    s_waitcnt vmcnt(4)
    s_barrier
    s_waitcnt vmcnt(0)
    s_mov_b64 exec, 1
    global_store_dword v6, v203, s[34:35] sc1
    s_mov_b64 exec, -1
    ds_read_b64_tr_b16 a[16:17], v194 offset:0
    ds_read_b64_tr_b16 a[18:19], v194 offset:1024
    s_waitcnt lgkmcnt(6)
    v_mfma_f32_32x32x16_bf16 v[144:159], a[4:7], v[96:99], v[144:159]
    ds_read_b64_tr_b16 a[20:21], v195 offset:0
    ds_read_b64_tr_b16 a[22:23], v195 offset:1024
    s_waitcnt lgkmcnt(6)
    v_mfma_f32_32x32x16_bf16 v[160:175], a[8:11], v[96:99], v[160:175]
    ds_read_b64_tr_b16 a[24:25], v194 offset:14336
    ds_read_b64_tr_b16 a[26:27], v194 offset:15360
    s_waitcnt lgkmcnt(6)
    v_mfma_f32_32x32x16_bf16 v[176:191], a[12:15], v[96:99], v[176:191]
    ds_read_b64_tr_b16 a[28:29], v195 offset:14336
    ds_read_b64_tr_b16 a[30:31], v195 offset:15360
    s_waitcnt lgkmcnt(6)
    v_mfma_f32_32x32x16_bf16 v[128:143], a[16:19], v[100:103], v[128:143]
    ds_read_b64_tr_b16 a[0:1], v194 offset:2048
    ds_read_b64_tr_b16 a[2:3], v194 offset:3072
    s_waitcnt lgkmcnt(6)
    v_mfma_f32_32x32x16_bf16 v[144:159], a[20:23], v[100:103], v[144:159]
    ds_read_b64_tr_b16 a[4:5], v195 offset:2048
    ds_read_b64_tr_b16 a[6:7], v195 offset:3072
    s_waitcnt lgkmcnt(6)
    v_mfma_f32_32x32x16_bf16 v[160:175], a[24:27], v[100:103], v[160:175]
    ds_read_b64_tr_b16 a[8:9], v194 offset:16384
    ds_read_b64_tr_b16 a[10:11], v194 offset:17408
    s_waitcnt lgkmcnt(6)
    v_mfma_f32_32x32x16_bf16 v[176:191], a[28:31], v[100:103], v[176:191]
    ds_read_b64_tr_b16 a[12:13], v195 offset:16384
    ds_read_b64_tr_b16 a[14:15], v195 offset:17408
    s_waitcnt lgkmcnt(6)
    v_mfma_f32_32x32x16_bf16 v[128:143], a[0:3], v[104:107], v[128:143]
    ds_read_b64_tr_b16 a[16:17], v194 offset:4096
    ds_read_b64_tr_b16 a[18:19], v194 offset:5120
    s_waitcnt lgkmcnt(6)
    v_mfma_f32_32x32x16_bf16 v[144:159], a[4:7], v[104:107], v[144:159]
    ds_read_b64_tr_b16 a[20:21], v195 offset:4096
    ds_read_b64_tr_b16 a[22:23], v195 offset:5120
    s_waitcnt lgkmcnt(6)
    v_mfma_f32_32x32x16_bf16 v[160:175], a[8:11], v[104:107], v[160:175]
    ds_read_b64_tr_b16 a[24:25], v194 offset:18432
    ds_read_b64_tr_b16 a[26:27], v194 offset:19456
    s_waitcnt lgkmcnt(6)
    v_mfma_f32_32x32x16_bf16 v[176:191], a[12:15], v[104:107], v[176:191]
    ds_read_b64_tr_b16 a[28:29], v195 offset:18432
    ds_read_b64_tr_b16 a[30:31], v195 offset:19456
    s_waitcnt lgkmcnt(6)
    v_mfma_f32_32x32x16_bf16 v[128:143], a[16:19], v[108:111], v[128:143]
    ds_read_b64_tr_b16 a[0:1], v194 offset:6144
    ds_read_b64_tr_b16 a[2:3], v194 offset:7168
    s_waitcnt lgkmcnt(6)
    v_mfma_f32_32x32x16_bf16 v[144:159], a[20:23], v[108:111], v[144:159]
    ds_read_b64_tr_b16 a[4:5], v195 offset:6144
    ds_read_b64_tr_b16 a[6:7], v195 offset:7168
    s_waitcnt lgkmcnt(6)
    v_mfma_f32_32x32x16_bf16 v[160:175], a[24:27], v[108:111], v[160:175]
    ds_read_b64_tr_b16 a[8:9], v194 offset:20480
    ds_read_b64_tr_b16 a[10:11], v194 offset:21504
    s_waitcnt lgkmcnt(6)
    v_mfma_f32_32x32x16_bf16 v[176:191], a[28:31], v[108:111], v[176:191]
    ds_read_b64_tr_b16 a[12:13], v195 offset:20480
    ds_read_b64_tr_b16 a[14:15], v195 offset:21504
    s_waitcnt lgkmcnt(6)
    v_mfma_f32_32x32x16_bf16 v[128:143], a[0:3], v[112:115], v[128:143]
    ds_read_b64_tr_b16 a[16:17], v194 offset:8192
    ds_read_b64_tr_b16 a[18:19], v194 offset:9216
    s_waitcnt lgkmcnt(6)
    v_mfma_f32_32x32x16_bf16 v[144:159], a[4:7], v[112:115], v[144:159]
    ds_read_b64_tr_b16 a[20:21], v195 offset:8192
    ds_read_b64_tr_b16 a[22:23], v195 offset:9216
    s_waitcnt lgkmcnt(6)
    v_mfma_f32_32x32x16_bf16 v[160:175], a[8:11], v[112:115], v[160:175]
    ds_read_b64_tr_b16 a[24:25], v194 offset:22528
    ds_read_b64_tr_b16 a[26:27], v194 offset:23552
    s_waitcnt lgkmcnt(6)
    v_mfma_f32_32x32x16_bf16 v[176:191], a[12:15], v[112:115], v[176:191]
    ds_read_b64_tr_b16 a[28:29], v195 offset:22528
    ds_read_b64_tr_b16 a[30:31], v195 offset:23552
    s_waitcnt lgkmcnt(6)
    v_mfma_f32_32x32x16_bf16 v[128:143], a[16:19], v[116:119], v[128:143]
    ds_read_b64_tr_b16 a[0:1], v194 offset:10240
    ds_read_b64_tr_b16 a[2:3], v194 offset:11264
    s_waitcnt lgkmcnt(6)
    v_mfma_f32_32x32x16_bf16 v[144:159], a[20:23], v[116:119], v[144:159]
    ds_read_b64_tr_b16 a[4:5], v195 offset:10240
    ds_read_b64_tr_b16 a[6:7], v195 offset:11264
    s_waitcnt lgkmcnt(6)
    v_mfma_f32_32x32x16_bf16 v[160:175], a[24:27], v[116:119], v[160:175]
    ds_read_b64_tr_b16 a[8:9], v194 offset:24576
    ds_read_b64_tr_b16 a[10:11], v194 offset:25600
    s_waitcnt lgkmcnt(6)
    v_mfma_f32_32x32x16_bf16 v[176:191], a[28:31], v[116:119], v[176:191]
    ds_read_b64_tr_b16 a[12:13], v195 offset:24576
    ds_read_b64_tr_b16 a[14:15], v195 offset:25600
    s_waitcnt lgkmcnt(6)
    v_mfma_f32_32x32x16_bf16 v[128:143], a[0:3], v[120:123], v[128:143]
    ds_read_b64_tr_b16 a[16:17], v194 offset:12288
    ds_read_b64_tr_b16 a[18:19], v194 offset:13312
    s_waitcnt lgkmcnt(6)
    v_mfma_f32_32x32x16_bf16 v[144:159], a[4:7], v[120:123], v[144:159]
    ds_read_b64_tr_b16 a[20:21], v195 offset:12288
    ds_read_b64_tr_b16 a[22:23], v195 offset:13312
    s_waitcnt lgkmcnt(6)
    v_mfma_f32_32x32x16_bf16 v[160:175], a[8:11], v[120:123], v[160:175]
    ds_read_b64_tr_b16 a[24:25], v194 offset:26624
    ds_read_b64_tr_b16 a[26:27], v194 offset:27648
    s_waitcnt lgkmcnt(6)
    v_mfma_f32_32x32x16_bf16 v[176:191], a[12:15], v[120:123], v[176:191]
    ds_read_b64_tr_b16 a[28:29], v195 offset:26624
    ds_read_b64_tr_b16 a[30:31], v195 offset:27648
    s_waitcnt lgkmcnt(6)
    v_mfma_f32_32x32x16_bf16 v[128:143], a[16:19], v[124:127], v[128:143]
    s_waitcnt lgkmcnt(4)
    v_mfma_f32_32x32x16_bf16 v[144:159], a[20:23], v[124:127], v[144:159]
    s_waitcnt lgkmcnt(2)
    v_mfma_f32_32x32x16_bf16 v[160:175], a[24:27], v[124:127], v[160:175]
    s_waitcnt lgkmcnt(0)
    v_mfma_f32_32x32x16_bf16 v[176:191], a[28:31], v[124:127], v[176:191]
    s_barrier
    s_nop 7
    global_load_dword v4, v3, s[34:35] sc1
    s_lshl_b32 s4, s68, 12
    v_add_u32 v202, s4, v200
    v_mul_f32 v232, v14, v128
    v_mul_f32 v233, v14, v129
    v_mul_f32 v234, v14, v130
    v_mul_f32 v235, v14, v131
    v_exp_f32 v232, v232
    v_exp_f32 v233, v233
    v_exp_f32 v234, v234
    v_exp_f32 v235, v235
    v_mul_f32 v236, v128, v160
    v_mul_f32 v237, v129, v161
    v_mul_f32 v238, v130, v162
    v_mul_f32 v239, v131, v163
    v_fma_f32 v232, v232, v15, v15
    v_fma_f32 v233, v233, v15, v15
    v_fma_f32 v234, v234, v15, v15
    v_fma_f32 v235, v235, v15, v15
    v_rcp_f32 v232, v232
    v_rcp_f32 v233, v233
    v_rcp_f32 v234, v234
    v_rcp_f32 v235, v235
    v_mul_f32 v244, v14, v132
    v_mul_f32 v245, v14, v133
    v_mul_f32 v246, v14, v134
    v_mul_f32 v247, v14, v135
    v_exp_f32 v244, v244
    v_exp_f32 v245, v245
    v_exp_f32 v246, v246
    v_exp_f32 v247, v247
    v_mul_f32 v248, v132, v164
    v_mul_f32 v249, v133, v165
    v_mul_f32 v236, v236, v232
    v_mul_f32 v237, v237, v233
    v_mul_f32 v238, v238, v234
    v_mul_f32 v239, v239, v235
    v_cvt_pk_bf16_f32 v96, v236, v237
    v_cvt_pk_bf16_f32 v97, v238, v239
    v_mul_f32 v250, v134, v166
    v_mul_f32 v251, v135, v167
    v_fma_f32 v244, v244, v15, v15
    v_fma_f32 v245, v245, v15, v15
    v_fma_f32 v246, v246, v15, v15
    v_fma_f32 v247, v247, v15, v15
    v_rcp_f32 v244, v244
    v_rcp_f32 v245, v245
    v_rcp_f32 v246, v246
    v_rcp_f32 v247, v247
    v_mul_f32 v232, v14, v136
    v_mul_f32 v233, v14, v137
    v_mul_f32 v234, v14, v138
    v_mul_f32 v235, v14, v139
    v_exp_f32 v232, v232
    v_exp_f32 v233, v233
    v_exp_f32 v234, v234
    v_exp_f32 v235, v235
    v_mul_f32 v236, v136, v168
    v_mul_f32 v237, v137, v169
    v_mul_f32 v248, v248, v244
    v_mul_f32 v249, v249, v245
    v_mul_f32 v250, v250, v246
    v_mul_f32 v251, v251, v247
    v_cvt_pk_bf16_f32 v98, v248, v249
    v_cvt_pk_bf16_f32 v99, v250, v251
    v_mul_f32 v238, v138, v170
    v_mul_f32 v239, v139, v171
    v_fma_f32 v232, v232, v15, v15
    v_fma_f32 v233, v233, v15, v15
    v_fma_f32 v234, v234, v15, v15
    v_fma_f32 v235, v235, v15, v15
    global_load_dword v253, v3, s[34:35] sc1
    v_rcp_f32 v232, v232
    v_rcp_f32 v233, v233
    v_rcp_f32 v234, v234
    v_rcp_f32 v235, v235
    v_mul_f32 v244, v14, v140
    v_mul_f32 v245, v14, v141
    v_mul_f32 v246, v14, v142
    v_mul_f32 v247, v14, v143
    v_exp_f32 v244, v244
    v_exp_f32 v245, v245
    v_exp_f32 v246, v246
    v_exp_f32 v247, v247
    v_mul_f32 v248, v140, v172
    v_mul_f32 v249, v141, v173
    v_mul_f32 v236, v236, v232
    v_mul_f32 v237, v237, v233
    v_mul_f32 v238, v238, v234
    v_mul_f32 v239, v239, v235
    v_cvt_pk_bf16_f32 v100, v236, v237
    v_cvt_pk_bf16_f32 v101, v238, v239
    v_mul_f32 v250, v142, v174
    v_mul_f32 v251, v143, v175
    v_fma_f32 v244, v244, v15, v15
    v_fma_f32 v245, v245, v15, v15
    v_fma_f32 v246, v246, v15, v15
    v_fma_f32 v247, v247, v15, v15
    v_rcp_f32 v244, v244
    v_rcp_f32 v245, v245
    v_rcp_f32 v246, v246
    v_rcp_f32 v247, v247
    v_mul_f32 v232, v14, v144
    v_mul_f32 v233, v14, v145
    v_mul_f32 v234, v14, v146
    v_mul_f32 v235, v14, v147
    v_exp_f32 v232, v232
    v_lshlrev_b32 v2, 4, v1
    s_lshl_b32 s4, s10, 6
    s_lshl_b32 s5, s36, 4
    s_add_u32 s5, s5, s4
    s_lshl_b32 s5, s5, 12
    s_add_u32 s5, s5, 2097152
    s_add_u32 s52, s34, s5
    s_addc_u32 s53, s35, 0
    s_lshl_b32 s69, s11, 2
    s_add_u32 s69, s69, s4
    s_lshl_b32 s69, s69, 11
    s_waitcnt vmcnt(1)
    v_cmp_ne_u32 vcc, s39, v4
    s_nop 0
    s_cbranch_vccz ready_10
    s_waitcnt vmcnt(0)
    v_cmp_ne_u32 vcc, s39, v253
    s_nop 0
    s_cbranch_vccz ready_10
    s_mov_b32 s4, 0
poll_11:
    global_load_dword v4, v3, s[34:35] sc1
    s_waitcnt vmcnt(0)
    v_cmp_ne_u32 vcc, s39, v4
    s_add_u32 s4, s4, 1
    s_cbranch_vccz polldone_12
    s_cmp_lt_u32 s4, 40000
    s_cbranch_scc0 polldone_12
    s_branch poll_11
polldone_12:
ready_10:
    global_load_dwordx4 a[192:195], v2, s[52:53] offset:0 sc1
    s_mov_b32 s60, 3
    s_mov_b32 s40, s28
    s_and_b32 s41, s29, 0xffff
    s_mul_i32 s42, s14, 1605632
    global_load_dwordx4 a[196:199], v2, s[52:53] offset:1024 sc1
    s_mov_b32 s43, 0x20000
    s_mov_b32 s44, s20
    s_and_b32 s45, s21, 0xffff
    s_mov_b32 s46, 401408
    s_mov_b32 s47, 0x20000
    global_load_dwordx4 a[200:203], v2, s[52:53] offset:2048 sc1
    s_add_u32 s48, s34, 8388608
    s_addc_u32 s49, s35, 0
    s_and_b32 s49, s49, 0xffff
    s_mul_i32 s50, s14, 7340032
    s_mov_b32 s51, 0x20000
    global_load_dwordx4 a[204:207], v2, s[52:53] offset:3072 sc1
    s_mul_i32 s61, s36, 40960
    s_add_u32 s62, s61, 16384
    s_lshl_b32 s4, s13, 7
    s_mul_i32 s5, s36, 401408
    s_add_u32 s63, s4, s5
    s_xor_b32 s3, s36, 0
    s_lshl_b32 s3, s3, 11
    s_add_u32 s3, s3, s69
    s_add_u32 s98, s34, s3
    s_addc_u32 s99, s35, 0
    global_load_dwordx4 a[160:163], v2, s[98:99] offset:0 sc1
    s_mov_b32 s97, s63
    s_mul_i32 s5, s36, 100352
    s_add_u32 s67, s4, s5
    s_and_b32 s4, s36, 1
    s_xor_b32 s4, s4, 0
    global_load_dwordx4 a[164:167], v2, s[98:99] offset:1024 sc1
    s_lshl_b32 s5, s12, 1
    s_add_u32 s4, s4, s5
    s_mul_i32 s5, s4, 114688
    s_mul_i32 s6, s36, 28672
    s_xor_b32 s3, s36, 1
    s_lshl_b32 s3, s3, 11
    s_add_u32 s3, s3, s69
    s_add_u32 s98, s34, s3
    s_addc_u32 s99, s35, 0
    global_load_dwordx4 a[168:171], v2, s[98:99] offset:0 sc1
    s_add_u32 s5, s5, s6
    s_add_u32 s5, s5, 8388608
    s_add_u32 s64, s34, s5
    s_addc_u32 s65, s35, 0
    s_lshl_b32 s5, s4, 15
    s_lshl_b32 s6, s36, 13
    global_load_dwordx4 a[172:175], v2, s[98:99] offset:1024 sc1
    s_add_u32 s5, s5, s6
    s_add_u32 s58, s5, 6291456
    s_and_b32 s4, s36, 1
    s_xor_b32 s4, s4, 1
    s_lshl_b32 s5, s12, 1
    s_xor_b32 s3, s36, 2
    s_lshl_b32 s3, s3, 11
    s_add_u32 s3, s3, s69
    s_add_u32 s98, s34, s3
    s_addc_u32 s99, s35, 0
    global_load_dwordx4 a[176:179], v2, s[98:99] offset:0 sc1
    s_add_u32 s4, s4, s5
    s_mul_i32 s5, s4, 114688
    s_mul_i32 s6, s36, 28672
    s_add_u32 s5, s5, s6
    global_load_dwordx4 a[180:183], v2, s[98:99] offset:1024 sc1
    s_add_u32 s5, s5, 8388608
    s_add_u32 s100, s34, s5
    s_addc_u32 s101, s35, 0
    s_lshl_b32 s5, s4, 15
    s_lshl_b32 s6, s36, 13
    s_add_u32 s5, s5, s6
    s_xor_b32 s3, s36, 3
    s_lshl_b32 s3, s3, 11
    s_add_u32 s3, s3, s69
    s_add_u32 s98, s34, s3
    s_addc_u32 s99, s35, 0
    global_load_dwordx4 a[184:187], v2, s[98:99] offset:0 sc1
    s_add_u32 s59, s5, 6291456
    v_lshrrev_b32 v16, 3, v1
    v_and_b32 v17, 7, v1
    v_bfe_u32 v18, v1, 4, 1
    v_lshlrev_b32 v18, 2, v18
    global_load_dwordx4 a[188:191], v2, s[98:99] offset:1024 sc1
    v_xor_b32 v18, v17, v18
    v_mul_u32_u24 v19, 896, v16
    v_lshl_add_u32 v5, v18, 4, v19
    v_lshrrev_b32 v16, 5, v1
    s_add_u32 s54, s52, 4096
    s_addc_u32 s55, s53, 0
    global_load_dwordx4 a[208:211], v2, s[54:55] offset:0 sc1
    v_bfe_u32 v17, v1, 2, 2
    v_lshl_add_u32 v18, v16, 2, v17
    v_lshlrev_b32 v18, 7, v18
    v_add_u32 v18, s61, v18
    v_bfe_u32 v19, v1, 4, 1
    global_load_dwordx4 a[212:215], v2, s[54:55] offset:1024 sc1
    v_and_b32 v20, 3, v1
    v_lshlrev_b32 v19, 5, v19
    v_lshl_add_u32 v19, v20, 3, v19
    v_lshrrev_b32 v20, 1, v17
    v_lshlrev_b32 v20, 6, v20
    global_load_dwordx4 a[216:219], v2, s[54:55] offset:2048 sc1
    s_lshr_b32 s4, s36, 1
    s_lshl_b32 s4, s4, 6
    s_xor_b32 s5, s4, 0
    v_add_u32 v21, s5, v19
    global_load_dwordx4 a[220:223], v2, s[54:55] offset:3072 sc1
    v_xor_b32 v21, v21, v20
    v_add_u32 v8, v21, v18
    s_xor_b32 s5, s4, 64
    v_add_u32 v21, s5, v19
    v_xor_b32 v21, v21, v20
    s_add_u32 s54, s52, 8192
    s_addc_u32 s55, s53, 0
    global_load_dwordx4 a[224:227], v2, s[54:55] offset:0 sc1
    v_add_u32 v9, v21, v18
    v_add_u32 v10, s61, v2
    s_xor_b32 s4, s36, 1
    s_mul_i32 s4, s4, 40960
    v_add_u32 v11, s4, v2
    global_load_dwordx4 a[228:231], v2, s[54:55] offset:1024 sc1
    s_xor_b32 s4, s36, 2
    s_mul_i32 s4, s4, 40960
    v_add_u32 v12, s4, v2
    s_xor_b32 s4, s36, 3
    global_load_dwordx4 a[232:235], v2, s[54:55] offset:2048 sc1
    s_mul_i32 s4, s4, 40960
    v_add_u32 v13, s4, v2
    v_bfe_u32 v16, v1, 4, 1
    s_lshl_b32 s4, s12, 1
    v_add_u32 v16, s4, v16
    global_load_dwordx4 a[236:239], v2, s[54:55] offset:3072 sc1
    v_lshlrev_b32 v16, 4, v16
    v_and_b32 v17, 15, v1
    v_add_u32 v16, v16, v17
    v_lshlrev_b32 v16, 7, v16
    v_add_u32 v3, 17104896, v16
    s_nop 3
    v_exp_f32 v233, v233
    v_exp_f32 v234, v234
    v_exp_f32 v235, v235
    v_mul_f32 v236, v144, v176
    v_mul_f32 v237, v145, v177
    v_mul_f32 v248, v248, v244
    v_mul_f32 v249, v249, v245
    v_mul_f32 v250, v250, v246
    v_mul_f32 v251, v251, v247
    v_cvt_pk_bf16_f32 v102, v248, v249
    v_cvt_pk_bf16_f32 v103, v250, v251
    v_mul_f32 v238, v146, v178
    v_mul_f32 v239, v147, v179
    v_fma_f32 v232, v232, v15, v15
    v_fma_f32 v233, v233, v15, v15
    v_fma_f32 v234, v234, v15, v15
    v_fma_f32 v235, v235, v15, v15
    v_rcp_f32 v232, v232
    v_rcp_f32 v233, v233
    v_rcp_f32 v234, v234
    v_rcp_f32 v235, v235
    v_mul_f32 v244, v14, v148
    v_mul_f32 v245, v14, v149
    v_mul_f32 v246, v14, v150
    v_mul_f32 v247, v14, v151
    v_exp_f32 v244, v244
    v_exp_f32 v245, v245
    v_exp_f32 v246, v246
    v_exp_f32 v247, v247
    v_mul_f32 v248, v148, v180
    v_mul_f32 v249, v149, v181
    v_mul_f32 v236, v236, v232
    v_mul_f32 v237, v237, v233
    v_mul_f32 v238, v238, v234
    v_mul_f32 v239, v239, v235
    v_cvt_pk_bf16_f32 v104, v236, v237
    v_cvt_pk_bf16_f32 v105, v238, v239
    v_mul_f32 v250, v150, v182
    v_mul_f32 v251, v151, v183
    v_fma_f32 v244, v244, v15, v15
    v_fma_f32 v245, v245, v15, v15
    v_fma_f32 v246, v246, v15, v15
    v_fma_f32 v247, v247, v15, v15
    v_rcp_f32 v244, v244
    v_rcp_f32 v245, v245
    v_rcp_f32 v246, v246
    v_rcp_f32 v247, v247
    v_mul_f32 v232, v14, v152
    v_mul_f32 v233, v14, v153
    v_mul_f32 v234, v14, v154
    v_mul_f32 v235, v14, v155
    v_exp_f32 v232, v232
    v_exp_f32 v233, v233
    v_exp_f32 v234, v234
    v_exp_f32 v235, v235
    v_mul_f32 v236, v152, v184
    v_mul_f32 v237, v153, v185
    v_mul_f32 v248, v248, v244
    v_mul_f32 v249, v249, v245
    v_mul_f32 v250, v250, v246
    v_mul_f32 v251, v251, v247
    v_cvt_pk_bf16_f32 v106, v248, v249
    v_cvt_pk_bf16_f32 v107, v250, v251
    v_mul_f32 v238, v154, v186
    v_mul_f32 v239, v155, v187
    v_fma_f32 v232, v232, v15, v15
    v_fma_f32 v233, v233, v15, v15
    v_fma_f32 v234, v234, v15, v15
    v_fma_f32 v235, v235, v15, v15
    v_rcp_f32 v232, v232
    v_rcp_f32 v233, v233
    v_rcp_f32 v234, v234
    v_rcp_f32 v235, v235
    v_mul_f32 v244, v14, v156
    v_mul_f32 v245, v14, v157
    v_mul_f32 v246, v14, v158
    v_mul_f32 v247, v14, v159
    v_exp_f32 v244, v244
    v_exp_f32 v245, v245
    v_exp_f32 v246, v246
    v_exp_f32 v247, v247
    v_mul_f32 v248, v156, v188
    v_mul_f32 v249, v157, v189
    v_mul_f32 v236, v236, v232
    v_mul_f32 v237, v237, v233
    v_mul_f32 v238, v238, v234
    v_mul_f32 v239, v239, v235
    v_cvt_pk_bf16_f32 v108, v236, v237
    v_cvt_pk_bf16_f32 v109, v238, v239
    v_mul_f32 v250, v158, v190
    v_mul_f32 v251, v159, v191
    v_fma_f32 v244, v244, v15, v15
    v_fma_f32 v245, v245, v15, v15
    v_fma_f32 v246, v246, v15, v15
    v_fma_f32 v247, v247, v15, v15
    v_rcp_f32 v244, v244
    v_rcp_f32 v245, v245
    v_rcp_f32 v246, v246
    v_rcp_f32 v247, v247
    s_nop 0
    v_mul_f32 v248, v248, v244
    v_mul_f32 v249, v249, v245
    v_mul_f32 v250, v250, v246
    v_mul_f32 v251, v251, v247
    v_cvt_pk_bf16_f32 v110, v248, v249
    v_cvt_pk_bf16_f32 v111, v250, v251
    global_store_dwordx4 v202, v[96:99], s[34:35] offset:0 sc1
    global_store_dwordx4 v202, v[100:103], s[34:35] offset:1024 sc1
    global_store_dwordx4 v202, v[104:107], s[34:35] offset:2048 sc1
    global_store_dwordx4 v202, v[108:111], s[34:35] offset:3072 sc1
    v_mov_b32 v14, v203
    s_waitcnt vmcnt(12)
    v_mfma_f32_32x32x16_bf16 v[16:31], a[192:195], a[160:163], 0
    v_mfma_f32_32x32x16_bf16 v[16:31], a[196:199], a[164:167], v[16:31]
    s_nop 7
    s_nop 4
.p2align 6
attn_entry:
    v_exp_f32 v16, v16
    v_exp_f32 v17, v17
    v_mfma_f32_32x32x16_bf16 v[32:47], a[192:195], a[168:171], 0
    s_add_u32 s54, s52, 12288
    s_addc_u32 s55, s53, 0
    v_exp_f32 v18, v18
    v_exp_f32 v19, v19
    v_cvt_pk_bf16_f32 v48, v16, v17
    v_exp_f32 v20, v20
    v_exp_f32 v21, v21
    v_cvt_pk_bf16_f32 v49, v18, v19
    v_mfma_f32_32x32x16_bf16 v[32:47], a[196:199], a[172:175], v[32:47]
    s_mov_b32 m0, s62
    s_add_u32 s62, s62, 1024
    buffer_load_dwordx4 v5, s[40:43], s63 offen lds
    s_add_u32 s63, s63, 7168
    v_exp_f32 v22, v22
    v_exp_f32 v23, v23
    v_cvt_pk_bf16_f32 v50, v20, v21
    v_exp_f32 v24, v24
    v_exp_f32 v25, v25
    v_cvt_pk_bf16_f32 v51, v22, v23
    v_exp_f32 v26, v26
    v_exp_f32 v27, v27
    v_cvt_pk_bf16_f32 v52, v24, v25
    v_exp_f32 v28, v28
    v_exp_f32 v29, v29
    v_cvt_pk_bf16_f32 v53, v26, v27
    s_mov_b32 m0, s62
    s_add_u32 s62, s62, 1024
    buffer_load_dwordx4 v5, s[40:43], s63 offen lds
    s_add_u32 s63, s63, 7168
    v_exp_f32 v30, v30
    v_exp_f32 v31, v31
    v_cvt_pk_bf16_f32 v54, v28, v29
    v_exp_f32 v32, v32
    v_exp_f32 v33, v33
    v_cvt_pk_bf16_f32 v55, v30, v31
    v_mfma_f32_32x32x16_bf16 v[16:31], a[192:195], a[176:179], 0
    global_load_dwordx4 a[240:243], v2, s[54:55] offset:0 sc1
    v_exp_f32 v34, v34
    v_exp_f32 v35, v35
    v_cvt_pk_bf16_f32 v56, v32, v33
    v_exp_f32 v36, v36
    v_exp_f32 v37, v37
    v_cvt_pk_bf16_f32 v57, v34, v35
    v_mfma_f32_32x32x16_bf16 v[16:31], a[196:199], a[180:183], v[16:31]
    global_load_dwordx4 a[244:247], v2, s[54:55] offset:1024 sc1
    v_exp_f32 v38, v38
    v_exp_f32 v39, v39
    v_cvt_pk_bf16_f32 v58, v36, v37
    v_exp_f32 v40, v40
    v_exp_f32 v41, v41
    v_cvt_pk_bf16_f32 v59, v38, v39
    v_mfma_f32_32x32x16_bf16 a[0:15], a[200:203], v[48:51], 0
    global_load_dwordx4 a[248:251], v2, s[54:55] offset:2048 sc1
    v_exp_f32 v42, v42
    v_exp_f32 v43, v43
    v_cvt_pk_bf16_f32 v60, v40, v41
    v_exp_f32 v44, v44
    v_exp_f32 v45, v45
    v_cvt_pk_bf16_f32 v61, v42, v43
    v_mfma_f32_32x32x16_bf16 a[0:15], a[204:207], v[52:55], a[0:15]
    global_load_dwordx4 a[252:255], v2, s[54:55] offset:3072 sc1
    v_exp_f32 v46, v46
    v_exp_f32 v47, v47
    v_cvt_pk_bf16_f32 v62, v44, v45
    v_exp_f32 v16, v16
    v_exp_f32 v17, v17
    v_cvt_pk_bf16_f32 v63, v46, v47
    v_mfma_f32_32x32x16_bf16 v[32:47], a[192:195], a[184:187], 0
    v_exp_f32 v18, v18
    v_exp_f32 v19, v19
    v_cvt_pk_bf16_f32 v48, v16, v17
    v_exp_f32 v20, v20
    v_exp_f32 v21, v21
    v_cvt_pk_bf16_f32 v49, v18, v19
    v_mfma_f32_32x32x16_bf16 v[32:47], a[196:199], a[188:191], v[32:47]
    s_mov_b32 m0, s62
    s_add_u32 s62, s62, 1024
    buffer_load_dwordx4 v5, s[40:43], s63 offen lds
    s_add_u32 s63, s63, 7168
    v_exp_f32 v22, v22
    v_exp_f32 v23, v23
    v_cvt_pk_bf16_f32 v50, v20, v21
    v_exp_f32 v24, v24
    v_exp_f32 v25, v25
    v_cvt_pk_bf16_f32 v51, v22, v23
    v_mfma_f32_32x32x16_bf16 a[16:31], a[200:203], v[56:59], 0
    v_exp_f32 v26, v26
    v_exp_f32 v27, v27
    v_cvt_pk_bf16_f32 v52, v24, v25
    v_exp_f32 v28, v28
    v_exp_f32 v29, v29
    v_cvt_pk_bf16_f32 v53, v26, v27
    v_mfma_f32_32x32x16_bf16 a[16:31], a[204:207], v[60:63], a[16:31]
    s_mov_b32 m0, s62
    s_add_u32 s62, s62, 1024
    buffer_load_dwordx4 v5, s[40:43], s63 offen lds
    s_add_u32 s63, s63, 7168
    v_exp_f32 v30, v30
    v_exp_f32 v31, v31
    v_cvt_pk_bf16_f32 v54, v28, v29
    v_exp_f32 v32, v32
    v_exp_f32 v33, v33
    v_cvt_pk_bf16_f32 v55, v30, v31
    s_waitcnt vmcnt(16)
    v_mfma_f32_32x32x16_bf16 v[16:31], a[208:211], a[160:163], 0
    v_exp_f32 v34, v34
    v_exp_f32 v35, v35
    v_cvt_pk_bf16_f32 v56, v32, v33
    v_exp_f32 v36, v36
    v_exp_f32 v37, v37
    v_cvt_pk_bf16_f32 v57, v34, v35
    v_mfma_f32_32x32x16_bf16 v[16:31], a[212:215], a[164:167], v[16:31]
    s_mov_b32 m0, s62
    s_add_u32 s62, s62, 1024
    buffer_load_dwordx4 v5, s[40:43], s63 offen lds
    s_add_u32 s63, s63, 7168
    v_exp_f32 v38, v38
    v_exp_f32 v39, v39
    v_cvt_pk_bf16_f32 v58, v36, v37
    v_exp_f32 v40, v40
    v_exp_f32 v41, v41
    v_cvt_pk_bf16_f32 v59, v38, v39
    v_mfma_f32_32x32x16_bf16 a[32:47], a[200:203], v[48:51], 0
    v_exp_f32 v42, v42
    v_exp_f32 v43, v43
    v_cvt_pk_bf16_f32 v60, v40, v41
    v_exp_f32 v44, v44
    v_exp_f32 v45, v45
    v_cvt_pk_bf16_f32 v61, v42, v43
    v_mfma_f32_32x32x16_bf16 a[32:47], a[204:207], v[52:55], a[32:47]
    s_mov_b32 m0, s62
    s_add_u32 s62, s62, 1024
    buffer_load_dwordx4 v5, s[40:43], s63 offen lds
    s_add_u32 s63, s63, 7168
    v_exp_f32 v46, v46
    v_exp_f32 v47, v47
    v_cvt_pk_bf16_f32 v62, v44, v45
    v_exp_f32 v16, v16
    v_exp_f32 v17, v17
    v_cvt_pk_bf16_f32 v63, v46, v47
    v_mfma_f32_32x32x16_bf16 v[32:47], a[208:211], a[168:171], 0
    s_add_u32 s54, s54, 4096
    s_addc_u32 s55, s55, 0
    v_exp_f32 v18, v18
    v_exp_f32 v19, v19
    v_cvt_pk_bf16_f32 v48, v16, v17
    v_exp_f32 v20, v20
    v_exp_f32 v21, v21
    v_cvt_pk_bf16_f32 v49, v18, v19
    v_mfma_f32_32x32x16_bf16 v[32:47], a[212:215], a[172:175], v[32:47]
    s_mov_b32 m0, s62
    s_add_u32 s62, s62, 1024
    buffer_load_dwordx4 v5, s[40:43], s63 offen lds
    s_add_u32 s63, s63, 7168
    v_exp_f32 v22, v22
    v_exp_f32 v23, v23
    v_cvt_pk_bf16_f32 v50, v20, v21
    v_exp_f32 v24, v24
    v_exp_f32 v25, v25
    v_cvt_pk_bf16_f32 v51, v22, v23
    v_mfma_f32_32x32x16_bf16 a[48:63], a[200:203], v[56:59], 0
    v_exp_f32 v26, v26
    v_exp_f32 v27, v27
    v_cvt_pk_bf16_f32 v52, v24, v25
    v_exp_f32 v28, v28
    v_exp_f32 v29, v29
    v_cvt_pk_bf16_f32 v53, v26, v27
    v_mfma_f32_32x32x16_bf16 a[48:63], a[204:207], v[60:63], a[48:63]
    s_mov_b32 m0, s62
    s_add_u32 s62, s62, 1024
    buffer_load_dwordx4 v5, s[40:43], s63 offen lds
    s_add_u32 s63, s63, 7168
    v_exp_f32 v30, v30
    v_exp_f32 v31, v31
    v_cvt_pk_bf16_f32 v54, v28, v29
    v_exp_f32 v32, v32
    v_exp_f32 v33, v33
    v_cvt_pk_bf16_f32 v55, v30, v31
    v_mfma_f32_32x32x16_bf16 v[16:31], a[208:211], a[176:179], 0
    global_load_dwordx4 a[192:195], v2, s[54:55] offset:0 sc1
    v_exp_f32 v34, v34
    v_exp_f32 v35, v35
    v_cvt_pk_bf16_f32 v56, v32, v33
    v_exp_f32 v36, v36
    v_exp_f32 v37, v37
    v_cvt_pk_bf16_f32 v57, v34, v35
    v_mfma_f32_32x32x16_bf16 v[16:31], a[212:215], a[180:183], v[16:31]
    global_load_dwordx4 a[196:199], v2, s[54:55] offset:1024 sc1
    v_exp_f32 v38, v38
    v_exp_f32 v39, v39
    v_cvt_pk_bf16_f32 v58, v36, v37
    v_exp_f32 v40, v40
    v_exp_f32 v41, v41
    v_cvt_pk_bf16_f32 v59, v38, v39
    v_mfma_f32_32x32x16_bf16 a[0:15], a[216:219], v[48:51], a[0:15]
    global_load_dwordx4 a[200:203], v2, s[54:55] offset:2048 sc1
    v_exp_f32 v42, v42
    v_exp_f32 v43, v43
    v_cvt_pk_bf16_f32 v60, v40, v41
    v_exp_f32 v44, v44
    v_exp_f32 v45, v45
    v_cvt_pk_bf16_f32 v61, v42, v43
    v_mfma_f32_32x32x16_bf16 a[0:15], a[220:223], v[52:55], a[0:15]
    global_load_dwordx4 a[204:207], v2, s[54:55] offset:3072 sc1
    v_exp_f32 v46, v46
    v_exp_f32 v47, v47
    v_cvt_pk_bf16_f32 v62, v44, v45
    v_exp_f32 v16, v16
    v_exp_f32 v17, v17
    v_cvt_pk_bf16_f32 v63, v46, v47
    v_mfma_f32_32x32x16_bf16 v[32:47], a[208:211], a[184:187], 0
    v_exp_f32 v18, v18
    v_exp_f32 v19, v19
    v_cvt_pk_bf16_f32 v48, v16, v17
    v_exp_f32 v20, v20
    v_exp_f32 v21, v21
    v_cvt_pk_bf16_f32 v49, v18, v19
    v_mfma_f32_32x32x16_bf16 v[32:47], a[212:215], a[188:191], v[32:47]
    s_mov_b32 m0, s62
    s_add_u32 s62, s62, 1024
    buffer_load_dwordx4 v5, s[40:43], s63 offen lds
    s_add_u32 s63, s63, 7168
    v_exp_f32 v22, v22
    v_exp_f32 v23, v23
    v_cvt_pk_bf16_f32 v50, v20, v21
    v_exp_f32 v24, v24
    v_exp_f32 v25, v25
    v_cvt_pk_bf16_f32 v51, v22, v23
    v_mfma_f32_32x32x16_bf16 a[16:31], a[216:219], v[56:59], a[16:31]
    v_exp_f32 v26, v26
    v_exp_f32 v27, v27
    v_cvt_pk_bf16_f32 v52, v24, v25
    v_exp_f32 v28, v28
    v_exp_f32 v29, v29
    v_cvt_pk_bf16_f32 v53, v26, v27
    v_mfma_f32_32x32x16_bf16 a[16:31], a[220:223], v[60:63], a[16:31]
    s_mov_b32 m0, s62
    s_add_u32 s62, s62, 1024
    buffer_load_dwordx4 v5, s[40:43], s63 offen lds
    s_add_u32 s63, s63, 7168
    v_exp_f32 v30, v30
    v_exp_f32 v31, v31
    v_cvt_pk_bf16_f32 v54, v28, v29
    v_exp_f32 v32, v32
    v_exp_f32 v33, v33
    v_cvt_pk_bf16_f32 v55, v30, v31
    s_waitcnt vmcnt(22)
    v_mfma_f32_32x32x16_bf16 v[16:31], a[224:227], a[160:163], 0
    v_exp_f32 v34, v34
    v_exp_f32 v35, v35
    v_cvt_pk_bf16_f32 v56, v32, v33
    v_exp_f32 v36, v36
    v_exp_f32 v37, v37
    v_cvt_pk_bf16_f32 v57, v34, v35
    v_mfma_f32_32x32x16_bf16 v[16:31], a[228:231], a[164:167], v[16:31]
    s_mov_b32 m0, s62
    s_add_u32 s62, s62, 1024
    buffer_load_dwordx4 v5, s[40:43], s63 offen lds
    s_add_u32 s63, s63, 7168
    v_exp_f32 v38, v38
    v_exp_f32 v39, v39
    v_cvt_pk_bf16_f32 v58, v36, v37
    v_exp_f32 v40, v40
    v_exp_f32 v41, v41
    v_cvt_pk_bf16_f32 v59, v38, v39
    v_mfma_f32_32x32x16_bf16 a[32:47], a[216:219], v[48:51], a[32:47]
    v_exp_f32 v42, v42
    v_exp_f32 v43, v43
    v_cvt_pk_bf16_f32 v60, v40, v41
    v_exp_f32 v44, v44
    v_exp_f32 v45, v45
    v_cvt_pk_bf16_f32 v61, v42, v43
    v_mfma_f32_32x32x16_bf16 a[32:47], a[220:223], v[52:55], a[32:47]
    s_mov_b32 m0, s62
    s_add_u32 s62, s62, 1024
    buffer_load_dwordx4 v5, s[40:43], s63 offen lds
    s_add_u32 s63, s63, 7168
    v_exp_f32 v46, v46
    v_exp_f32 v47, v47
    v_cvt_pk_bf16_f32 v62, v44, v45
    v_exp_f32 v16, v16
    v_exp_f32 v17, v17
    v_cvt_pk_bf16_f32 v63, v46, v47
    v_mfma_f32_32x32x16_bf16 v[32:47], a[224:227], a[168:171], 0
    s_add_u32 s54, s54, 4096
    s_addc_u32 s55, s55, 0
    v_exp_f32 v18, v18
    v_exp_f32 v19, v19
    v_cvt_pk_bf16_f32 v48, v16, v17
    v_exp_f32 v20, v20
    v_exp_f32 v21, v21
    v_cvt_pk_bf16_f32 v49, v18, v19
    v_mfma_f32_32x32x16_bf16 v[32:47], a[228:231], a[172:175], v[32:47]
    s_mov_b32 m0, s62
    s_add_u32 s62, s62, 1024
    buffer_load_dwordx4 v5, s[40:43], s63 offen lds
    s_add_u32 s63, s63, 7168
    v_exp_f32 v22, v22
    v_exp_f32 v23, v23
    v_cvt_pk_bf16_f32 v50, v20, v21
    v_exp_f32 v24, v24
    v_exp_f32 v25, v25
    v_cvt_pk_bf16_f32 v51, v22, v23
    v_mfma_f32_32x32x16_bf16 a[48:63], a[216:219], v[56:59], a[48:63]
    v_exp_f32 v26, v26
    v_exp_f32 v27, v27
    v_cvt_pk_bf16_f32 v52, v24, v25
    v_exp_f32 v28, v28
    v_exp_f32 v29, v29
    v_cvt_pk_bf16_f32 v53, v26, v27
    v_mfma_f32_32x32x16_bf16 a[48:63], a[220:223], v[60:63], a[48:63]
    s_mov_b32 m0, s62
    s_add_u32 s62, s62, 1024
    buffer_load_dwordx4 v5, s[40:43], s63 offen lds
    s_add_u32 s63, s63, 7168
    v_exp_f32 v30, v30
    v_exp_f32 v31, v31
    v_cvt_pk_bf16_f32 v54, v28, v29
    v_exp_f32 v32, v32
    v_exp_f32 v33, v33
    v_cvt_pk_bf16_f32 v55, v30, v31
    v_mfma_f32_32x32x16_bf16 v[16:31], a[224:227], a[176:179], 0
    global_load_dwordx4 a[208:211], v2, s[54:55] offset:0 sc1
    v_exp_f32 v34, v34
    v_exp_f32 v35, v35
    v_cvt_pk_bf16_f32 v56, v32, v33
    v_exp_f32 v36, v36
    v_exp_f32 v37, v37
    v_cvt_pk_bf16_f32 v57, v34, v35
    v_mfma_f32_32x32x16_bf16 v[16:31], a[228:231], a[180:183], v[16:31]
    global_load_dwordx4 a[212:215], v2, s[54:55] offset:1024 sc1
    v_exp_f32 v38, v38
    v_exp_f32 v39, v39
    v_cvt_pk_bf16_f32 v58, v36, v37
    v_exp_f32 v40, v40
    v_exp_f32 v41, v41
    v_cvt_pk_bf16_f32 v59, v38, v39
    v_mfma_f32_32x32x16_bf16 a[0:15], a[232:235], v[48:51], a[0:15]
    global_load_dwordx4 a[216:219], v2, s[54:55] offset:2048 sc1
    v_exp_f32 v42, v42
    v_exp_f32 v43, v43
    v_cvt_pk_bf16_f32 v60, v40, v41
    v_exp_f32 v44, v44
    v_exp_f32 v45, v45
    v_cvt_pk_bf16_f32 v61, v42, v43
    v_mfma_f32_32x32x16_bf16 a[0:15], a[236:239], v[52:55], a[0:15]
    global_load_dwordx4 a[220:223], v2, s[54:55] offset:3072 sc1
    v_exp_f32 v46, v46
    v_exp_f32 v47, v47
    v_cvt_pk_bf16_f32 v62, v44, v45
    v_exp_f32 v16, v16
    v_exp_f32 v17, v17
    v_cvt_pk_bf16_f32 v63, v46, v47
    v_mfma_f32_32x32x16_bf16 v[32:47], a[224:227], a[184:187], 0
    v_exp_f32 v18, v18
    v_exp_f32 v19, v19
    v_cvt_pk_bf16_f32 v48, v16, v17
    v_exp_f32 v20, v20
    v_exp_f32 v21, v21
    v_cvt_pk_bf16_f32 v49, v18, v19
    v_mfma_f32_32x32x16_bf16 v[32:47], a[228:231], a[188:191], v[32:47]
    s_mov_b32 m0, s62
    s_add_u32 s62, s62, 1024
    buffer_load_dwordx4 v5, s[40:43], s63 offen lds
    s_add_u32 s63, s63, 7168
    v_exp_f32 v22, v22
    v_exp_f32 v23, v23
    v_cvt_pk_bf16_f32 v50, v20, v21
    v_exp_f32 v24, v24
    v_exp_f32 v25, v25
    v_cvt_pk_bf16_f32 v51, v22, v23
    v_mfma_f32_32x32x16_bf16 a[16:31], a[232:235], v[56:59], a[16:31]
    v_exp_f32 v26, v26
    v_exp_f32 v27, v27
    v_cvt_pk_bf16_f32 v52, v24, v25
    v_exp_f32 v28, v28
    v_exp_f32 v29, v29
    v_cvt_pk_bf16_f32 v53, v26, v27
    v_mfma_f32_32x32x16_bf16 a[16:31], a[236:239], v[60:63], a[16:31]
    s_mov_b32 m0, s62
    s_add_u32 s62, s62, 1024
    buffer_load_dwordx4 v5, s[40:43], s63 offen lds
    s_add_u32 s63, s63, 7168
    v_exp_f32 v30, v30
    v_exp_f32 v31, v31
    v_cvt_pk_bf16_f32 v54, v28, v29
    v_exp_f32 v32, v32
    v_exp_f32 v33, v33
    v_cvt_pk_bf16_f32 v55, v30, v31
    s_waitcnt vmcnt(22)
    v_mfma_f32_32x32x16_bf16 v[16:31], a[240:243], a[160:163], 0
    v_exp_f32 v34, v34
    v_exp_f32 v35, v35
    v_cvt_pk_bf16_f32 v56, v32, v33
    v_exp_f32 v36, v36
    v_exp_f32 v37, v37
    v_cvt_pk_bf16_f32 v57, v34, v35
    v_mfma_f32_32x32x16_bf16 v[16:31], a[244:247], a[164:167], v[16:31]
    s_mov_b32 m0, s62
    s_add_u32 s62, s62, 1024
    buffer_load_dwordx4 v5, s[40:43], s63 offen lds
    s_add_u32 s63, s63, 7168
    v_exp_f32 v38, v38
    v_exp_f32 v39, v39
    v_cvt_pk_bf16_f32 v58, v36, v37
    v_exp_f32 v40, v40
    v_exp_f32 v41, v41
    v_cvt_pk_bf16_f32 v59, v38, v39
    v_mfma_f32_32x32x16_bf16 a[32:47], a[232:235], v[48:51], a[32:47]
    v_exp_f32 v42, v42
    v_exp_f32 v43, v43
    v_cvt_pk_bf16_f32 v60, v40, v41
    v_exp_f32 v44, v44
    v_exp_f32 v45, v45
    v_cvt_pk_bf16_f32 v61, v42, v43
    v_mfma_f32_32x32x16_bf16 a[32:47], a[236:239], v[52:55], a[32:47]
    s_mov_b32 m0, s62
    s_add_u32 s62, s62, 1024
    buffer_load_dwordx4 v5, s[40:43], s63 offen lds
    s_add_u32 s63, s63, 7168
    v_exp_f32 v46, v46
    v_exp_f32 v47, v47
    v_cvt_pk_bf16_f32 v62, v44, v45
    v_exp_f32 v16, v16
    v_exp_f32 v17, v17
    v_cvt_pk_bf16_f32 v63, v46, v47
    v_mfma_f32_32x32x16_bf16 v[32:47], a[240:243], a[168:171], 0
    s_add_u32 s54, s54, 4096
    s_addc_u32 s55, s55, 0
    v_exp_f32 v18, v18
    v_exp_f32 v19, v19
    v_cvt_pk_bf16_f32 v48, v16, v17
    v_exp_f32 v20, v20
    v_exp_f32 v21, v21
    v_cvt_pk_bf16_f32 v49, v18, v19
    v_mfma_f32_32x32x16_bf16 v[32:47], a[244:247], a[172:175], v[32:47]
    s_mov_b32 m0, s62
    s_add_u32 s62, s62, 1024
    buffer_load_dwordx4 v5, s[40:43], s63 offen lds
    s_add_u32 s63, s63, 7168
    v_exp_f32 v22, v22
    v_exp_f32 v23, v23
    v_cvt_pk_bf16_f32 v50, v20, v21
    v_exp_f32 v24, v24
    v_exp_f32 v25, v25
    v_cvt_pk_bf16_f32 v51, v22, v23
    v_mfma_f32_32x32x16_bf16 a[48:63], a[232:235], v[56:59], a[48:63]
    v_exp_f32 v26, v26
    v_exp_f32 v27, v27
    v_cvt_pk_bf16_f32 v52, v24, v25
    v_exp_f32 v28, v28
    v_exp_f32 v29, v29
    v_cvt_pk_bf16_f32 v53, v26, v27
    v_mfma_f32_32x32x16_bf16 a[48:63], a[236:239], v[60:63], a[48:63]
    s_mov_b32 m0, s62
    s_add_u32 s62, s62, 1024
    buffer_load_dwordx4 v5, s[40:43], s63 offen lds
    s_add_u32 s63, s63, 7168
    v_exp_f32 v30, v30
    v_exp_f32 v31, v31
    v_cvt_pk_bf16_f32 v54, v28, v29
    v_exp_f32 v32, v32
    v_exp_f32 v33, v33
    v_cvt_pk_bf16_f32 v55, v30, v31
    v_mfma_f32_32x32x16_bf16 v[16:31], a[240:243], a[176:179], 0
    global_load_dwordx4 a[224:227], v2, s[54:55] offset:0 sc1
    v_exp_f32 v34, v34
    v_exp_f32 v35, v35
    v_cvt_pk_bf16_f32 v56, v32, v33
    v_exp_f32 v36, v36
    v_exp_f32 v37, v37
    v_cvt_pk_bf16_f32 v57, v34, v35
    v_mfma_f32_32x32x16_bf16 v[16:31], a[244:247], a[180:183], v[16:31]
    global_load_dwordx4 a[228:231], v2, s[54:55] offset:1024 sc1
    v_exp_f32 v38, v38
    v_exp_f32 v39, v39
    v_cvt_pk_bf16_f32 v58, v36, v37
    v_exp_f32 v40, v40
    v_exp_f32 v41, v41
    v_cvt_pk_bf16_f32 v59, v38, v39
    v_mfma_f32_32x32x16_bf16 a[0:15], a[248:251], v[48:51], a[0:15]
    global_load_dwordx4 a[232:235], v2, s[54:55] offset:2048 sc1
    v_exp_f32 v42, v42
    v_exp_f32 v43, v43
    v_cvt_pk_bf16_f32 v60, v40, v41
    v_exp_f32 v44, v44
    v_exp_f32 v45, v45
    v_cvt_pk_bf16_f32 v61, v42, v43
    v_mfma_f32_32x32x16_bf16 a[0:15], a[252:255], v[52:55], a[0:15]
    global_load_dwordx4 a[236:239], v2, s[54:55] offset:3072 sc1
    v_exp_f32 v46, v46
    v_exp_f32 v47, v47
    v_cvt_pk_bf16_f32 v62, v44, v45
    v_exp_f32 v16, v16
    v_exp_f32 v17, v17
    v_cvt_pk_bf16_f32 v63, v46, v47
    v_mfma_f32_32x32x16_bf16 v[32:47], a[240:243], a[184:187], 0
    v_exp_f32 v18, v18
    v_exp_f32 v19, v19
    v_cvt_pk_bf16_f32 v48, v16, v17
    v_exp_f32 v20, v20
    v_exp_f32 v21, v21
    v_cvt_pk_bf16_f32 v49, v18, v19
    v_mfma_f32_32x32x16_bf16 v[32:47], a[244:247], a[188:191], v[32:47]
    s_mov_b32 m0, s62
    s_add_u32 s62, s62, 1024
    buffer_load_dwordx4 v5, s[40:43], s63 offen lds
    s_add_u32 s63, s63, 7168
    v_exp_f32 v22, v22
    v_exp_f32 v23, v23
    v_cvt_pk_bf16_f32 v50, v20, v21
    v_exp_f32 v24, v24
    v_exp_f32 v25, v25
    v_cvt_pk_bf16_f32 v51, v22, v23
    v_mfma_f32_32x32x16_bf16 a[16:31], a[248:251], v[56:59], a[16:31]
    v_exp_f32 v26, v26
    v_exp_f32 v27, v27
    v_cvt_pk_bf16_f32 v52, v24, v25
    v_exp_f32 v28, v28
    v_exp_f32 v29, v29
    v_cvt_pk_bf16_f32 v53, v26, v27
    v_mfma_f32_32x32x16_bf16 a[16:31], a[252:255], v[60:63], a[16:31]
    s_mov_b32 m0, s62
    s_add_u32 s62, s62, 1024
    buffer_load_dwordx4 v5, s[40:43], s63 offen lds
    s_add_u32 s63, s63, 7168
    v_exp_f32 v30, v30
    v_exp_f32 v31, v31
    v_cvt_pk_bf16_f32 v54, v28, v29
    v_exp_f32 v32, v32
    v_exp_f32 v33, v33
    v_cvt_pk_bf16_f32 v55, v30, v31
    s_waitcnt vmcnt(22)
    v_mfma_f32_32x32x16_bf16 v[16:31], a[192:195], a[160:163], 0
    v_exp_f32 v34, v34
    v_exp_f32 v35, v35
    v_cvt_pk_bf16_f32 v56, v32, v33
    v_exp_f32 v36, v36
    v_exp_f32 v37, v37
    v_cvt_pk_bf16_f32 v57, v34, v35
    v_mfma_f32_32x32x16_bf16 v[16:31], a[196:199], a[164:167], v[16:31]
    s_mov_b32 m0, s62
    s_add_u32 s62, s62, 1024
    buffer_load_dwordx4 v5, s[40:43], s63 offen lds
    s_add_u32 s63, s63, 7168
    v_exp_f32 v38, v38
    v_exp_f32 v39, v39
    v_cvt_pk_bf16_f32 v58, v36, v37
    v_exp_f32 v40, v40
    v_exp_f32 v41, v41
    v_cvt_pk_bf16_f32 v59, v38, v39
    v_mfma_f32_32x32x16_bf16 a[32:47], a[248:251], v[48:51], a[32:47]
    v_exp_f32 v42, v42
    v_exp_f32 v43, v43
    v_cvt_pk_bf16_f32 v60, v40, v41
    v_exp_f32 v44, v44
    v_exp_f32 v45, v45
    v_cvt_pk_bf16_f32 v61, v42, v43
    v_mfma_f32_32x32x16_bf16 a[32:47], a[252:255], v[52:55], a[32:47]
    s_mov_b32 m0, s62
    s_add_u32 s62, s62, 1024
    buffer_load_dwordx4 v5, s[40:43], s63 offen lds
    s_add_u32 s63, s63, 7168
    v_exp_f32 v46, v46
    v_exp_f32 v47, v47
    v_cvt_pk_bf16_f32 v62, v44, v45
    s_mov_b64 exec, 1
    global_store_dword v7, v14, s[34:35] sc1
    s_mov_b64 exec, -1
    v_exp_f32 v16, v16
    v_exp_f32 v17, v17
    v_cvt_pk_bf16_f32 v63, v46, v47
    v_mfma_f32_32x32x16_bf16 v[32:47], a[192:195], a[168:171], 0
    s_add_u32 s54, s54, 4096
    s_addc_u32 s55, s55, 0
    v_exp_f32 v18, v18
    v_exp_f32 v19, v19
    v_cvt_pk_bf16_f32 v48, v16, v17
    v_exp_f32 v20, v20
    v_exp_f32 v21, v21
    v_cvt_pk_bf16_f32 v49, v18, v19
    v_mfma_f32_32x32x16_bf16 v[32:47], a[196:199], a[172:175], v[32:47]
    v_exp_f32 v22, v22
    v_exp_f32 v23, v23
    v_cvt_pk_bf16_f32 v50, v20, v21
    v_exp_f32 v24, v24
    v_exp_f32 v25, v25
    v_cvt_pk_bf16_f32 v51, v22, v23
    v_mfma_f32_32x32x16_bf16 a[48:63], a[248:251], v[56:59], a[48:63]
    v_exp_f32 v26, v26
    v_exp_f32 v27, v27
    v_cvt_pk_bf16_f32 v52, v24, v25
    v_exp_f32 v28, v28
    v_exp_f32 v29, v29
    v_cvt_pk_bf16_f32 v53, v26, v27
    v_mfma_f32_32x32x16_bf16 a[48:63], a[252:255], v[60:63], a[48:63]
    s_waitcnt vmcnt(1)
    ds_read_b64_tr_b16 v[192:193], v8 offset:16384
    ds_read_b64_tr_b16 v[194:195], v8 offset:17408
    ds_read_b64_tr_b16 v[196:197], v9 offset:16384
    ds_read_b64_tr_b16 v[198:199], v9 offset:17408
    v_exp_f32 v30, v30
    v_exp_f32 v31, v31
    v_cvt_pk_bf16_f32 v54, v28, v29
    v_exp_f32 v32, v32
    v_exp_f32 v33, v33
    v_cvt_pk_bf16_f32 v55, v30, v31
    v_mfma_f32_32x32x16_bf16 v[16:31], a[192:195], a[176:179], 0
    global_load_dwordx4 a[240:243], v2, s[54:55] offset:0 sc1
    v_exp_f32 v34, v34
    v_exp_f32 v35, v35
    v_cvt_pk_bf16_f32 v56, v32, v33
    v_exp_f32 v36, v36
    v_exp_f32 v37, v37
    v_cvt_pk_bf16_f32 v57, v34, v35
    v_mfma_f32_32x32x16_bf16 v[16:31], a[196:199], a[180:183], v[16:31]
    global_load_dwordx4 a[244:247], v2, s[54:55] offset:1024 sc1
    v_exp_f32 v38, v38
    v_exp_f32 v39, v39
    v_cvt_pk_bf16_f32 v58, v36, v37
    v_exp_f32 v40, v40
    v_exp_f32 v41, v41
    v_cvt_pk_bf16_f32 v59, v38, v39
    v_mfma_f32_32x32x16_bf16 a[0:15], a[200:203], v[48:51], a[0:15]
    global_load_dwordx4 a[248:251], v2, s[54:55] offset:2048 sc1
    v_exp_f32 v42, v42
    v_exp_f32 v43, v43
    v_cvt_pk_bf16_f32 v60, v40, v41
    v_exp_f32 v44, v44
    v_exp_f32 v45, v45
    v_cvt_pk_bf16_f32 v61, v42, v43
    v_mfma_f32_32x32x16_bf16 a[0:15], a[204:207], v[52:55], a[0:15]
    global_load_dwordx4 a[252:255], v2, s[54:55] offset:3072 sc1
    v_exp_f32 v46, v46
    v_exp_f32 v47, v47
    v_cvt_pk_bf16_f32 v62, v44, v45
    v_exp_f32 v16, v16
    v_exp_f32 v17, v17
    v_cvt_pk_bf16_f32 v63, v46, v47
    v_mfma_f32_32x32x16_bf16 v[32:47], a[192:195], a[184:187], 0
    ds_read_b64_tr_b16 v[200:201], v8 offset:18432
    ds_read_b64_tr_b16 v[202:203], v8 offset:19456
    v_exp_f32 v18, v18
    v_exp_f32 v19, v19
    v_cvt_pk_bf16_f32 v48, v16, v17
    v_exp_f32 v20, v20
    v_exp_f32 v21, v21
    v_cvt_pk_bf16_f32 v49, v18, v19
    v_mfma_f32_32x32x16_bf16 v[32:47], a[196:199], a[188:191], v[32:47]
    ds_read_b64_tr_b16 v[204:205], v9 offset:18432
    ds_read_b64_tr_b16 v[206:207], v9 offset:19456
    v_exp_f32 v22, v22
    v_exp_f32 v23, v23
    v_cvt_pk_bf16_f32 v50, v20, v21
    v_exp_f32 v24, v24
    v_exp_f32 v25, v25
    v_cvt_pk_bf16_f32 v51, v22, v23
    v_mfma_f32_32x32x16_bf16 a[16:31], a[200:203], v[56:59], a[16:31]
    v_exp_f32 v26, v26
    v_exp_f32 v27, v27
    v_cvt_pk_bf16_f32 v52, v24, v25
    v_exp_f32 v28, v28
    v_exp_f32 v29, v29
    v_cvt_pk_bf16_f32 v53, v26, v27
    v_mfma_f32_32x32x16_bf16 a[16:31], a[204:207], v[60:63], a[16:31]
    ds_read_b64_tr_b16 v[208:209], v8 offset:20480
    ds_read_b64_tr_b16 v[210:211], v8 offset:21504
    v_exp_f32 v30, v30
    v_exp_f32 v31, v31
    v_cvt_pk_bf16_f32 v54, v28, v29
    v_exp_f32 v32, v32
    v_exp_f32 v33, v33
    v_cvt_pk_bf16_f32 v55, v30, v31
    s_waitcnt vmcnt(19)
    v_mfma_f32_32x32x16_bf16 v[16:31], a[208:211], a[160:163], 0
    ds_read_b64_tr_b16 v[212:213], v9 offset:20480
    ds_read_b64_tr_b16 v[214:215], v9 offset:21504
    v_exp_f32 v34, v34
    v_exp_f32 v35, v35
    v_cvt_pk_bf16_f32 v56, v32, v33
    v_exp_f32 v36, v36
    v_exp_f32 v37, v37
    v_cvt_pk_bf16_f32 v57, v34, v35
    v_mfma_f32_32x32x16_bf16 v[16:31], a[212:215], a[164:167], v[16:31]
    ds_read_b64_tr_b16 v[216:217], v8 offset:22528
    ds_read_b64_tr_b16 v[218:219], v8 offset:23552
    v_exp_f32 v38, v38
    v_exp_f32 v39, v39
    v_cvt_pk_bf16_f32 v58, v36, v37
    v_exp_f32 v40, v40
    v_exp_f32 v41, v41
    v_cvt_pk_bf16_f32 v59, v38, v39
    v_mfma_f32_32x32x16_bf16 a[32:47], a[200:203], v[48:51], a[32:47]
    v_exp_f32 v42, v42
    v_exp_f32 v43, v43
    v_cvt_pk_bf16_f32 v60, v40, v41
    v_exp_f32 v44, v44
    v_exp_f32 v45, v45
    v_cvt_pk_bf16_f32 v61, v42, v43
    v_mfma_f32_32x32x16_bf16 a[32:47], a[204:207], v[52:55], a[32:47]
    ds_read_b64_tr_b16 v[220:221], v9 offset:22528
    ds_read_b64_tr_b16 v[222:223], v9 offset:23552
    v_exp_f32 v46, v46
    v_exp_f32 v47, v47
    v_cvt_pk_bf16_f32 v62, v44, v45
    v_exp_f32 v16, v16
    v_exp_f32 v17, v17
    v_cvt_pk_bf16_f32 v63, v46, v47
    v_mfma_f32_32x32x16_bf16 v[32:47], a[208:211], a[168:171], 0
    s_add_u32 s54, s54, 4096
    s_addc_u32 s55, s55, 0
    v_exp_f32 v18, v18
    v_exp_f32 v19, v19
    v_cvt_pk_bf16_f32 v48, v16, v17
    v_exp_f32 v20, v20
    v_exp_f32 v21, v21
    v_cvt_pk_bf16_f32 v49, v18, v19
    v_mfma_f32_32x32x16_bf16 v[32:47], a[212:215], a[172:175], v[32:47]
    v_exp_f32 v22, v22
    v_exp_f32 v23, v23
    v_cvt_pk_bf16_f32 v50, v20, v21
    v_exp_f32 v24, v24
    v_exp_f32 v25, v25
    v_cvt_pk_bf16_f32 v51, v22, v23
    v_mfma_f32_32x32x16_bf16 a[48:63], a[200:203], v[56:59], a[48:63]
    v_exp_f32 v26, v26
    v_exp_f32 v27, v27
    v_cvt_pk_bf16_f32 v52, v24, v25
    v_exp_f32 v28, v28
    v_exp_f32 v29, v29
    v_cvt_pk_bf16_f32 v53, v26, v27
    v_mfma_f32_32x32x16_bf16 a[48:63], a[204:207], v[60:63], a[48:63]
    ds_read_b64_tr_b16 v[224:225], v8 offset:24576
    ds_read_b64_tr_b16 v[226:227], v8 offset:25600
    ds_read_b64_tr_b16 v[228:229], v9 offset:24576
    ds_read_b64_tr_b16 v[230:231], v9 offset:25600
    v_exp_f32 v30, v30
    v_exp_f32 v31, v31
    v_cvt_pk_bf16_f32 v54, v28, v29
    v_exp_f32 v32, v32
    v_exp_f32 v33, v33
    v_cvt_pk_bf16_f32 v55, v30, v31
    v_mfma_f32_32x32x16_bf16 v[16:31], a[208:211], a[176:179], 0
    global_load_dwordx4 a[192:195], v2, s[54:55] offset:0 sc1
    v_exp_f32 v34, v34
    v_exp_f32 v35, v35
    v_cvt_pk_bf16_f32 v56, v32, v33
    v_exp_f32 v36, v36
    v_exp_f32 v37, v37
    v_cvt_pk_bf16_f32 v57, v34, v35
    v_mfma_f32_32x32x16_bf16 v[16:31], a[212:215], a[180:183], v[16:31]
    global_load_dwordx4 a[196:199], v2, s[54:55] offset:1024 sc1
    v_exp_f32 v38, v38
    v_exp_f32 v39, v39
    v_cvt_pk_bf16_f32 v58, v36, v37
    v_exp_f32 v40, v40
    v_exp_f32 v41, v41
    v_cvt_pk_bf16_f32 v59, v38, v39
    v_mfma_f32_32x32x16_bf16 a[0:15], a[216:219], v[48:51], a[0:15]
    global_load_dwordx4 a[200:203], v2, s[54:55] offset:2048 sc1
    v_exp_f32 v42, v42
    v_exp_f32 v43, v43
    v_cvt_pk_bf16_f32 v60, v40, v41
    v_exp_f32 v44, v44
    v_exp_f32 v45, v45
    v_cvt_pk_bf16_f32 v61, v42, v43
    v_mfma_f32_32x32x16_bf16 a[0:15], a[220:223], v[52:55], a[0:15]
    global_load_dwordx4 a[204:207], v2, s[54:55] offset:3072 sc1
    v_exp_f32 v46, v46
    v_exp_f32 v47, v47
    v_cvt_pk_bf16_f32 v62, v44, v45
    v_exp_f32 v16, v16
    v_exp_f32 v17, v17
    v_cvt_pk_bf16_f32 v63, v46, v47
    v_mfma_f32_32x32x16_bf16 v[32:47], a[208:211], a[184:187], 0
    ds_read_b64_tr_b16 v[232:233], v8 offset:26624
    ds_read_b64_tr_b16 v[234:235], v8 offset:27648
    v_exp_f32 v18, v18
    v_exp_f32 v19, v19
    v_cvt_pk_bf16_f32 v48, v16, v17
    v_exp_f32 v20, v20
    v_exp_f32 v21, v21
    v_cvt_pk_bf16_f32 v49, v18, v19
    v_mfma_f32_32x32x16_bf16 v[32:47], a[212:215], a[188:191], v[32:47]
    ds_read_b64_tr_b16 v[236:237], v9 offset:26624
    ds_read_b64_tr_b16 v[238:239], v9 offset:27648
    v_exp_f32 v22, v22
    v_exp_f32 v23, v23
    v_cvt_pk_bf16_f32 v50, v20, v21
    v_exp_f32 v24, v24
    v_exp_f32 v25, v25
    v_cvt_pk_bf16_f32 v51, v22, v23
    v_mfma_f32_32x32x16_bf16 a[16:31], a[216:219], v[56:59], a[16:31]
    v_exp_f32 v26, v26
    v_exp_f32 v27, v27
    v_cvt_pk_bf16_f32 v52, v24, v25
    v_exp_f32 v28, v28
    v_exp_f32 v29, v29
    v_cvt_pk_bf16_f32 v53, v26, v27
    v_mfma_f32_32x32x16_bf16 a[16:31], a[220:223], v[60:63], a[16:31]
    ds_read_b64_tr_b16 v[240:241], v8 offset:28672
    ds_read_b64_tr_b16 v[242:243], v8 offset:29696
    v_exp_f32 v30, v30
    v_exp_f32 v31, v31
    v_cvt_pk_bf16_f32 v54, v28, v29
    v_exp_f32 v32, v32
    v_exp_f32 v33, v33
    v_cvt_pk_bf16_f32 v55, v30, v31
    s_waitcnt vmcnt(13)
    v_mfma_f32_32x32x16_bf16 v[16:31], a[224:227], a[160:163], 0
    ds_read_b64_tr_b16 v[244:245], v9 offset:28672
    ds_read_b64_tr_b16 v[246:247], v9 offset:29696
    v_exp_f32 v34, v34
    v_exp_f32 v35, v35
    v_cvt_pk_bf16_f32 v56, v32, v33
    v_exp_f32 v36, v36
    v_exp_f32 v37, v37
    v_cvt_pk_bf16_f32 v57, v34, v35
    v_mfma_f32_32x32x16_bf16 v[16:31], a[228:231], a[164:167], v[16:31]
    ds_read_b64_tr_b16 v[248:249], v8 offset:30720
    ds_read_b64_tr_b16 v[250:251], v8 offset:31744
    v_exp_f32 v38, v38
    v_exp_f32 v39, v39
    v_cvt_pk_bf16_f32 v58, v36, v37
    v_exp_f32 v40, v40
    v_exp_f32 v41, v41
    v_cvt_pk_bf16_f32 v59, v38, v39
    v_mfma_f32_32x32x16_bf16 a[32:47], a[216:219], v[48:51], a[32:47]
    v_exp_f32 v42, v42
    v_exp_f32 v43, v43
    v_cvt_pk_bf16_f32 v60, v40, v41
    v_exp_f32 v44, v44
    v_exp_f32 v45, v45
    v_cvt_pk_bf16_f32 v61, v42, v43
    v_mfma_f32_32x32x16_bf16 a[32:47], a[220:223], v[52:55], a[32:47]
    ds_read_b64_tr_b16 v[252:253], v9 offset:30720
    ds_read_b64_tr_b16 v[254:255], v9 offset:31744
    v_exp_f32 v46, v46
    v_exp_f32 v47, v47
    v_cvt_pk_bf16_f32 v62, v44, v45
    v_exp_f32 v16, v16
    v_exp_f32 v17, v17
    v_cvt_pk_bf16_f32 v63, v46, v47
    v_mfma_f32_32x32x16_bf16 v[32:47], a[224:227], a[168:171], 0
    s_add_u32 s54, s54, 4096
    s_addc_u32 s55, s55, 0
    v_exp_f32 v18, v18
    v_exp_f32 v19, v19
    v_cvt_pk_bf16_f32 v48, v16, v17
    v_exp_f32 v20, v20
    v_exp_f32 v21, v21
    v_cvt_pk_bf16_f32 v49, v18, v19
    v_mfma_f32_32x32x16_bf16 v[32:47], a[228:231], a[172:175], v[32:47]
    v_exp_f32 v22, v22
    v_exp_f32 v23, v23
    v_cvt_pk_bf16_f32 v50, v20, v21
    v_exp_f32 v24, v24
    v_exp_f32 v25, v25
    v_cvt_pk_bf16_f32 v51, v22, v23
    v_mfma_f32_32x32x16_bf16 a[48:63], a[216:219], v[56:59], a[48:63]
    v_exp_f32 v26, v26
    v_exp_f32 v27, v27
    v_cvt_pk_bf16_f32 v52, v24, v25
    v_exp_f32 v28, v28
    v_exp_f32 v29, v29
    v_cvt_pk_bf16_f32 v53, v26, v27
    v_mfma_f32_32x32x16_bf16 a[48:63], a[220:223], v[60:63], a[48:63]
    s_waitcnt lgkmcnt(0)
    s_add_u32 m0, s61, 16384
    s_add_u32 s99, s97, 172032
    buffer_load_dwordx4 v5, s[40:43], s99 offen lds
    s_add_u32 m0, s61, 17408
    s_add_u32 s99, s97, 179200
    buffer_load_dwordx4 v5, s[40:43], s99 offen lds
    v_exp_f32 v30, v30
    v_exp_f32 v31, v31
    v_cvt_pk_bf16_f32 v54, v28, v29
    v_exp_f32 v32, v32
    v_exp_f32 v33, v33
    v_cvt_pk_bf16_f32 v55, v30, v31
    v_mfma_f32_32x32x16_bf16 v[16:31], a[224:227], a[176:179], 0
    global_load_dwordx4 a[208:211], v2, s[54:55] offset:0 sc1
    v_exp_f32 v34, v34
    v_exp_f32 v35, v35
    v_cvt_pk_bf16_f32 v56, v32, v33
    v_exp_f32 v36, v36
    v_exp_f32 v37, v37
    v_cvt_pk_bf16_f32 v57, v34, v35
    v_mfma_f32_32x32x16_bf16 v[16:31], a[228:231], a[180:183], v[16:31]
    global_load_dwordx4 a[212:215], v2, s[54:55] offset:1024 sc1
    v_exp_f32 v38, v38
    v_exp_f32 v39, v39
    v_cvt_pk_bf16_f32 v58, v36, v37
    v_exp_f32 v40, v40
    v_exp_f32 v41, v41
    v_cvt_pk_bf16_f32 v59, v38, v39
    v_mfma_f32_32x32x16_bf16 a[0:15], a[232:235], v[48:51], a[0:15]
    global_load_dwordx4 a[216:219], v2, s[54:55] offset:2048 sc1
    v_exp_f32 v42, v42
    v_exp_f32 v43, v43
    v_cvt_pk_bf16_f32 v60, v40, v41
    v_exp_f32 v44, v44
    v_exp_f32 v45, v45
    v_cvt_pk_bf16_f32 v61, v42, v43
    v_mfma_f32_32x32x16_bf16 a[0:15], a[236:239], v[52:55], a[0:15]
    global_load_dwordx4 a[220:223], v2, s[54:55] offset:3072 sc1
    global_load_dword v4, v3, s[34:35] sc1
    v_exp_f32 v46, v46
    v_exp_f32 v47, v47
    v_cvt_pk_bf16_f32 v62, v44, v45
    v_exp_f32 v16, v16
    v_exp_f32 v17, v17
    v_cvt_pk_bf16_f32 v63, v46, v47
    v_mfma_f32_32x32x16_bf16 v[32:47], a[224:227], a[184:187], 0
    s_add_u32 m0, s61, 18432
    s_add_u32 s99, s97, 186368
    buffer_load_dwordx4 v5, s[40:43], s99 offen lds
    v_exp_f32 v18, v18
    v_exp_f32 v19, v19
    v_cvt_pk_bf16_f32 v48, v16, v17
    v_exp_f32 v20, v20
    v_exp_f32 v21, v21
    v_cvt_pk_bf16_f32 v49, v18, v19
    v_mfma_f32_32x32x16_bf16 v[32:47], a[228:231], a[188:191], v[32:47]
    s_add_u32 m0, s61, 19456
    s_add_u32 s99, s97, 193536
    buffer_load_dwordx4 v5, s[40:43], s99 offen lds
    v_exp_f32 v22, v22
    v_exp_f32 v23, v23
    v_cvt_pk_bf16_f32 v50, v20, v21
    v_exp_f32 v24, v24
    v_exp_f32 v25, v25
    v_cvt_pk_bf16_f32 v51, v22, v23
    v_mfma_f32_32x32x16_bf16 a[16:31], a[232:235], v[56:59], a[16:31]
    v_exp_f32 v26, v26
    v_exp_f32 v27, v27
    v_cvt_pk_bf16_f32 v52, v24, v25
    v_exp_f32 v28, v28
    v_exp_f32 v29, v29
    v_cvt_pk_bf16_f32 v53, v26, v27
    v_mfma_f32_32x32x16_bf16 a[16:31], a[236:239], v[60:63], a[16:31]
    s_add_u32 m0, s61, 20480
    s_add_u32 s99, s97, 200704
    buffer_load_dwordx4 v5, s[40:43], s99 offen lds
    v_exp_f32 v30, v30
    v_exp_f32 v31, v31
    v_cvt_pk_bf16_f32 v54, v28, v29
    v_exp_f32 v32, v32
    v_exp_f32 v33, v33
    v_cvt_pk_bf16_f32 v55, v30, v31
    s_waitcnt vmcnt(14)
    v_mfma_f32_32x32x16_bf16 v[16:31], a[240:243], a[160:163], 0
    s_add_u32 m0, s61, 21504
    s_add_u32 s99, s97, 207872
    buffer_load_dwordx4 v5, s[40:43], s99 offen lds
    v_exp_f32 v34, v34
    v_exp_f32 v35, v35
    v_cvt_pk_bf16_f32 v56, v32, v33
    v_exp_f32 v36, v36
    v_exp_f32 v37, v37
    v_cvt_pk_bf16_f32 v57, v34, v35
    v_mfma_f32_32x32x16_bf16 v[16:31], a[244:247], a[164:167], v[16:31]
    s_add_u32 m0, s61, 22528
    s_add_u32 s99, s97, 215040
    buffer_load_dwordx4 v5, s[40:43], s99 offen lds
    v_exp_f32 v38, v38
    v_exp_f32 v39, v39
    v_cvt_pk_bf16_f32 v58, v36, v37
    v_exp_f32 v40, v40
    v_exp_f32 v41, v41
    v_cvt_pk_bf16_f32 v59, v38, v39
    v_mfma_f32_32x32x16_bf16 a[32:47], a[232:235], v[48:51], a[32:47]
    v_exp_f32 v42, v42
    v_exp_f32 v43, v43
    v_cvt_pk_bf16_f32 v60, v40, v41
    v_exp_f32 v44, v44
    v_exp_f32 v45, v45
    v_cvt_pk_bf16_f32 v61, v42, v43
    v_mfma_f32_32x32x16_bf16 a[32:47], a[236:239], v[52:55], a[32:47]
    s_add_u32 m0, s61, 23552
    s_add_u32 s99, s97, 222208
    buffer_load_dwordx4 v5, s[40:43], s99 offen lds
    v_exp_f32 v46, v46
    v_exp_f32 v47, v47
    v_cvt_pk_bf16_f32 v62, v44, v45
    v_exp_f32 v16, v16
    v_exp_f32 v17, v17
    v_cvt_pk_bf16_f32 v63, v46, v47
    v_mfma_f32_32x32x16_bf16 v[32:47], a[240:243], a[168:171], 0
    s_add_u32 s54, s54, 4096
    s_addc_u32 s55, s55, 0
    v_exp_f32 v18, v18
    v_exp_f32 v19, v19
    v_cvt_pk_bf16_f32 v48, v16, v17
    v_exp_f32 v20, v20
    v_exp_f32 v21, v21
    v_cvt_pk_bf16_f32 v49, v18, v19
    v_mfma_f32_32x32x16_bf16 v[32:47], a[244:247], a[172:175], v[32:47]
    v_exp_f32 v22, v22
    v_exp_f32 v23, v23
    v_cvt_pk_bf16_f32 v50, v20, v21
    v_exp_f32 v24, v24
    v_exp_f32 v25, v25
    v_cvt_pk_bf16_f32 v51, v22, v23
    v_mfma_f32_32x32x16_bf16 a[48:63], a[232:235], v[56:59], a[48:63]
    v_exp_f32 v26, v26
    v_exp_f32 v27, v27
    v_cvt_pk_bf16_f32 v52, v24, v25
    v_exp_f32 v28, v28
    v_exp_f32 v29, v29
    v_cvt_pk_bf16_f32 v53, v26, v27
    v_mfma_f32_32x32x16_bf16 a[48:63], a[236:239], v[60:63], a[48:63]
    s_add_u32 m0, s61, 24576
    s_add_u32 s99, s97, 229376
    buffer_load_dwordx4 v5, s[40:43], s99 offen lds
    s_add_u32 m0, s61, 25600
    s_add_u32 s99, s97, 236544
    buffer_load_dwordx4 v5, s[40:43], s99 offen lds
    v_exp_f32 v30, v30
    v_exp_f32 v31, v31
    v_cvt_pk_bf16_f32 v54, v28, v29
    v_exp_f32 v32, v32
    v_exp_f32 v33, v33
    v_cvt_pk_bf16_f32 v55, v30, v31
    v_mfma_f32_32x32x16_bf16 v[16:31], a[240:243], a[176:179], 0
    global_load_dwordx4 a[224:227], v2, s[54:55] offset:0 sc1
    v_exp_f32 v34, v34
    v_exp_f32 v35, v35
    v_cvt_pk_bf16_f32 v56, v32, v33
    v_exp_f32 v36, v36
    v_exp_f32 v37, v37
    v_cvt_pk_bf16_f32 v57, v34, v35
    v_mfma_f32_32x32x16_bf16 v[16:31], a[244:247], a[180:183], v[16:31]
    global_load_dwordx4 a[228:231], v2, s[54:55] offset:1024 sc1
    v_exp_f32 v38, v38
    v_exp_f32 v39, v39
    v_cvt_pk_bf16_f32 v58, v36, v37
    v_exp_f32 v40, v40
    v_exp_f32 v41, v41
    v_cvt_pk_bf16_f32 v59, v38, v39
    v_mfma_f32_32x32x16_bf16 a[0:15], a[248:251], v[48:51], a[0:15]
    global_load_dwordx4 a[232:235], v2, s[54:55] offset:2048 sc1
    v_exp_f32 v42, v42
    v_exp_f32 v43, v43
    v_cvt_pk_bf16_f32 v60, v40, v41
    v_exp_f32 v44, v44
    v_exp_f32 v45, v45
    v_cvt_pk_bf16_f32 v61, v42, v43
    v_mfma_f32_32x32x16_bf16 a[0:15], a[252:255], v[52:55], a[0:15]
    global_load_dwordx4 a[236:239], v2, s[54:55] offset:3072 sc1
    v_exp_f32 v46, v46
    v_exp_f32 v47, v47
    v_cvt_pk_bf16_f32 v62, v44, v45
    v_exp_f32 v16, v16
    v_exp_f32 v17, v17
    v_cvt_pk_bf16_f32 v63, v46, v47
    v_mfma_f32_32x32x16_bf16 v[32:47], a[240:243], a[184:187], 0
    s_add_u32 m0, s61, 26624
    s_add_u32 s99, s97, 243712
    buffer_load_dwordx4 v5, s[40:43], s99 offen lds
    v_exp_f32 v18, v18
    v_exp_f32 v19, v19
    v_cvt_pk_bf16_f32 v48, v16, v17
    v_exp_f32 v20, v20
    v_exp_f32 v21, v21
    v_cvt_pk_bf16_f32 v49, v18, v19
    v_mfma_f32_32x32x16_bf16 v[32:47], a[244:247], a[188:191], v[32:47]
    s_add_u32 m0, s61, 27648
    s_add_u32 s99, s97, 250880
    buffer_load_dwordx4 v5, s[40:43], s99 offen lds
    v_exp_f32 v22, v22
    v_exp_f32 v23, v23
    v_cvt_pk_bf16_f32 v50, v20, v21
    v_exp_f32 v24, v24
    v_exp_f32 v25, v25
    v_cvt_pk_bf16_f32 v51, v22, v23
    v_mfma_f32_32x32x16_bf16 a[16:31], a[248:251], v[56:59], a[16:31]
    v_exp_f32 v26, v26
    v_exp_f32 v27, v27
    v_cvt_pk_bf16_f32 v52, v24, v25
    v_exp_f32 v28, v28
    v_exp_f32 v29, v29
    v_cvt_pk_bf16_f32 v53, v26, v27
    v_mfma_f32_32x32x16_bf16 a[16:31], a[252:255], v[60:63], a[16:31]
    s_add_u32 m0, s61, 28672
    s_add_u32 s99, s97, 258048
    buffer_load_dwordx4 v5, s[40:43], s99 offen lds
    v_exp_f32 v30, v30
    v_exp_f32 v31, v31
    v_cvt_pk_bf16_f32 v54, v28, v29
    v_exp_f32 v32, v32
    v_exp_f32 v33, v33
    v_cvt_pk_bf16_f32 v55, v30, v31
    s_waitcnt vmcnt(22)
    v_mfma_f32_32x32x16_bf16 v[16:31], a[192:195], a[160:163], 0
    s_add_u32 m0, s61, 29696
    s_add_u32 s99, s97, 265216
    buffer_load_dwordx4 v5, s[40:43], s99 offen lds
    v_exp_f32 v34, v34
    v_exp_f32 v35, v35
    v_cvt_pk_bf16_f32 v56, v32, v33
    v_exp_f32 v36, v36
    v_exp_f32 v37, v37
    v_cvt_pk_bf16_f32 v57, v34, v35
    v_mfma_f32_32x32x16_bf16 v[16:31], a[196:199], a[164:167], v[16:31]
    s_add_u32 m0, s61, 30720
    s_add_u32 s99, s97, 272384
    buffer_load_dwordx4 v5, s[40:43], s99 offen lds
    v_exp_f32 v38, v38
    v_exp_f32 v39, v39
    v_cvt_pk_bf16_f32 v58, v36, v37
    v_exp_f32 v40, v40
    v_exp_f32 v41, v41
    v_cvt_pk_bf16_f32 v59, v38, v39
    v_mfma_f32_32x32x16_bf16 a[32:47], a[248:251], v[48:51], a[32:47]
    v_exp_f32 v42, v42
    v_exp_f32 v43, v43
    v_cvt_pk_bf16_f32 v60, v40, v41
    v_exp_f32 v44, v44
    v_exp_f32 v45, v45
    v_cvt_pk_bf16_f32 v61, v42, v43
    v_mfma_f32_32x32x16_bf16 a[32:47], a[252:255], v[52:55], a[32:47]
    s_add_u32 m0, s61, 31744
    s_add_u32 s99, s97, 279552
    buffer_load_dwordx4 v5, s[40:43], s99 offen lds
    v_exp_f32 v46, v46
    v_exp_f32 v47, v47
    v_cvt_pk_bf16_f32 v62, v44, v45
    s_waitcnt vmcnt(18)
    v_cmp_ne_u32 vcc, s39, v4
    s_nop 0
    s_cbranch_vccz ready_13
    s_mov_b32 s4, 0
poll_14:
    global_load_dword v4, v3, s[34:35] sc1
    s_waitcnt vmcnt(0)
    v_cmp_ne_u32 vcc, s39, v4
    s_add_u32 s4, s4, 1
    s_cbranch_vccz polldone_15
    s_cmp_lt_u32 s4, 40000
    s_cbranch_scc0 polldone_15
    s_branch poll_14
polldone_15:
ready_13:
    v_exp_f32 v16, v16
    v_exp_f32 v17, v17
    v_cvt_pk_bf16_f32 v63, v46, v47
    v_mfma_f32_32x32x16_bf16 v[32:47], a[192:195], a[168:171], 0
    s_add_u32 s54, s54, 4096
    s_addc_u32 s55, s55, 0
    v_exp_f32 v18, v18
    v_exp_f32 v19, v19
    v_cvt_pk_bf16_f32 v48, v16, v17
    v_exp_f32 v20, v20
    v_exp_f32 v21, v21
    v_cvt_pk_bf16_f32 v49, v18, v19
    v_mfma_f32_32x32x16_bf16 v[32:47], a[196:199], a[172:175], v[32:47]
    global_load_dwordx4 v[64:67], v2, s[64:65] offset:0 sc1
    global_load_dwordx4 v[68:71], v2, s[100:101] offset:0 sc1
    v_exp_f32 v22, v22
    v_exp_f32 v23, v23
    v_cvt_pk_bf16_f32 v50, v20, v21
    v_exp_f32 v24, v24
    v_exp_f32 v25, v25
    v_cvt_pk_bf16_f32 v51, v22, v23
    v_mfma_f32_32x32x16_bf16 a[48:63], a[248:251], v[56:59], a[48:63]
    v_exp_f32 v26, v26
    v_exp_f32 v27, v27
    v_cvt_pk_bf16_f32 v52, v24, v25
    v_exp_f32 v28, v28
    v_exp_f32 v29, v29
    v_cvt_pk_bf16_f32 v53, v26, v27
    v_mfma_f32_32x32x16_bf16 a[48:63], a[252:255], v[60:63], a[48:63]
    global_load_dwordx4 v[72:75], v2, s[64:65] offset:1024 sc1
    v_exp_f32 v30, v30
    v_exp_f32 v31, v31
    v_cvt_pk_bf16_f32 v54, v28, v29
    v_exp_f32 v32, v32
    v_exp_f32 v33, v33
    v_cvt_pk_bf16_f32 v55, v30, v31
    v_mfma_f32_32x32x16_bf16 v[16:31], a[192:195], a[176:179], 0
    global_load_dwordx4 a[240:243], v2, s[54:55] offset:0 sc1
    v_exp_f32 v34, v34
    v_exp_f32 v35, v35
    v_cvt_pk_bf16_f32 v56, v32, v33
    v_exp_f32 v36, v36
    v_exp_f32 v37, v37
    v_cvt_pk_bf16_f32 v57, v34, v35
    v_mfma_f32_32x32x16_bf16 v[16:31], a[196:199], a[180:183], v[16:31]
    global_load_dwordx4 a[244:247], v2, s[54:55] offset:1024 sc1
    v_exp_f32 v38, v38
    v_exp_f32 v39, v39
    v_cvt_pk_bf16_f32 v58, v36, v37
    v_exp_f32 v40, v40
    v_exp_f32 v41, v41
    v_cvt_pk_bf16_f32 v59, v38, v39
    v_mfma_f32_32x32x16_bf16 a[0:15], a[200:203], v[48:51], a[0:15]
    global_load_dwordx4 a[248:251], v2, s[54:55] offset:2048 sc1
    v_exp_f32 v42, v42
    v_exp_f32 v43, v43
    v_cvt_pk_bf16_f32 v60, v40, v41
    v_exp_f32 v44, v44
    v_exp_f32 v45, v45
    v_cvt_pk_bf16_f32 v61, v42, v43
    v_mfma_f32_32x32x16_bf16 a[0:15], a[204:207], v[52:55], a[0:15]
    global_load_dwordx4 a[252:255], v2, s[54:55] offset:3072 sc1
    v_exp_f32 v46, v46
    v_exp_f32 v47, v47
    v_cvt_pk_bf16_f32 v62, v44, v45
    v_exp_f32 v16, v16
    v_exp_f32 v17, v17
    v_cvt_pk_bf16_f32 v63, v46, v47
    v_mfma_f32_32x32x16_bf16 v[32:47], a[192:195], a[184:187], 0
    v_exp_f32 v18, v18
    v_exp_f32 v19, v19
    v_cvt_pk_bf16_f32 v48, v16, v17
    v_exp_f32 v20, v20
    v_exp_f32 v21, v21
    v_cvt_pk_bf16_f32 v49, v18, v19
    v_mfma_f32_32x32x16_bf16 v[32:47], a[196:199], a[188:191], v[32:47]
    global_load_dwordx4 v[76:79], v2, s[100:101] offset:1024 sc1
    v_exp_f32 v22, v22
    v_exp_f32 v23, v23
    v_cvt_pk_bf16_f32 v50, v20, v21
    v_exp_f32 v24, v24
    v_exp_f32 v25, v25
    v_cvt_pk_bf16_f32 v51, v22, v23
    v_mfma_f32_32x32x16_bf16 a[16:31], a[200:203], v[56:59], a[16:31]
    v_exp_f32 v26, v26
    v_exp_f32 v27, v27
    v_cvt_pk_bf16_f32 v52, v24, v25
    v_exp_f32 v28, v28
    v_exp_f32 v29, v29
    v_cvt_pk_bf16_f32 v53, v26, v27
    v_mfma_f32_32x32x16_bf16 a[16:31], a[204:207], v[60:63], a[16:31]
    global_load_dwordx4 v[80:83], v2, s[64:65] offset:2048 sc1
    v_exp_f32 v30, v30
    v_exp_f32 v31, v31
    v_cvt_pk_bf16_f32 v54, v28, v29
    v_exp_f32 v32, v32
    v_exp_f32 v33, v33
    v_cvt_pk_bf16_f32 v55, v30, v31
    s_waitcnt vmcnt(28)
    v_mfma_f32_32x32x16_bf16 v[16:31], a[208:211], a[160:163], 0
    v_exp_f32 v34, v34
    v_exp_f32 v35, v35
    v_cvt_pk_bf16_f32 v56, v32, v33
    v_exp_f32 v36, v36
    v_exp_f32 v37, v37
    v_cvt_pk_bf16_f32 v57, v34, v35
    v_mfma_f32_32x32x16_bf16 v[16:31], a[212:215], a[164:167], v[16:31]
    global_load_dwordx4 v[84:87], v2, s[100:101] offset:2048 sc1
    v_exp_f32 v38, v38
    v_exp_f32 v39, v39
    v_cvt_pk_bf16_f32 v58, v36, v37
    v_exp_f32 v40, v40
    v_exp_f32 v41, v41
    v_cvt_pk_bf16_f32 v59, v38, v39
    v_mfma_f32_32x32x16_bf16 a[32:47], a[200:203], v[48:51], a[32:47]
    v_exp_f32 v42, v42
    v_exp_f32 v43, v43
    v_cvt_pk_bf16_f32 v60, v40, v41
    v_exp_f32 v44, v44
    v_exp_f32 v45, v45
    v_cvt_pk_bf16_f32 v61, v42, v43
    v_mfma_f32_32x32x16_bf16 a[32:47], a[204:207], v[52:55], a[32:47]
    global_load_dwordx4 v[88:91], v2, s[64:65] offset:3072 sc1
    v_exp_f32 v46, v46
    v_exp_f32 v47, v47
    v_cvt_pk_bf16_f32 v62, v44, v45
    v_exp_f32 v16, v16
    v_exp_f32 v17, v17
    v_cvt_pk_bf16_f32 v63, v46, v47
    v_mfma_f32_32x32x16_bf16 v[32:47], a[208:211], a[168:171], 0
    s_add_u32 s54, s54, 4096
    s_addc_u32 s55, s55, 0
    v_exp_f32 v18, v18
    v_exp_f32 v19, v19
    v_cvt_pk_bf16_f32 v48, v16, v17
    v_exp_f32 v20, v20
    v_exp_f32 v21, v21
    v_cvt_pk_bf16_f32 v49, v18, v19
    v_mfma_f32_32x32x16_bf16 v[32:47], a[212:215], a[172:175], v[32:47]
    global_load_dwordx4 v[92:95], v2, s[100:101] offset:3072 sc1
    s_add_u32 s64, s64, 4096
    s_addc_u32 s65, s65, 0
    global_load_dwordx4 v[96:99], v2, s[64:65] offset:0 sc1
    v_exp_f32 v22, v22
    v_exp_f32 v23, v23
    v_cvt_pk_bf16_f32 v50, v20, v21
    v_exp_f32 v24, v24
    v_exp_f32 v25, v25
    v_cvt_pk_bf16_f32 v51, v22, v23
    v_mfma_f32_32x32x16_bf16 a[48:63], a[200:203], v[56:59], a[48:63]
    v_exp_f32 v26, v26
    v_exp_f32 v27, v27
    v_cvt_pk_bf16_f32 v52, v24, v25
    v_exp_f32 v28, v28
    v_exp_f32 v29, v29
    v_cvt_pk_bf16_f32 v53, v26, v27
    v_mfma_f32_32x32x16_bf16 a[48:63], a[204:207], v[60:63], a[48:63]
    s_add_u32 s100, s100, 4096
    s_addc_u32 s101, s101, 0
    global_load_dwordx4 v[100:103], v2, s[100:101] offset:0 sc1
    v_exp_f32 v30, v30
    v_exp_f32 v31, v31
    v_cvt_pk_bf16_f32 v54, v28, v29
    v_exp_f32 v32, v32
    v_exp_f32 v33, v33
    v_cvt_pk_bf16_f32 v55, v30, v31
    v_mfma_f32_32x32x16_bf16 v[16:31], a[208:211], a[176:179], 0
    global_load_dwordx4 a[192:195], v2, s[54:55] offset:0 sc1
    v_exp_f32 v34, v34
    v_exp_f32 v35, v35
    v_cvt_pk_bf16_f32 v56, v32, v33
    v_exp_f32 v36, v36
    v_exp_f32 v37, v37
    v_cvt_pk_bf16_f32 v57, v34, v35
    v_mfma_f32_32x32x16_bf16 v[16:31], a[212:215], a[180:183], v[16:31]
    global_load_dwordx4 a[196:199], v2, s[54:55] offset:1024 sc1
    v_exp_f32 v38, v38
    v_exp_f32 v39, v39
    v_cvt_pk_bf16_f32 v58, v36, v37
    v_exp_f32 v40, v40
    v_exp_f32 v41, v41
    v_cvt_pk_bf16_f32 v59, v38, v39
    v_mfma_f32_32x32x16_bf16 a[0:15], a[216:219], v[48:51], a[0:15]
    global_load_dwordx4 a[200:203], v2, s[54:55] offset:2048 sc1
    v_exp_f32 v42, v42
    v_exp_f32 v43, v43
    v_cvt_pk_bf16_f32 v60, v40, v41
    v_exp_f32 v44, v44
    v_exp_f32 v45, v45
    v_cvt_pk_bf16_f32 v61, v42, v43
    v_mfma_f32_32x32x16_bf16 a[0:15], a[220:223], v[52:55], a[0:15]
    global_load_dwordx4 a[204:207], v2, s[54:55] offset:3072 sc1
    v_exp_f32 v46, v46
    v_exp_f32 v47, v47
    v_cvt_pk_bf16_f32 v62, v44, v45
    v_exp_f32 v16, v16
    v_exp_f32 v17, v17
    v_cvt_pk_bf16_f32 v63, v46, v47
    v_mfma_f32_32x32x16_bf16 v[32:47], a[208:211], a[184:187], 0
    v_exp_f32 v18, v18
    v_exp_f32 v19, v19
    v_cvt_pk_bf16_f32 v48, v16, v17
    v_exp_f32 v20, v20
    v_exp_f32 v21, v21
    v_cvt_pk_bf16_f32 v49, v18, v19
    v_mfma_f32_32x32x16_bf16 v[32:47], a[212:215], a[188:191], v[32:47]
    global_load_dwordx4 v[104:107], v2, s[64:65] offset:1024 sc1
    v_exp_f32 v22, v22
    v_exp_f32 v23, v23
    v_cvt_pk_bf16_f32 v50, v20, v21
    v_exp_f32 v24, v24
    v_exp_f32 v25, v25
    v_cvt_pk_bf16_f32 v51, v22, v23
    v_mfma_f32_32x32x16_bf16 a[16:31], a[216:219], v[56:59], a[16:31]
    v_exp_f32 v26, v26
    v_exp_f32 v27, v27
    v_cvt_pk_bf16_f32 v52, v24, v25
    v_exp_f32 v28, v28
    v_exp_f32 v29, v29
    v_cvt_pk_bf16_f32 v53, v26, v27
    v_mfma_f32_32x32x16_bf16 a[16:31], a[220:223], v[60:63], a[16:31]
    global_load_dwordx4 v[108:111], v2, s[100:101] offset:1024 sc1
    v_exp_f32 v30, v30
    v_exp_f32 v31, v31
    v_cvt_pk_bf16_f32 v54, v28, v29
    v_exp_f32 v32, v32
    v_exp_f32 v33, v33
    v_cvt_pk_bf16_f32 v55, v30, v31
    s_waitcnt vmcnt(26)
    v_mfma_f32_32x32x16_bf16 v[16:31], a[224:227], a[160:163], 0
    v_exp_f32 v34, v34
    v_exp_f32 v35, v35
    v_cvt_pk_bf16_f32 v56, v32, v33
    v_exp_f32 v36, v36
    v_exp_f32 v37, v37
    v_cvt_pk_bf16_f32 v57, v34, v35
    v_mfma_f32_32x32x16_bf16 v[16:31], a[228:231], a[164:167], v[16:31]
    global_load_dwordx4 v[112:115], v2, s[64:65] offset:2048 sc1
    v_exp_f32 v38, v38
    v_exp_f32 v39, v39
    v_cvt_pk_bf16_f32 v58, v36, v37
    v_exp_f32 v40, v40
    v_exp_f32 v41, v41
    v_cvt_pk_bf16_f32 v59, v38, v39
    v_mfma_f32_32x32x16_bf16 a[32:47], a[216:219], v[48:51], a[32:47]
    v_exp_f32 v42, v42
    v_exp_f32 v43, v43
    v_cvt_pk_bf16_f32 v60, v40, v41
    v_exp_f32 v44, v44
    v_exp_f32 v45, v45
    v_cvt_pk_bf16_f32 v61, v42, v43
    v_mfma_f32_32x32x16_bf16 a[32:47], a[220:223], v[52:55], a[32:47]
    global_load_dwordx4 v[116:119], v2, s[100:101] offset:2048 sc1
    v_exp_f32 v46, v46
    v_exp_f32 v47, v47
    v_cvt_pk_bf16_f32 v62, v44, v45
    v_exp_f32 v16, v16
    v_exp_f32 v17, v17
    v_cvt_pk_bf16_f32 v63, v46, v47
    v_mfma_f32_32x32x16_bf16 v[32:47], a[224:227], a[168:171], 0
    s_add_u32 s54, s54, 4096
    s_addc_u32 s55, s55, 0
    v_exp_f32 v18, v18
    v_exp_f32 v19, v19
    v_cvt_pk_bf16_f32 v48, v16, v17
    v_exp_f32 v20, v20
    v_exp_f32 v21, v21
    v_cvt_pk_bf16_f32 v49, v18, v19
    v_mfma_f32_32x32x16_bf16 v[32:47], a[228:231], a[172:175], v[32:47]
    global_load_dwordx4 v[120:123], v2, s[64:65] offset:3072 sc1
    global_load_dwordx4 v[124:127], v2, s[100:101] offset:3072 sc1
    v_exp_f32 v22, v22
    v_exp_f32 v23, v23
    v_cvt_pk_bf16_f32 v50, v20, v21
    v_exp_f32 v24, v24
    v_exp_f32 v25, v25
    v_cvt_pk_bf16_f32 v51, v22, v23
    v_mfma_f32_32x32x16_bf16 a[48:63], a[216:219], v[56:59], a[48:63]
    v_exp_f32 v26, v26
    v_exp_f32 v27, v27
    v_cvt_pk_bf16_f32 v52, v24, v25
    v_exp_f32 v28, v28
    v_exp_f32 v29, v29
    v_cvt_pk_bf16_f32 v53, v26, v27
    v_mfma_f32_32x32x16_bf16 a[48:63], a[220:223], v[60:63], a[48:63]
    s_add_u32 s64, s64, 4096
    s_addc_u32 s65, s65, 0
    global_load_dwordx4 v[128:131], v2, s[64:65] offset:0 sc1
    v_exp_f32 v30, v30
    v_exp_f32 v31, v31
    v_cvt_pk_bf16_f32 v54, v28, v29
    v_exp_f32 v32, v32
    v_exp_f32 v33, v33
    v_cvt_pk_bf16_f32 v55, v30, v31
    v_mfma_f32_32x32x16_bf16 v[16:31], a[224:227], a[176:179], 0
    global_load_dwordx4 a[208:211], v2, s[54:55] offset:0 sc1
    v_exp_f32 v34, v34
    v_exp_f32 v35, v35
    v_cvt_pk_bf16_f32 v56, v32, v33
    v_exp_f32 v36, v36
    v_exp_f32 v37, v37
    v_cvt_pk_bf16_f32 v57, v34, v35
    v_mfma_f32_32x32x16_bf16 v[16:31], a[228:231], a[180:183], v[16:31]
    global_load_dwordx4 a[212:215], v2, s[54:55] offset:1024 sc1
    v_exp_f32 v38, v38
    v_exp_f32 v39, v39
    v_cvt_pk_bf16_f32 v58, v36, v37
    v_exp_f32 v40, v40
    v_exp_f32 v41, v41
    v_cvt_pk_bf16_f32 v59, v38, v39
    v_mfma_f32_32x32x16_bf16 a[0:15], a[232:235], v[48:51], a[0:15]
    global_load_dwordx4 a[216:219], v2, s[54:55] offset:2048 sc1
    v_exp_f32 v42, v42
    v_exp_f32 v43, v43
    v_cvt_pk_bf16_f32 v60, v40, v41
    v_exp_f32 v44, v44
    v_exp_f32 v45, v45
    v_cvt_pk_bf16_f32 v61, v42, v43
    v_mfma_f32_32x32x16_bf16 a[0:15], a[236:239], v[52:55], a[0:15]
    global_load_dwordx4 a[220:223], v2, s[54:55] offset:3072 sc1
    v_exp_f32 v46, v46
    v_exp_f32 v47, v47
    v_cvt_pk_bf16_f32 v62, v44, v45
    v_exp_f32 v16, v16
    v_exp_f32 v17, v17
    v_cvt_pk_bf16_f32 v63, v46, v47
    v_mfma_f32_32x32x16_bf16 v[32:47], a[224:227], a[184:187], 0
    v_exp_f32 v18, v18
    v_exp_f32 v19, v19
    v_cvt_pk_bf16_f32 v48, v16, v17
    v_exp_f32 v20, v20
    v_exp_f32 v21, v21
    v_cvt_pk_bf16_f32 v49, v18, v19
    v_mfma_f32_32x32x16_bf16 v[32:47], a[228:231], a[188:191], v[32:47]
    s_add_u32 s100, s100, 4096
    s_addc_u32 s101, s101, 0
    global_load_dwordx4 v[132:135], v2, s[100:101] offset:0 sc1
    v_exp_f32 v22, v22
    v_exp_f32 v23, v23
    v_cvt_pk_bf16_f32 v50, v20, v21
    v_exp_f32 v24, v24
    v_exp_f32 v25, v25
    v_cvt_pk_bf16_f32 v51, v22, v23
    v_mfma_f32_32x32x16_bf16 a[16:31], a[232:235], v[56:59], a[16:31]
    v_exp_f32 v26, v26
    v_exp_f32 v27, v27
    v_cvt_pk_bf16_f32 v52, v24, v25
    v_exp_f32 v28, v28
    v_exp_f32 v29, v29
    v_cvt_pk_bf16_f32 v53, v26, v27
    v_mfma_f32_32x32x16_bf16 a[16:31], a[236:239], v[60:63], a[16:31]
    global_load_dwordx4 v[136:139], v2, s[64:65] offset:1024 sc1
    v_exp_f32 v30, v30
    v_exp_f32 v31, v31
    v_cvt_pk_bf16_f32 v54, v28, v29
    v_exp_f32 v32, v32
    v_exp_f32 v33, v33
    v_cvt_pk_bf16_f32 v55, v30, v31
    s_waitcnt vmcnt(24)
    v_mfma_f32_32x32x16_bf16 v[16:31], a[240:243], a[160:163], 0
    v_exp_f32 v34, v34
    v_exp_f32 v35, v35
    v_cvt_pk_bf16_f32 v56, v32, v33
    v_exp_f32 v36, v36
    v_exp_f32 v37, v37
    v_cvt_pk_bf16_f32 v57, v34, v35
    v_mfma_f32_32x32x16_bf16 v[16:31], a[244:247], a[164:167], v[16:31]
    global_load_dwordx4 v[140:143], v2, s[100:101] offset:1024 sc1
    v_exp_f32 v38, v38
    v_exp_f32 v39, v39
    v_cvt_pk_bf16_f32 v58, v36, v37
    v_exp_f32 v40, v40
    v_exp_f32 v41, v41
    v_cvt_pk_bf16_f32 v59, v38, v39
    v_mfma_f32_32x32x16_bf16 a[32:47], a[232:235], v[48:51], a[32:47]
    v_exp_f32 v42, v42
    v_exp_f32 v43, v43
    v_cvt_pk_bf16_f32 v60, v40, v41
    v_exp_f32 v44, v44
    v_exp_f32 v45, v45
    v_cvt_pk_bf16_f32 v61, v42, v43
    v_mfma_f32_32x32x16_bf16 a[32:47], a[236:239], v[52:55], a[32:47]
    global_load_dwordx4 v[144:147], v2, s[64:65] offset:2048 sc1
    v_exp_f32 v46, v46
    v_exp_f32 v47, v47
    v_cvt_pk_bf16_f32 v62, v44, v45
    v_exp_f32 v16, v16
    v_exp_f32 v17, v17
    v_cvt_pk_bf16_f32 v63, v46, v47
    v_mfma_f32_32x32x16_bf16 v[32:47], a[240:243], a[168:171], 0
    s_add_u32 s54, s54, 4096
    s_addc_u32 s55, s55, 0
    v_exp_f32 v18, v18
    v_exp_f32 v19, v19
    v_cvt_pk_bf16_f32 v48, v16, v17
    v_exp_f32 v20, v20
    v_exp_f32 v21, v21
    v_cvt_pk_bf16_f32 v49, v18, v19
    v_mfma_f32_32x32x16_bf16 v[32:47], a[244:247], a[172:175], v[32:47]
    global_load_dwordx4 v[148:151], v2, s[100:101] offset:2048 sc1
    global_load_dwordx4 v[152:155], v2, s[64:65] offset:3072 sc1
    v_exp_f32 v22, v22
    v_exp_f32 v23, v23
    v_cvt_pk_bf16_f32 v50, v20, v21
    v_exp_f32 v24, v24
    v_exp_f32 v25, v25
    v_cvt_pk_bf16_f32 v51, v22, v23
    v_mfma_f32_32x32x16_bf16 a[48:63], a[232:235], v[56:59], a[48:63]
    v_exp_f32 v26, v26
    v_exp_f32 v27, v27
    v_cvt_pk_bf16_f32 v52, v24, v25
    v_exp_f32 v28, v28
    v_exp_f32 v29, v29
    v_cvt_pk_bf16_f32 v53, v26, v27
    v_mfma_f32_32x32x16_bf16 a[48:63], a[236:239], v[60:63], a[48:63]
    global_load_dwordx4 v[156:159], v2, s[100:101] offset:3072 sc1
    v_exp_f32 v30, v30
    v_exp_f32 v31, v31
    v_cvt_pk_bf16_f32 v54, v28, v29
    v_exp_f32 v32, v32
    v_exp_f32 v33, v33
    v_cvt_pk_bf16_f32 v55, v30, v31
    v_mfma_f32_32x32x16_bf16 v[16:31], a[240:243], a[176:179], 0
    global_load_dwordx4 a[224:227], v2, s[54:55] offset:0 sc1
    v_exp_f32 v34, v34
    v_exp_f32 v35, v35
    v_cvt_pk_bf16_f32 v56, v32, v33
    v_exp_f32 v36, v36
    v_exp_f32 v37, v37
    v_cvt_pk_bf16_f32 v57, v34, v35
    v_mfma_f32_32x32x16_bf16 v[16:31], a[244:247], a[180:183], v[16:31]
    global_load_dwordx4 a[228:231], v2, s[54:55] offset:1024 sc1
    v_exp_f32 v38, v38
    v_exp_f32 v39, v39
    v_cvt_pk_bf16_f32 v58, v36, v37
    v_exp_f32 v40, v40
    v_exp_f32 v41, v41
    v_cvt_pk_bf16_f32 v59, v38, v39
    v_mfma_f32_32x32x16_bf16 a[0:15], a[248:251], v[48:51], a[0:15]
    global_load_dwordx4 a[232:235], v2, s[54:55] offset:2048 sc1
    v_exp_f32 v42, v42
    v_exp_f32 v43, v43
    v_cvt_pk_bf16_f32 v60, v40, v41
    v_exp_f32 v44, v44
    v_exp_f32 v45, v45
    v_cvt_pk_bf16_f32 v61, v42, v43
    v_mfma_f32_32x32x16_bf16 a[0:15], a[252:255], v[52:55], a[0:15]
    global_load_dwordx4 a[236:239], v2, s[54:55] offset:3072 sc1
    v_exp_f32 v46, v46
    v_exp_f32 v47, v47
    v_cvt_pk_bf16_f32 v62, v44, v45
    v_exp_f32 v16, v16
    v_exp_f32 v17, v17
    v_cvt_pk_bf16_f32 v63, v46, v47
    v_mfma_f32_32x32x16_bf16 v[32:47], a[240:243], a[184:187], 0
    v_exp_f32 v18, v18
    v_exp_f32 v19, v19
    v_cvt_pk_bf16_f32 v48, v16, v17
    v_exp_f32 v20, v20
    v_exp_f32 v21, v21
    v_cvt_pk_bf16_f32 v49, v18, v19
    v_mfma_f32_32x32x16_bf16 v[32:47], a[244:247], a[188:191], v[32:47]
    s_add_u32 s64, s64, 4096
    s_addc_u32 s65, s65, 0
    global_load_dwordx4 v[160:163], v2, s[64:65] offset:0 sc1
    v_exp_f32 v22, v22
    v_exp_f32 v23, v23
    v_cvt_pk_bf16_f32 v50, v20, v21
    v_exp_f32 v24, v24
    v_exp_f32 v25, v25
    v_cvt_pk_bf16_f32 v51, v22, v23
    v_mfma_f32_32x32x16_bf16 a[16:31], a[248:251], v[56:59], a[16:31]
    v_exp_f32 v26, v26
    v_exp_f32 v27, v27
    v_cvt_pk_bf16_f32 v52, v24, v25
    v_exp_f32 v28, v28
    v_exp_f32 v29, v29
    v_cvt_pk_bf16_f32 v53, v26, v27
    v_mfma_f32_32x32x16_bf16 a[16:31], a[252:255], v[60:63], a[16:31]
    s_add_u32 s100, s100, 4096
    s_addc_u32 s101, s101, 0
    global_load_dwordx4 v[164:167], v2, s[100:101] offset:0 sc1
    v_exp_f32 v30, v30
    v_exp_f32 v31, v31
    v_cvt_pk_bf16_f32 v54, v28, v29
    v_exp_f32 v32, v32
    v_exp_f32 v33, v33
    v_cvt_pk_bf16_f32 v55, v30, v31
    s_waitcnt vmcnt(24)
    v_mfma_f32_32x32x16_bf16 v[16:31], a[192:195], a[160:163], 0
    v_exp_f32 v34, v34
    v_exp_f32 v35, v35
    v_cvt_pk_bf16_f32 v56, v32, v33
    v_exp_f32 v36, v36
    v_exp_f32 v37, v37
    v_cvt_pk_bf16_f32 v57, v34, v35
    v_mfma_f32_32x32x16_bf16 v[16:31], a[196:199], a[164:167], v[16:31]
    global_load_dwordx4 v[168:171], v2, s[64:65] offset:1024 sc1
    v_exp_f32 v38, v38
    v_exp_f32 v39, v39
    v_cvt_pk_bf16_f32 v58, v36, v37
    v_exp_f32 v40, v40
    v_exp_f32 v41, v41
    v_cvt_pk_bf16_f32 v59, v38, v39
    v_mfma_f32_32x32x16_bf16 a[32:47], a[248:251], v[48:51], a[32:47]
    v_exp_f32 v42, v42
    v_exp_f32 v43, v43
    v_cvt_pk_bf16_f32 v60, v40, v41
    v_exp_f32 v44, v44
    v_exp_f32 v45, v45
    v_cvt_pk_bf16_f32 v61, v42, v43
    v_mfma_f32_32x32x16_bf16 a[32:47], a[252:255], v[52:55], a[32:47]
    global_load_dwordx4 v[172:175], v2, s[100:101] offset:1024 sc1
    v_exp_f32 v46, v46
    v_exp_f32 v47, v47
    v_cvt_pk_bf16_f32 v62, v44, v45
    v_exp_f32 v16, v16
    v_exp_f32 v17, v17
    v_cvt_pk_bf16_f32 v63, v46, v47
    v_mfma_f32_32x32x16_bf16 v[32:47], a[192:195], a[168:171], 0
    s_add_u32 s54, s54, 4096
    s_addc_u32 s55, s55, 0
    v_exp_f32 v18, v18
    v_exp_f32 v19, v19
    v_cvt_pk_bf16_f32 v48, v16, v17
    v_exp_f32 v20, v20
    v_exp_f32 v21, v21
    v_cvt_pk_bf16_f32 v49, v18, v19
    v_mfma_f32_32x32x16_bf16 v[32:47], a[196:199], a[172:175], v[32:47]
    global_load_dwordx4 v[176:179], v2, s[64:65] offset:2048 sc1
    global_load_dwordx4 v[180:183], v2, s[100:101] offset:2048 sc1
    v_exp_f32 v22, v22
    v_exp_f32 v23, v23
    v_cvt_pk_bf16_f32 v50, v20, v21
    v_exp_f32 v24, v24
    v_exp_f32 v25, v25
    v_cvt_pk_bf16_f32 v51, v22, v23
    v_mfma_f32_32x32x16_bf16 a[48:63], a[248:251], v[56:59], a[48:63]
    v_exp_f32 v26, v26
    v_exp_f32 v27, v27
    v_cvt_pk_bf16_f32 v52, v24, v25
    v_exp_f32 v28, v28
    v_exp_f32 v29, v29
    v_cvt_pk_bf16_f32 v53, v26, v27
    v_mfma_f32_32x32x16_bf16 a[48:63], a[252:255], v[60:63], a[48:63]
    global_load_dwordx4 v[184:187], v2, s[64:65] offset:3072 sc1
    v_exp_f32 v30, v30
    v_exp_f32 v31, v31
    v_cvt_pk_bf16_f32 v54, v28, v29
    v_exp_f32 v32, v32
    v_exp_f32 v33, v33
    v_cvt_pk_bf16_f32 v55, v30, v31
    v_mfma_f32_32x32x16_bf16 v[16:31], a[192:195], a[176:179], 0
    global_load_dwordx4 a[240:243], v2, s[54:55] offset:0 sc1
    v_exp_f32 v34, v34
    v_exp_f32 v35, v35
    v_cvt_pk_bf16_f32 v56, v32, v33
    v_exp_f32 v36, v36
    v_exp_f32 v37, v37
    v_cvt_pk_bf16_f32 v57, v34, v35
    v_mfma_f32_32x32x16_bf16 v[16:31], a[196:199], a[180:183], v[16:31]
    global_load_dwordx4 a[244:247], v2, s[54:55] offset:1024 sc1
    v_exp_f32 v38, v38
    v_exp_f32 v39, v39
    v_cvt_pk_bf16_f32 v58, v36, v37
    v_exp_f32 v40, v40
    v_exp_f32 v41, v41
    v_cvt_pk_bf16_f32 v59, v38, v39
    v_mfma_f32_32x32x16_bf16 a[0:15], a[200:203], v[48:51], a[0:15]
    global_load_dwordx4 a[248:251], v2, s[54:55] offset:2048 sc1
    v_exp_f32 v42, v42
    v_exp_f32 v43, v43
    v_cvt_pk_bf16_f32 v60, v40, v41
    v_exp_f32 v44, v44
    v_exp_f32 v45, v45
    v_cvt_pk_bf16_f32 v61, v42, v43
    v_mfma_f32_32x32x16_bf16 a[0:15], a[204:207], v[52:55], a[0:15]
    global_load_dwordx4 a[252:255], v2, s[54:55] offset:3072 sc1
    v_exp_f32 v46, v46
    v_exp_f32 v47, v47
    v_cvt_pk_bf16_f32 v62, v44, v45
    v_exp_f32 v16, v16
    v_exp_f32 v17, v17
    v_cvt_pk_bf16_f32 v63, v46, v47
    v_mfma_f32_32x32x16_bf16 v[32:47], a[192:195], a[184:187], 0
    v_exp_f32 v18, v18
    v_exp_f32 v19, v19
    v_cvt_pk_bf16_f32 v48, v16, v17
    v_exp_f32 v20, v20
    v_exp_f32 v21, v21
    v_cvt_pk_bf16_f32 v49, v18, v19
    v_mfma_f32_32x32x16_bf16 v[32:47], a[196:199], a[188:191], v[32:47]
    global_load_dwordx4 v[188:191], v2, s[100:101] offset:3072 sc1
    v_exp_f32 v22, v22
    v_exp_f32 v23, v23
    v_cvt_pk_bf16_f32 v50, v20, v21
    v_exp_f32 v24, v24
    v_exp_f32 v25, v25
    v_cvt_pk_bf16_f32 v51, v22, v23
    v_mfma_f32_32x32x16_bf16 a[16:31], a[200:203], v[56:59], a[16:31]
    v_exp_f32 v26, v26
    v_exp_f32 v27, v27
    v_cvt_pk_bf16_f32 v52, v24, v25
    v_exp_f32 v28, v28
    v_exp_f32 v29, v29
    v_cvt_pk_bf16_f32 v53, v26, v27
    v_mfma_f32_32x32x16_bf16 a[16:31], a[204:207], v[60:63], a[16:31]
    s_add_u32 s64, s64, 4096
    s_addc_u32 s65, s65, 0
    global_load_dwordx4 a[64:67], v2, s[64:65] offset:0 sc1
    v_exp_f32 v30, v30
    v_exp_f32 v31, v31
    v_cvt_pk_bf16_f32 v54, v28, v29
    v_exp_f32 v32, v32
    v_exp_f32 v33, v33
    v_cvt_pk_bf16_f32 v55, v30, v31
    s_waitcnt vmcnt(24)
    v_mfma_f32_32x32x16_bf16 v[16:31], a[208:211], a[160:163], 0
    v_exp_f32 v34, v34
    v_exp_f32 v35, v35
    v_cvt_pk_bf16_f32 v56, v32, v33
    v_exp_f32 v36, v36
    v_exp_f32 v37, v37
    v_cvt_pk_bf16_f32 v57, v34, v35
    v_mfma_f32_32x32x16_bf16 v[16:31], a[212:215], a[164:167], v[16:31]
    s_add_u32 s100, s100, 4096
    s_addc_u32 s101, s101, 0
    global_load_dwordx4 a[68:71], v2, s[100:101] offset:0 sc1
    v_exp_f32 v38, v38
    v_exp_f32 v39, v39
    v_cvt_pk_bf16_f32 v58, v36, v37
    v_exp_f32 v40, v40
    v_exp_f32 v41, v41
    v_cvt_pk_bf16_f32 v59, v38, v39
    v_mfma_f32_32x32x16_bf16 a[32:47], a[200:203], v[48:51], a[32:47]
    v_exp_f32 v42, v42
    v_exp_f32 v43, v43
    v_cvt_pk_bf16_f32 v60, v40, v41
    v_exp_f32 v44, v44
    v_exp_f32 v45, v45
    v_cvt_pk_bf16_f32 v61, v42, v43
    v_mfma_f32_32x32x16_bf16 a[32:47], a[204:207], v[52:55], a[32:47]
    global_load_dwordx4 a[72:75], v2, s[64:65] offset:1024 sc1
    v_exp_f32 v46, v46
    v_exp_f32 v47, v47
    v_cvt_pk_bf16_f32 v62, v44, v45
    v_exp_f32 v16, v16
    v_exp_f32 v17, v17
    v_cvt_pk_bf16_f32 v63, v46, v47
    v_mfma_f32_32x32x16_bf16 v[32:47], a[208:211], a[168:171], 0
    v_exp_f32 v18, v18
    v_exp_f32 v19, v19
    v_cvt_pk_bf16_f32 v48, v16, v17
    v_exp_f32 v20, v20
    v_exp_f32 v21, v21
    v_cvt_pk_bf16_f32 v49, v18, v19
    v_mfma_f32_32x32x16_bf16 v[32:47], a[212:215], a[172:175], v[32:47]
    global_load_dwordx4 a[76:79], v2, s[100:101] offset:1024 sc1
    global_load_dwordx4 a[80:83], v2, s[64:65] offset:2048 sc1
    v_exp_f32 v22, v22
    v_exp_f32 v23, v23
    v_cvt_pk_bf16_f32 v50, v20, v21
    v_exp_f32 v24, v24
    v_exp_f32 v25, v25
    v_cvt_pk_bf16_f32 v51, v22, v23
    v_mfma_f32_32x32x16_bf16 a[48:63], a[200:203], v[56:59], a[48:63]
    v_exp_f32 v26, v26
    v_exp_f32 v27, v27
    v_cvt_pk_bf16_f32 v52, v24, v25
    v_exp_f32 v28, v28
    v_exp_f32 v29, v29
    v_cvt_pk_bf16_f32 v53, v26, v27
    v_mfma_f32_32x32x16_bf16 a[48:63], a[204:207], v[60:63], a[48:63]
    global_load_dwordx4 a[84:87], v2, s[100:101] offset:2048 sc1
    v_exp_f32 v30, v30
    v_exp_f32 v31, v31
    v_cvt_pk_bf16_f32 v54, v28, v29
    v_exp_f32 v32, v32
    v_exp_f32 v33, v33
    v_cvt_pk_bf16_f32 v55, v30, v31
    v_mfma_f32_32x32x16_bf16 v[16:31], a[208:211], a[176:179], 0
    v_exp_f32 v34, v34
    v_exp_f32 v35, v35
    v_cvt_pk_bf16_f32 v56, v32, v33
    v_exp_f32 v36, v36
    v_exp_f32 v37, v37
    v_cvt_pk_bf16_f32 v57, v34, v35
    v_mfma_f32_32x32x16_bf16 v[16:31], a[212:215], a[180:183], v[16:31]
    v_exp_f32 v38, v38
    v_exp_f32 v39, v39
    v_cvt_pk_bf16_f32 v58, v36, v37
    v_exp_f32 v40, v40
    v_exp_f32 v41, v41
    v_cvt_pk_bf16_f32 v59, v38, v39
    v_mfma_f32_32x32x16_bf16 a[0:15], a[216:219], v[48:51], a[0:15]
    v_exp_f32 v42, v42
    v_exp_f32 v43, v43
    v_cvt_pk_bf16_f32 v60, v40, v41
    v_exp_f32 v44, v44
    v_exp_f32 v45, v45
    v_cvt_pk_bf16_f32 v61, v42, v43
    v_mfma_f32_32x32x16_bf16 a[0:15], a[220:223], v[52:55], a[0:15]
    v_exp_f32 v46, v46
    v_exp_f32 v47, v47
    v_cvt_pk_bf16_f32 v62, v44, v45
    v_exp_f32 v16, v16
    v_exp_f32 v17, v17
    v_cvt_pk_bf16_f32 v63, v46, v47
    v_mfma_f32_32x32x16_bf16 v[32:47], a[208:211], a[184:187], 0
    v_exp_f32 v18, v18
    v_exp_f32 v19, v19
    v_cvt_pk_bf16_f32 v48, v16, v17
    v_exp_f32 v20, v20
    v_exp_f32 v21, v21
    v_cvt_pk_bf16_f32 v49, v18, v19
    v_mfma_f32_32x32x16_bf16 v[32:47], a[212:215], a[188:191], v[32:47]
    global_load_dwordx4 a[88:91], v2, s[64:65] offset:3072 sc1
    v_exp_f32 v22, v22
    v_exp_f32 v23, v23
    v_cvt_pk_bf16_f32 v50, v20, v21
    v_exp_f32 v24, v24
    v_exp_f32 v25, v25
    v_cvt_pk_bf16_f32 v51, v22, v23
    v_mfma_f32_32x32x16_bf16 a[16:31], a[216:219], v[56:59], a[16:31]
    v_exp_f32 v26, v26
    v_exp_f32 v27, v27
    v_cvt_pk_bf16_f32 v52, v24, v25
    v_exp_f32 v28, v28
    v_exp_f32 v29, v29
    v_cvt_pk_bf16_f32 v53, v26, v27
    v_mfma_f32_32x32x16_bf16 a[16:31], a[220:223], v[60:63], a[16:31]
    global_load_dwordx4 a[92:95], v2, s[100:101] offset:3072 sc1
    v_exp_f32 v30, v30
    v_exp_f32 v31, v31
    v_cvt_pk_bf16_f32 v54, v28, v29
    v_exp_f32 v32, v32
    v_exp_f32 v33, v33
    v_cvt_pk_bf16_f32 v55, v30, v31
    s_waitcnt vmcnt(20)
    v_mfma_f32_32x32x16_bf16 v[16:31], a[224:227], a[160:163], 0
    v_exp_f32 v34, v34
    v_exp_f32 v35, v35
    v_cvt_pk_bf16_f32 v56, v32, v33
    v_exp_f32 v36, v36
    v_exp_f32 v37, v37
    v_cvt_pk_bf16_f32 v57, v34, v35
    v_mfma_f32_32x32x16_bf16 v[16:31], a[228:231], a[164:167], v[16:31]
    s_add_u32 s64, s64, 4096
    s_addc_u32 s65, s65, 0
    global_load_dwordx4 a[96:99], v2, s[64:65] offset:0 sc1
    v_exp_f32 v38, v38
    v_exp_f32 v39, v39
    v_cvt_pk_bf16_f32 v58, v36, v37
    v_exp_f32 v40, v40
    v_exp_f32 v41, v41
    v_cvt_pk_bf16_f32 v59, v38, v39
    v_mfma_f32_32x32x16_bf16 a[32:47], a[216:219], v[48:51], a[32:47]
    v_exp_f32 v42, v42
    v_exp_f32 v43, v43
    v_cvt_pk_bf16_f32 v60, v40, v41
    v_exp_f32 v44, v44
    v_exp_f32 v45, v45
    v_cvt_pk_bf16_f32 v61, v42, v43
    v_mfma_f32_32x32x16_bf16 a[32:47], a[220:223], v[52:55], a[32:47]
    s_add_u32 s100, s100, 4096
    s_addc_u32 s101, s101, 0
    global_load_dwordx4 a[100:103], v2, s[100:101] offset:0 sc1
    v_exp_f32 v46, v46
    v_exp_f32 v47, v47
    v_cvt_pk_bf16_f32 v62, v44, v45
    v_exp_f32 v16, v16
    v_exp_f32 v17, v17
    v_cvt_pk_bf16_f32 v63, v46, v47
    v_mfma_f32_32x32x16_bf16 v[32:47], a[224:227], a[168:171], 0
    v_exp_f32 v18, v18
    v_exp_f32 v19, v19
    v_cvt_pk_bf16_f32 v48, v16, v17
    v_exp_f32 v20, v20
    v_exp_f32 v21, v21
    v_cvt_pk_bf16_f32 v49, v18, v19
    v_mfma_f32_32x32x16_bf16 v[32:47], a[228:231], a[172:175], v[32:47]
    global_load_dwordx4 a[104:107], v2, s[64:65] offset:1024 sc1
    global_load_dwordx4 a[108:111], v2, s[100:101] offset:1024 sc1
    v_exp_f32 v22, v22
    v_exp_f32 v23, v23
    v_cvt_pk_bf16_f32 v50, v20, v21
    v_exp_f32 v24, v24
    v_exp_f32 v25, v25
    v_cvt_pk_bf16_f32 v51, v22, v23
    v_mfma_f32_32x32x16_bf16 a[48:63], a[216:219], v[56:59], a[48:63]
    v_exp_f32 v26, v26
    v_exp_f32 v27, v27
    v_cvt_pk_bf16_f32 v52, v24, v25
    v_exp_f32 v28, v28
    v_exp_f32 v29, v29
    v_cvt_pk_bf16_f32 v53, v26, v27
    v_mfma_f32_32x32x16_bf16 a[48:63], a[220:223], v[60:63], a[48:63]
    global_load_dwordx4 a[112:115], v2, s[64:65] offset:2048 sc1
    v_exp_f32 v30, v30
    v_exp_f32 v31, v31
    v_cvt_pk_bf16_f32 v54, v28, v29
    v_exp_f32 v32, v32
    v_exp_f32 v33, v33
    v_cvt_pk_bf16_f32 v55, v30, v31
    v_mfma_f32_32x32x16_bf16 v[16:31], a[224:227], a[176:179], 0
    v_exp_f32 v34, v34
    v_exp_f32 v35, v35
    v_cvt_pk_bf16_f32 v56, v32, v33
    v_exp_f32 v36, v36
    v_exp_f32 v37, v37
    v_cvt_pk_bf16_f32 v57, v34, v35
    v_mfma_f32_32x32x16_bf16 v[16:31], a[228:231], a[180:183], v[16:31]
    v_exp_f32 v38, v38
    v_exp_f32 v39, v39
    v_cvt_pk_bf16_f32 v58, v36, v37
    v_exp_f32 v40, v40
    v_exp_f32 v41, v41
    v_cvt_pk_bf16_f32 v59, v38, v39
    v_mfma_f32_32x32x16_bf16 a[0:15], a[232:235], v[48:51], a[0:15]
    v_exp_f32 v42, v42
    v_exp_f32 v43, v43
    v_cvt_pk_bf16_f32 v60, v40, v41
    v_exp_f32 v44, v44
    v_exp_f32 v45, v45
    v_cvt_pk_bf16_f32 v61, v42, v43
    v_mfma_f32_32x32x16_bf16 a[0:15], a[236:239], v[52:55], a[0:15]
    v_exp_f32 v46, v46
    v_exp_f32 v47, v47
    v_cvt_pk_bf16_f32 v62, v44, v45
    v_exp_f32 v16, v16
    v_exp_f32 v17, v17
    v_cvt_pk_bf16_f32 v63, v46, v47
    v_mfma_f32_32x32x16_bf16 v[32:47], a[224:227], a[184:187], 0
    v_exp_f32 v18, v18
    v_exp_f32 v19, v19
    v_cvt_pk_bf16_f32 v48, v16, v17
    v_exp_f32 v20, v20
    v_exp_f32 v21, v21
    v_cvt_pk_bf16_f32 v49, v18, v19
    v_mfma_f32_32x32x16_bf16 v[32:47], a[228:231], a[188:191], v[32:47]
    global_load_dwordx4 a[116:119], v2, s[100:101] offset:2048 sc1
    v_exp_f32 v22, v22
    v_exp_f32 v23, v23
    v_cvt_pk_bf16_f32 v50, v20, v21
    v_exp_f32 v24, v24
    v_exp_f32 v25, v25
    v_cvt_pk_bf16_f32 v51, v22, v23
    v_mfma_f32_32x32x16_bf16 a[16:31], a[232:235], v[56:59], a[16:31]
    v_exp_f32 v26, v26
    v_exp_f32 v27, v27
    v_cvt_pk_bf16_f32 v52, v24, v25
    v_exp_f32 v28, v28
    v_exp_f32 v29, v29
    v_cvt_pk_bf16_f32 v53, v26, v27
    v_mfma_f32_32x32x16_bf16 a[16:31], a[236:239], v[60:63], a[16:31]
    global_load_dwordx4 a[120:123], v2, s[64:65] offset:3072 sc1
    v_exp_f32 v30, v30
    v_exp_f32 v31, v31
    v_cvt_pk_bf16_f32 v54, v28, v29
    v_exp_f32 v32, v32
    v_exp_f32 v33, v33
    v_cvt_pk_bf16_f32 v55, v30, v31
    s_waitcnt vmcnt(16)
    v_mfma_f32_32x32x16_bf16 v[16:31], a[240:243], a[160:163], 0
    v_exp_f32 v34, v34
    v_exp_f32 v35, v35
    v_cvt_pk_bf16_f32 v56, v32, v33
    v_exp_f32 v36, v36
    v_exp_f32 v37, v37
    v_cvt_pk_bf16_f32 v57, v34, v35
    v_mfma_f32_32x32x16_bf16 v[16:31], a[244:247], a[164:167], v[16:31]
    global_load_dwordx4 a[124:127], v2, s[100:101] offset:3072 sc1
    v_exp_f32 v38, v38
    v_exp_f32 v39, v39
    v_cvt_pk_bf16_f32 v58, v36, v37
    v_exp_f32 v40, v40
    v_exp_f32 v41, v41
    v_cvt_pk_bf16_f32 v59, v38, v39
    v_mfma_f32_32x32x16_bf16 a[32:47], a[232:235], v[48:51], a[32:47]
    v_exp_f32 v42, v42
    v_exp_f32 v43, v43
    v_cvt_pk_bf16_f32 v60, v40, v41
    v_exp_f32 v44, v44
    v_exp_f32 v45, v45
    v_cvt_pk_bf16_f32 v61, v42, v43
    v_mfma_f32_32x32x16_bf16 a[32:47], a[236:239], v[52:55], a[32:47]
    s_add_u32 s64, s64, 4096
    s_addc_u32 s65, s65, 0
    global_load_dwordx4 a[128:131], v2, s[64:65] offset:0 sc1
    v_exp_f32 v46, v46
    v_exp_f32 v47, v47
    v_cvt_pk_bf16_f32 v62, v44, v45
    v_exp_f32 v16, v16
    v_exp_f32 v17, v17
    v_cvt_pk_bf16_f32 v63, v46, v47
    v_mfma_f32_32x32x16_bf16 v[32:47], a[240:243], a[168:171], 0
    v_exp_f32 v18, v18
    v_exp_f32 v19, v19
    v_cvt_pk_bf16_f32 v48, v16, v17
    v_exp_f32 v20, v20
    v_exp_f32 v21, v21
    v_cvt_pk_bf16_f32 v49, v18, v19
    v_mfma_f32_32x32x16_bf16 v[32:47], a[244:247], a[172:175], v[32:47]
    s_add_u32 s100, s100, 4096
    s_addc_u32 s101, s101, 0
    global_load_dwordx4 a[132:135], v2, s[100:101] offset:0 sc1
    global_load_dwordx4 a[136:139], v2, s[64:65] offset:1024 sc1
    v_exp_f32 v22, v22
    v_exp_f32 v23, v23
    v_cvt_pk_bf16_f32 v50, v20, v21
    v_exp_f32 v24, v24
    v_exp_f32 v25, v25
    v_cvt_pk_bf16_f32 v51, v22, v23
    v_mfma_f32_32x32x16_bf16 a[48:63], a[232:235], v[56:59], a[48:63]
    v_exp_f32 v26, v26
    v_exp_f32 v27, v27
    v_cvt_pk_bf16_f32 v52, v24, v25
    v_exp_f32 v28, v28
    v_exp_f32 v29, v29
    v_cvt_pk_bf16_f32 v53, v26, v27
    v_mfma_f32_32x32x16_bf16 a[48:63], a[236:239], v[60:63], a[48:63]
    global_load_dwordx4 a[140:143], v2, s[100:101] offset:1024 sc1
    v_exp_f32 v30, v30
    v_exp_f32 v31, v31
    v_cvt_pk_bf16_f32 v54, v28, v29
    v_exp_f32 v32, v32
    v_exp_f32 v33, v33
    v_cvt_pk_bf16_f32 v55, v30, v31
    v_mfma_f32_32x32x16_bf16 v[16:31], a[240:243], a[176:179], 0
    v_exp_f32 v34, v34
    v_exp_f32 v35, v35
    v_cvt_pk_bf16_f32 v56, v32, v33
    v_exp_f32 v36, v36
    v_exp_f32 v37, v37
    v_cvt_pk_bf16_f32 v57, v34, v35
    v_mfma_f32_32x32x16_bf16 v[16:31], a[244:247], a[180:183], v[16:31]
    v_exp_f32 v38, v38
    v_exp_f32 v39, v39
    v_cvt_pk_bf16_f32 v58, v36, v37
    v_exp_f32 v40, v40
    v_exp_f32 v41, v41
    v_cvt_pk_bf16_f32 v59, v38, v39
    v_mfma_f32_32x32x16_bf16 a[0:15], a[248:251], v[48:51], a[0:15]
    v_exp_f32 v42, v42
    v_exp_f32 v43, v43
    v_cvt_pk_bf16_f32 v60, v40, v41
    v_exp_f32 v44, v44
    v_exp_f32 v45, v45
    v_cvt_pk_bf16_f32 v61, v42, v43
    v_mfma_f32_32x32x16_bf16 a[0:15], a[252:255], v[52:55], a[0:15]
    v_exp_f32 v46, v46
    v_exp_f32 v47, v47
    v_cvt_pk_bf16_f32 v62, v44, v45
    v_exp_f32 v16, v16
    v_exp_f32 v17, v17
    v_cvt_pk_bf16_f32 v63, v46, v47
    v_mfma_f32_32x32x16_bf16 v[32:47], a[240:243], a[184:187], 0
    v_exp_f32 v18, v18
    v_exp_f32 v19, v19
    v_cvt_pk_bf16_f32 v48, v16, v17
    v_exp_f32 v20, v20
    v_exp_f32 v21, v21
    v_cvt_pk_bf16_f32 v49, v18, v19
    v_mfma_f32_32x32x16_bf16 v[32:47], a[244:247], a[188:191], v[32:47]
    global_load_dwordx4 a[144:147], v2, s[64:65] offset:2048 sc1
    v_exp_f32 v22, v22
    v_exp_f32 v23, v23
    v_cvt_pk_bf16_f32 v50, v20, v21
    v_exp_f32 v24, v24
    v_exp_f32 v25, v25
    v_cvt_pk_bf16_f32 v51, v22, v23
    v_mfma_f32_32x32x16_bf16 a[16:31], a[248:251], v[56:59], a[16:31]
    v_exp_f32 v26, v26
    v_exp_f32 v27, v27
    v_cvt_pk_bf16_f32 v52, v24, v25
    v_exp_f32 v28, v28
    v_exp_f32 v29, v29
    v_cvt_pk_bf16_f32 v53, v26, v27
    v_mfma_f32_32x32x16_bf16 a[16:31], a[252:255], v[60:63], a[16:31]
    global_load_dwordx4 a[148:151], v2, s[100:101] offset:2048 sc1
    v_exp_f32 v30, v30
    v_exp_f32 v31, v31
    v_cvt_pk_bf16_f32 v54, v28, v29
    v_exp_f32 v32, v32
    v_exp_f32 v33, v33
    v_cvt_pk_bf16_f32 v55, v30, v31
    v_exp_f32 v34, v34
    v_exp_f32 v35, v35
    v_cvt_pk_bf16_f32 v56, v32, v33
    v_exp_f32 v36, v36
    v_exp_f32 v37, v37
    v_cvt_pk_bf16_f32 v57, v34, v35
    global_load_dwordx4 a[152:155], v2, s[64:65] offset:3072 sc1
    v_exp_f32 v38, v38
    v_exp_f32 v39, v39
    v_cvt_pk_bf16_f32 v58, v36, v37
    v_exp_f32 v40, v40
    v_exp_f32 v41, v41
    v_cvt_pk_bf16_f32 v59, v38, v39
    v_mfma_f32_32x32x16_bf16 a[32:47], a[248:251], v[48:51], a[32:47]
    v_exp_f32 v42, v42
    v_exp_f32 v43, v43
    v_cvt_pk_bf16_f32 v60, v40, v41
    v_exp_f32 v44, v44
    v_exp_f32 v45, v45
    v_cvt_pk_bf16_f32 v61, v42, v43
    v_mfma_f32_32x32x16_bf16 a[32:47], a[252:255], v[52:55], a[32:47]
    global_load_dwordx4 a[156:159], v2, s[100:101] offset:3072 sc1
    v_exp_f32 v46, v46
    v_exp_f32 v47, v47
    v_cvt_pk_bf16_f32 v62, v44, v45
    v_cvt_pk_bf16_f32 v63, v46, v47
    s_nop 1
    v_mfma_f32_32x32x16_bf16 a[48:63], a[248:251], v[56:59], a[48:63]
    v_mfma_f32_32x32x16_bf16 a[48:63], a[252:255], v[60:63], a[48:63]
    s_nop 3
    ds_write_b128 v11, a[16:19] offset:0
    ds_write_b128 v11, a[20:23] offset:1024
    ds_write_b128 v11, a[24:27] offset:2048
    ds_write_b128 v11, a[28:31] offset:3072
    ds_write_b128 v12, a[32:35] offset:4096
    ds_write_b128 v12, a[36:39] offset:5120
    ds_write_b128 v12, a[40:43] offset:6144
    ds_write_b128 v12, a[44:47] offset:7168
    s_nop 1
    ds_write_b128 v13, a[48:51] offset:8192
    ds_write_b128 v13, a[52:55] offset:9216
    ds_write_b128 v13, a[56:59] offset:10240
    ds_write_b128 v13, a[60:63] offset:11264
    s_waitcnt lgkmcnt(0)
    s_barrier
    ds_read_b128 v[16:19], v10 offset:0
    ds_read_b128 v[20:23], v10 offset:1024
    ds_read_b128 v[24:27], v10 offset:2048
    ds_read_b128 v[28:31], v10 offset:3072
    ds_read_b128 v[32:35], v10 offset:4096
    ds_read_b128 v[36:39], v10 offset:5120
    ds_read_b128 v[40:43], v10 offset:6144
    ds_read_b128 v[44:47], v10 offset:7168
    ds_read_b128 v[48:51], v10 offset:8192
    ds_read_b128 v[52:55], v10 offset:9216
    ds_read_b128 v[56:59], v10 offset:10240
    ds_read_b128 v[60:63], v10 offset:11264
    s_waitcnt lgkmcnt(4)
    v_add_f32 v16, v16, v32
    v_add_f32 v17, v17, v33
    v_add_f32 v18, v18, v34
    v_add_f32 v19, v19, v35
    v_add_f32 v20, v20, v36
    v_add_f32 v21, v21, v37
    v_add_f32 v22, v22, v38
    v_add_f32 v23, v23, v39
    v_add_f32 v24, v24, v40
    v_add_f32 v25, v25, v41
    v_add_f32 v26, v26, v42
    v_add_f32 v27, v27, v43
    v_add_f32 v28, v28, v44
    v_add_f32 v29, v29, v45
    v_add_f32 v30, v30, v46
    v_add_f32 v31, v31, v47
    v_accvgpr_read_b32 v32, a0
    v_accvgpr_read_b32 v33, a1
    v_accvgpr_read_b32 v34, a2
    v_accvgpr_read_b32 v35, a3
    v_accvgpr_read_b32 v36, a4
    v_accvgpr_read_b32 v37, a5
    v_accvgpr_read_b32 v38, a6
    v_accvgpr_read_b32 v39, a7
    v_accvgpr_read_b32 v40, a8
    v_accvgpr_read_b32 v41, a9
    v_accvgpr_read_b32 v42, a10
    v_accvgpr_read_b32 v43, a11
    v_accvgpr_read_b32 v44, a12
    v_accvgpr_read_b32 v45, a13
    v_accvgpr_read_b32 v46, a14
    v_accvgpr_read_b32 v47, a15
    s_waitcnt lgkmcnt(0)
    v_add_f32 v16, v16, v48
    v_add_f32 v17, v17, v49
    v_add_f32 v18, v18, v50
    v_add_f32 v19, v19, v51
    v_add_f32 v20, v20, v52
    v_add_f32 v21, v21, v53
    v_add_f32 v22, v22, v54
    v_add_f32 v23, v23, v55
    v_add_f32 v24, v24, v56
    v_add_f32 v25, v25, v57
    v_add_f32 v26, v26, v58
    v_add_f32 v27, v27, v59
    v_add_f32 v28, v28, v60
    v_add_f32 v29, v29, v61
    v_add_f32 v30, v30, v62
    v_add_f32 v31, v31, v63
    v_add_f32 v16, v16, v32
    v_add_f32 v17, v17, v33
    v_add_f32 v18, v18, v34
    v_add_f32 v19, v19, v35
    v_add_f32 v20, v20, v36
    v_add_f32 v21, v21, v37
    v_add_f32 v22, v22, v38
    v_add_f32 v23, v23, v39
    v_add_f32 v24, v24, v40
    v_add_f32 v25, v25, v41
    v_add_f32 v26, v26, v42
    v_add_f32 v27, v27, v43
    v_add_f32 v28, v28, v44
    v_add_f32 v29, v29, v45
    v_add_f32 v30, v30, v46
    v_add_f32 v31, v31, v47
    v_mov_b32 v32, v31
    v_mov_b32 v33, v31
    v_mul_f32 v34, 0, v16
    v_fmac_f32 v34, 0, v17
    v_fmac_f32 v34, 0, v18
    v_fmac_f32 v34, 0, v19
    v_fmac_f32 v34, 0, v20
    v_fmac_f32 v34, 0, v21
    v_fmac_f32 v34, 0, v22
    v_fmac_f32 v34, 0, v23
    v_fmac_f32 v34, 0, v24
    v_fmac_f32 v34, 0, v25
    v_fmac_f32 v34, 0, v26
    v_fmac_f32 v34, 0, v27
    v_fmac_f32 v34, 0, v28
    v_fmac_f32 v34, 0, v29
    v_fmac_f32 v34, 0, v30
    v_fmac_f32 v34, 0, v31
    v_permlane32_swap_b32 v32, v33
    s_mov_b32 s4, 0x17800000
    s_mov_b32 s5, 0x71800000
    v_cmp_nle_f32 vcc, s4, v33
    v_cmp_nge_f32 s[6:7], s5, v33
    v_cmp_u_f32 s[8:9], v34, v34
    s_nop 1
    s_or_b64 s[6:7], s[6:7], s[8:9]
    s_or_b64 vcc, vcc, s[6:7]
    s_cbranch_vccnz attn_slow
attn_norm:
    v_rcp_f32 v33, v33
    s_lshl_b32 s4, s11, 2
    s_add_u32 s4, s4, s36
    s_lshl_b32 s4, s4, 4
    s_add_u32 s4, s4, s10
    s_lshl_b32 s4, s4, 11
    s_add_u32 s4, s4, 6291456
    v_add_u32 v45, s4, v2
    s_and_b32 s69, s39, 0x3fff
    s_add_u32 s69, s69, 0x2000
    s_lshl_b32 s69, s69, 16
    v_mov_b32 v7, s69
    v_mul_f32 v16, v16, v33
    v_mul_f32 v17, v17, v33
    v_mul_f32 v18, v18, v33
    v_mul_f32 v19, v19, v33
    v_mul_f32 v20, v20, v33
    v_mul_f32 v21, v21, v33
    v_mul_f32 v22, v22, v33
    v_mul_f32 v24, v24, v33
    v_mul_f32 v25, v25, v33
    v_mul_f32 v26, v26, v33
    v_mul_f32 v27, v27, v33
    v_mul_f32 v28, v28, v33
    v_mul_f32 v29, v29, v33
    v_mul_f32 v30, v30, v33
    v_cvt_pk_bf16_f32 v36, v16, v17
    v_cvt_pk_bf16_f32 v37, v18, v19
    v_cvt_pk_bf16_f32 v38, v20, v21
    v_cvt_pk_bf16_f32 v39, v22, v7
    v_cvt_pk_bf16_f32 v40, v24, v25
    v_cvt_pk_bf16_f32 v41, v26, v27
    v_cvt_pk_bf16_f32 v42, v28, v29
    v_cvt_pk_bf16_f32 v43, v30, v7
    global_store_dwordx4 v45, v[36:39], s[34:35] sc1
    global_store_dwordx4 v45, v[40:43], s[34:35] offset:1024 sc1
    s_and_b32 s4, s36, 1
    s_lshl_b32 s4, s4, 5
    s_lshl_b32 s5, s12, 6
    s_add_u32 s4, s4, s5
    s_mul_i32 s4, s4, 896
    s_lshr_b32 s5, s36, 1
    s_lshl_b32 s5, s5, 6
    s_lshl_b32 s6, s13, 7
    s_add_u32 s4, s4, s5
    s_add_u32 s4, s4, s6
    v_and_b32 v6, 31, v1
    v_mul_u32_u24 v6, 896, v6
    v_lshrrev_b32 v15, 5, v1
    v_lshl_add_u32 v6, v15, 4, v6
    v_add_u32 v6, s4, v6
    s_cmp_lg_u32 s14, 0
    s_cbranch_scc1 do_final
    s_endpgm
do_final:
    v_lshrrev_b32 v16, 3, v1
    v_cmp_eq_u32 vcc, 7, v16
    v_mov_b32 v17, 0x7ff00000
    s_nop 0
    v_cndmask_b32 v12, v5, v17, vcc
    v_lshrrev_b32 v16, 5, v1
    v_lshlrev_b32 v16, 9, v16
    v_add_u32 v10, v16, v8
    v_add_u32 v11, v16, v9
    s_lshr_b32 s4, s69, 16
    s_or_b32 s4, s4, s69
    v_mov_b32 v13, s4
    s_mov_b32 s96, 0x07060302
    s_add_u32 s48, s34, 0
    s_addc_u32 s49, s35, 0
    s_and_b32 s49, s49, 0xffff
    s_mov_b32 s50, 8388608
.p2align 6
    s_nop 0
    s_waitcnt vmcnt(54)
    v_mfma_f32_32x32x16_bf16 a[0:15], v[192:195], v[64:67], 0
    v_mfma_f32_32x32x16_bf16 a[16:31], v[192:195], v[68:71], 0
    s_add_u32 m0, s61, 0
    s_add_u32 s99, s97, 286720
    buffer_load_dwordx4 v5, s[40:43], s99 offen lds
    v_mfma_f32_32x32x16_bf16 a[32:47], v[196:199], v[64:67], 0
    s_add_u32 m0, s61, 1024
    s_add_u32 s99, s97, 293888
    buffer_load_dwordx4 v5, s[40:43], s99 offen lds
    v_mfma_f32_32x32x16_bf16 a[48:63], v[196:199], v[68:71], 0
    v_mfma_f32_32x32x16_bf16 a[0:15], v[200:203], v[72:75], a[0:15]
    v_mfma_f32_32x32x16_bf16 a[16:31], v[200:203], v[76:79], a[16:31]
    s_add_u32 m0, s61, 2048
    s_add_u32 s99, s97, 301056
    buffer_load_dwordx4 v5, s[40:43], s99 offen lds
    v_mfma_f32_32x32x16_bf16 a[32:47], v[204:207], v[72:75], a[32:47]
    s_add_u32 m0, s61, 3072
    s_add_u32 s99, s97, 308224
    buffer_load_dwordx4 v5, s[40:43], s99 offen lds
    v_mfma_f32_32x32x16_bf16 a[48:63], v[204:207], v[76:79], a[48:63]
    v_mfma_f32_32x32x16_bf16 a[0:15], v[208:211], v[80:83], a[0:15]
    v_mfma_f32_32x32x16_bf16 a[16:31], v[208:211], v[84:87], a[16:31]
    s_add_u32 m0, s61, 4096
    s_add_u32 s99, s97, 315392
    buffer_load_dwordx4 v5, s[40:43], s99 offen lds
    v_mfma_f32_32x32x16_bf16 a[32:47], v[212:215], v[80:83], a[32:47]
    s_add_u32 m0, s61, 5120
    s_add_u32 s99, s97, 322560
    buffer_load_dwordx4 v5, s[40:43], s99 offen lds
    v_mfma_f32_32x32x16_bf16 a[48:63], v[212:215], v[84:87], a[48:63]
    v_mfma_f32_32x32x16_bf16 a[0:15], v[216:219], v[88:91], a[0:15]
    v_mfma_f32_32x32x16_bf16 a[16:31], v[216:219], v[92:95], a[16:31]
    s_add_u32 m0, s61, 6144
    s_add_u32 s99, s97, 329728
    buffer_load_dwordx4 v5, s[40:43], s99 offen lds
    v_mfma_f32_32x32x16_bf16 a[32:47], v[220:223], v[88:91], a[32:47]
    s_add_u32 m0, s61, 7168
    s_add_u32 s99, s97, 336896
    buffer_load_dwordx4 v5, s[40:43], s99 offen lds
    v_mfma_f32_32x32x16_bf16 a[48:63], v[220:223], v[92:95], a[48:63]
    v_mfma_f32_32x32x16_bf16 a[0:15], v[224:227], v[96:99], a[0:15]
    v_mfma_f32_32x32x16_bf16 a[16:31], v[224:227], v[100:103], a[16:31]
    s_add_u32 m0, s61, 8192
    s_add_u32 s99, s97, 344064
    buffer_load_dwordx4 v5, s[40:43], s99 offen lds
    v_mfma_f32_32x32x16_bf16 a[32:47], v[228:231], v[96:99], a[32:47]
    s_add_u32 m0, s61, 9216
    s_add_u32 s99, s97, 351232
    buffer_load_dwordx4 v5, s[40:43], s99 offen lds
    v_mfma_f32_32x32x16_bf16 a[48:63], v[228:231], v[100:103], a[48:63]
    v_mfma_f32_32x32x16_bf16 a[0:15], v[232:235], v[104:107], a[0:15]
    v_mfma_f32_32x32x16_bf16 a[16:31], v[232:235], v[108:111], a[16:31]
    s_add_u32 m0, s61, 10240
    s_add_u32 s99, s97, 358400
    buffer_load_dwordx4 v5, s[40:43], s99 offen lds
    v_mfma_f32_32x32x16_bf16 a[32:47], v[236:239], v[104:107], a[32:47]
    s_add_u32 m0, s61, 11264
    s_add_u32 s99, s97, 365568
    buffer_load_dwordx4 v5, s[40:43], s99 offen lds
    v_mfma_f32_32x32x16_bf16 a[48:63], v[236:239], v[108:111], a[48:63]
    v_mfma_f32_32x32x16_bf16 a[0:15], v[240:243], v[112:115], a[0:15]
    ds_read_b64_tr_b16 a[160:161], v8 offset:32768
    ds_read_b64_tr_b16 a[162:163], v8 offset:33792
    v_mfma_f32_32x32x16_bf16 a[16:31], v[240:243], v[116:119], a[16:31]
    ds_read_b64_tr_b16 a[164:165], v9 offset:32768
    ds_read_b64_tr_b16 a[166:167], v9 offset:33792
    s_add_u32 m0, s61, 12288
    s_add_u32 s99, s97, 372736
    buffer_load_dwordx4 v5, s[40:43], s99 offen lds
    v_mfma_f32_32x32x16_bf16 a[32:47], v[244:247], v[112:115], a[32:47]
    s_add_u32 m0, s61, 13312
    s_add_u32 s99, s97, 379904
    buffer_load_dwordx4 v5, s[40:43], s99 offen lds
    v_mfma_f32_32x32x16_bf16 a[48:63], v[244:247], v[116:119], a[48:63]
    v_mfma_f32_32x32x16_bf16 a[0:15], v[248:251], v[120:123], a[0:15]
    ds_read_b64_tr_b16 a[168:169], v8 offset:34816
    ds_read_b64_tr_b16 a[170:171], v8 offset:35840
    v_mfma_f32_32x32x16_bf16 a[16:31], v[248:251], v[124:127], a[16:31]
    ds_read_b64_tr_b16 a[172:173], v9 offset:34816
    ds_read_b64_tr_b16 a[174:175], v9 offset:35840
    s_add_u32 m0, s61, 14336
    s_add_u32 s99, s97, 387072
    buffer_load_dwordx4 v5, s[40:43], s99 offen lds
    v_mfma_f32_32x32x16_bf16 a[32:47], v[252:255], v[120:123], a[32:47]
    s_add_u32 m0, s61, 15360
    s_add_u32 s99, s97, 394240
    buffer_load_dwordx4 v5, s[40:43], s99 offen lds
    v_mfma_f32_32x32x16_bf16 a[48:63], v[252:255], v[124:127], a[48:63]
    s_waitcnt vmcnt(42)
    s_waitcnt lgkmcnt(4)
    v_mfma_f32_32x32x16_bf16 a[0:15], a[160:163], v[128:131], a[0:15]
    ds_read_b64_tr_b16 a[176:177], v8 offset:36864
    ds_read_b64_tr_b16 a[178:179], v8 offset:37888
    v_mfma_f32_32x32x16_bf16 a[16:31], a[160:163], v[132:135], a[16:31]
    ds_read_b64_tr_b16 a[180:181], v9 offset:36864
    ds_read_b64_tr_b16 a[182:183], v9 offset:37888
    v_mfma_f32_32x32x16_bf16 a[32:47], a[164:167], v[128:131], a[32:47]
    v_mfma_f32_32x32x16_bf16 a[48:63], a[164:167], v[132:135], a[48:63]
    s_waitcnt lgkmcnt(4)
    v_mfma_f32_32x32x16_bf16 a[0:15], a[168:171], v[136:139], a[0:15]
    ds_read_b64_tr_b16 a[184:185], v8 offset:38912
    ds_read_b64_tr_b16 a[186:187], v8 offset:39936
    v_mfma_f32_32x32x16_bf16 a[16:31], a[168:171], v[140:143], a[16:31]
    ds_read_b64_tr_b16 a[188:189], v9 offset:38912
    ds_read_b64_tr_b16 a[190:191], v9 offset:39936
    v_mfma_f32_32x32x16_bf16 a[32:47], a[172:175], v[136:139], a[32:47]
    v_mfma_f32_32x32x16_bf16 a[48:63], a[172:175], v[140:143], a[48:63]
    s_waitcnt lgkmcnt(4)
    v_mfma_f32_32x32x16_bf16 a[0:15], a[176:179], v[144:147], a[0:15]
    s_waitcnt vmcnt(63)
    ds_read_b64_tr_b16 a[160:161], v8 offset:16384
    ds_read_b64_tr_b16 a[162:163], v8 offset:17408
    v_mfma_f32_32x32x16_bf16 a[16:31], a[176:179], v[148:151], a[16:31]
    ds_read_b64_tr_b16 a[164:165], v9 offset:16384
    ds_read_b64_tr_b16 a[166:167], v9 offset:17408
    v_mfma_f32_32x32x16_bf16 a[32:47], a[180:183], v[144:147], a[32:47]
    v_mfma_f32_32x32x16_bf16 a[48:63], a[180:183], v[148:151], a[48:63]
    s_waitcnt lgkmcnt(4)
    v_mfma_f32_32x32x16_bf16 a[0:15], a[184:187], v[152:155], a[0:15]
    ds_read_b64_tr_b16 a[168:169], v8 offset:18432
    ds_read_b64_tr_b16 a[170:171], v8 offset:19456
    v_mfma_f32_32x32x16_bf16 a[16:31], a[184:187], v[156:159], a[16:31]
    ds_read_b64_tr_b16 a[172:173], v9 offset:18432
    ds_read_b64_tr_b16 a[174:175], v9 offset:19456
    v_mfma_f32_32x32x16_bf16 a[32:47], a[188:191], v[152:155], a[32:47]
    v_mfma_f32_32x32x16_bf16 a[48:63], a[188:191], v[156:159], a[48:63]
    s_waitcnt lgkmcnt(4)
    v_mfma_f32_32x32x16_bf16 a[0:15], a[160:163], v[160:163], a[0:15]
    ds_read_b64_tr_b16 a[176:177], v8 offset:20480
    ds_read_b64_tr_b16 a[178:179], v8 offset:21504
    v_mfma_f32_32x32x16_bf16 a[16:31], a[160:163], v[164:167], a[16:31]
    ds_read_b64_tr_b16 a[180:181], v9 offset:20480
    ds_read_b64_tr_b16 a[182:183], v9 offset:21504
    s_add_u32 m0, s61, 32768
    s_add_u32 s99, s67, 0
    buffer_load_dwordx4 v12, s[44:47], s99 offen lds
    v_mfma_f32_32x32x16_bf16 a[32:47], a[164:167], v[160:163], a[32:47]
    s_add_u32 m0, s61, 33792
    s_add_u32 s99, s67, 6272
    buffer_load_dwordx4 v12, s[44:47], s99 offen lds
    v_mfma_f32_32x32x16_bf16 a[48:63], a[164:167], v[164:167], a[48:63]
    s_waitcnt lgkmcnt(4)
    v_mfma_f32_32x32x16_bf16 a[0:15], a[168:171], v[168:171], a[0:15]
    ds_read_b64_tr_b16 a[184:185], v8 offset:22528
    ds_read_b64_tr_b16 a[186:187], v8 offset:23552
    v_mfma_f32_32x32x16_bf16 a[16:31], a[168:171], v[172:175], a[16:31]
    ds_read_b64_tr_b16 a[188:189], v9 offset:22528
    ds_read_b64_tr_b16 a[190:191], v9 offset:23552
    s_add_u32 m0, s61, 34816
    s_add_u32 s99, s67, 12544
    buffer_load_dwordx4 v12, s[44:47], s99 offen lds
    v_mfma_f32_32x32x16_bf16 a[32:47], a[172:175], v[168:171], a[32:47]
    s_add_u32 m0, s61, 35840
    s_add_u32 s99, s67, 18816
    buffer_load_dwordx4 v12, s[44:47], s99 offen lds
    v_mfma_f32_32x32x16_bf16 a[48:63], a[172:175], v[172:175], a[48:63]
    s_waitcnt lgkmcnt(4)
    v_mfma_f32_32x32x16_bf16 a[0:15], a[176:179], v[176:179], a[0:15]
    s_waitcnt vmcnt(63)
    ds_read_b64_tr_b16 a[160:161], v8 offset:24576
    ds_read_b64_tr_b16 a[162:163], v8 offset:25600
    v_mfma_f32_32x32x16_bf16 a[16:31], a[176:179], v[180:183], a[16:31]
    ds_read_b64_tr_b16 a[164:165], v9 offset:24576
    ds_read_b64_tr_b16 a[166:167], v9 offset:25600
    s_add_u32 m0, s61, 36864
    s_add_u32 s99, s67, 25088
    buffer_load_dwordx4 v12, s[44:47], s99 offen lds
    v_mfma_f32_32x32x16_bf16 a[32:47], a[180:183], v[176:179], a[32:47]
    s_add_u32 m0, s61, 37888
    s_add_u32 s99, s67, 31360
    buffer_load_dwordx4 v12, s[44:47], s99 offen lds
    v_mfma_f32_32x32x16_bf16 a[48:63], a[180:183], v[180:183], a[48:63]
    s_waitcnt lgkmcnt(4)
    v_mfma_f32_32x32x16_bf16 a[0:15], a[184:187], v[184:187], a[0:15]
    ds_read_b64_tr_b16 a[168:169], v8 offset:26624
    ds_read_b64_tr_b16 a[170:171], v8 offset:27648
    v_mfma_f32_32x32x16_bf16 a[16:31], a[184:187], v[188:191], a[16:31]
    ds_read_b64_tr_b16 a[172:173], v9 offset:26624
    ds_read_b64_tr_b16 a[174:175], v9 offset:27648
    s_add_u32 m0, s61, 38912
    s_add_u32 s99, s67, 37632
    buffer_load_dwordx4 v12, s[44:47], s99 offen lds
    v_mfma_f32_32x32x16_bf16 a[32:47], a[188:191], v[184:187], a[32:47]
    s_add_u32 m0, s61, 39936
    s_add_u32 s99, s67, 43904
    buffer_load_dwordx4 v12, s[44:47], s99 offen lds
    v_mfma_f32_32x32x16_bf16 a[48:63], a[188:191], v[188:191], a[48:63]
    s_waitcnt vmcnt(34)
    s_waitcnt lgkmcnt(4)
    v_mfma_f32_32x32x16_bf16 a[0:15], a[160:163], a[64:67], a[0:15]
    ds_read_b64_tr_b16 a[176:177], v8 offset:28672
    ds_read_b64_tr_b16 a[178:179], v8 offset:29696
    v_mfma_f32_32x32x16_bf16 a[16:31], a[160:163], a[68:71], a[16:31]
    ds_read_b64_tr_b16 a[180:181], v9 offset:28672
    ds_read_b64_tr_b16 a[182:183], v9 offset:29696
    s_add_u32 m0, s61, 16384
    s_add_u32 s99, s67, 50176
    buffer_load_dwordx4 v12, s[44:47], s99 offen lds
    v_mfma_f32_32x32x16_bf16 a[32:47], a[164:167], a[64:67], a[32:47]
    s_add_u32 m0, s61, 17408
    s_add_u32 s99, s67, 56448
    buffer_load_dwordx4 v12, s[44:47], s99 offen lds
    v_mfma_f32_32x32x16_bf16 a[48:63], a[164:167], a[68:71], a[48:63]
    s_waitcnt lgkmcnt(4)
    v_mfma_f32_32x32x16_bf16 a[0:15], a[168:171], a[72:75], a[0:15]
    ds_read_b64_tr_b16 a[184:185], v8 offset:30720
    ds_read_b64_tr_b16 a[186:187], v8 offset:31744
    v_mfma_f32_32x32x16_bf16 a[16:31], a[168:171], a[76:79], a[16:31]
    ds_read_b64_tr_b16 a[188:189], v9 offset:30720
    ds_read_b64_tr_b16 a[190:191], v9 offset:31744
    s_add_u32 m0, s61, 18432
    s_add_u32 s99, s67, 62720
    buffer_load_dwordx4 v12, s[44:47], s99 offen lds
    v_mfma_f32_32x32x16_bf16 a[32:47], a[172:175], a[72:75], a[32:47]
    s_add_u32 m0, s61, 19456
    s_add_u32 s99, s67, 68992
    buffer_load_dwordx4 v12, s[44:47], s99 offen lds
    v_mfma_f32_32x32x16_bf16 a[48:63], a[172:175], a[76:79], a[48:63]
    s_waitcnt lgkmcnt(4)
    v_mfma_f32_32x32x16_bf16 a[0:15], a[176:179], a[80:83], a[0:15]
    s_waitcnt vmcnt(20)
    ds_read_b64_tr_b16 a[160:161], v8 offset:0
    ds_read_b64_tr_b16 a[162:163], v8 offset:1024
    v_mfma_f32_32x32x16_bf16 a[16:31], a[176:179], a[84:87], a[16:31]
    ds_read_b64_tr_b16 a[164:165], v9 offset:0
    ds_read_b64_tr_b16 a[166:167], v9 offset:1024
    s_add_u32 m0, s61, 20480
    s_add_u32 s99, s67, 75264
    buffer_load_dwordx4 v12, s[44:47], s99 offen lds
    v_mfma_f32_32x32x16_bf16 a[32:47], a[180:183], a[80:83], a[32:47]
    s_add_u32 m0, s61, 21504
    s_add_u32 s99, s67, 81536
    buffer_load_dwordx4 v12, s[44:47], s99 offen lds
    v_mfma_f32_32x32x16_bf16 a[48:63], a[180:183], a[84:87], a[48:63]
    s_waitcnt lgkmcnt(4)
    v_mfma_f32_32x32x16_bf16 a[0:15], a[184:187], a[88:91], a[0:15]
    ds_read_b64_tr_b16 a[168:169], v8 offset:2048
    ds_read_b64_tr_b16 a[170:171], v8 offset:3072
    v_mfma_f32_32x32x16_bf16 a[16:31], a[184:187], a[92:95], a[16:31]
    ds_read_b64_tr_b16 a[172:173], v9 offset:2048
    ds_read_b64_tr_b16 a[174:175], v9 offset:3072
    s_add_u32 m0, s61, 22528
    s_add_u32 s99, s67, 87808
    buffer_load_dwordx4 v12, s[44:47], s99 offen lds
    v_mfma_f32_32x32x16_bf16 a[32:47], a[188:191], a[88:91], a[32:47]
    s_add_u32 m0, s61, 23552
    s_add_u32 s99, s67, 94080
    buffer_load_dwordx4 v12, s[44:47], s99 offen lds
    v_mfma_f32_32x32x16_bf16 a[48:63], a[188:191], a[92:95], a[48:63]
    s_waitcnt lgkmcnt(4)
    v_mfma_f32_32x32x16_bf16 a[0:15], a[160:163], a[96:99], a[0:15]
    ds_read_b64_tr_b16 a[176:177], v8 offset:4096
    ds_read_b64_tr_b16 a[178:179], v8 offset:5120
    buffer_load_dwordx4 v[64:67], v2, s[48:51], s58 offen offset:0 sc1
    v_mfma_f32_32x32x16_bf16 a[16:31], a[160:163], a[100:103], a[16:31]
    ds_read_b64_tr_b16 a[180:181], v9 offset:4096
    ds_read_b64_tr_b16 a[182:183], v9 offset:5120
    buffer_load_dwordx4 v[72:75], v2, s[48:51], s58 offen offset:1024 sc1
    v_mfma_f32_32x32x16_bf16 a[32:47], a[164:167], a[96:99], a[32:47]
    buffer_load_dwordx4 v[80:83], v2, s[48:51], s58 offen offset:2048 sc1
    v_mfma_f32_32x32x16_bf16 a[48:63], a[164:167], a[100:103], a[48:63]
    global_load_dwordx4 v[48:51], v6, s[16:17]
    global_load_dwordx4 v[52:55], v6, s[16:17] offset:32
    buffer_load_dwordx4 v[88:91], v2, s[48:51], s58 offen offset:3072 sc1
    s_waitcnt lgkmcnt(4)
    v_mfma_f32_32x32x16_bf16 a[0:15], a[168:171], a[104:107], a[0:15]
    ds_read_b64_tr_b16 a[184:185], v8 offset:6144
    ds_read_b64_tr_b16 a[186:187], v8 offset:7168
    s_add_u32 s4, s58, 4096
    buffer_load_dwordx4 v[96:99], v2, s[48:51], s4 offen offset:0 sc1
    v_mfma_f32_32x32x16_bf16 a[16:31], a[168:171], a[108:111], a[16:31]
    ds_read_b64_tr_b16 a[188:189], v9 offset:6144
    ds_read_b64_tr_b16 a[190:191], v9 offset:7168
    buffer_load_dwordx4 v[104:107], v2, s[48:51], s4 offen offset:1024 sc1
    v_mfma_f32_32x32x16_bf16 a[32:47], a[172:175], a[104:107], a[32:47]
    buffer_load_dwordx4 v[112:115], v2, s[48:51], s4 offen offset:2048 sc1
    v_mfma_f32_32x32x16_bf16 a[48:63], a[172:175], a[108:111], a[48:63]
    buffer_load_dwordx4 v[120:123], v2, s[48:51], s4 offen offset:3072 sc1
    s_waitcnt lgkmcnt(4)
    v_mfma_f32_32x32x16_bf16 a[0:15], a[176:179], a[112:115], a[0:15]
    s_waitcnt vmcnt(26)
    ds_read_b64_tr_b16 a[160:161], v8 offset:8192
    ds_read_b64_tr_b16 a[162:163], v8 offset:9216
    buffer_load_dwordx4 v[68:71], v2, s[48:51], s59 offen offset:0 sc1
    v_mfma_f32_32x32x16_bf16 a[16:31], a[176:179], a[116:119], a[16:31]
    ds_read_b64_tr_b16 a[164:165], v9 offset:8192
    ds_read_b64_tr_b16 a[166:167], v9 offset:9216
    buffer_load_dwordx4 v[76:79], v2, s[48:51], s59 offen offset:1024 sc1
    v_mfma_f32_32x32x16_bf16 a[32:47], a[180:183], a[112:115], a[32:47]
    buffer_load_dwordx4 v[84:87], v2, s[48:51], s59 offen offset:2048 sc1
    v_mfma_f32_32x32x16_bf16 a[48:63], a[180:183], a[116:119], a[48:63]
    buffer_load_dwordx4 v[92:95], v2, s[48:51], s59 offen offset:3072 sc1
    s_waitcnt lgkmcnt(4)
    v_mfma_f32_32x32x16_bf16 a[0:15], a[184:187], a[120:123], a[0:15]
    ds_read_b64_tr_b16 a[168:169], v8 offset:10240
    ds_read_b64_tr_b16 a[170:171], v8 offset:11264
    s_add_u32 s4, s59, 4096
    buffer_load_dwordx4 v[100:103], v2, s[48:51], s4 offen offset:0 sc1
    v_mfma_f32_32x32x16_bf16 a[16:31], a[184:187], a[124:127], a[16:31]
    ds_read_b64_tr_b16 a[172:173], v9 offset:10240
    ds_read_b64_tr_b16 a[174:175], v9 offset:11264
    buffer_load_dwordx4 v[108:111], v2, s[48:51], s4 offen offset:1024 sc1
    v_mfma_f32_32x32x16_bf16 a[32:47], a[188:191], a[120:123], a[32:47]
    buffer_load_dwordx4 v[116:119], v2, s[48:51], s4 offen offset:2048 sc1
    v_mfma_f32_32x32x16_bf16 a[48:63], a[188:191], a[124:127], a[48:63]
    buffer_load_dwordx4 v[124:127], v2, s[48:51], s4 offen offset:3072 sc1
    s_waitcnt vmcnt(52)
    s_waitcnt lgkmcnt(4)
    v_mfma_f32_32x32x16_bf16 a[0:15], a[160:163], a[128:131], a[0:15]
    ds_read_b64_tr_b16 a[176:177], v8 offset:12288
    ds_read_b64_tr_b16 a[178:179], v8 offset:13312
    v_mfma_f32_32x32x16_bf16 a[16:31], a[160:163], a[132:135], a[16:31]
    ds_read_b64_tr_b16 a[180:181], v9 offset:12288
    ds_read_b64_tr_b16 a[182:183], v9 offset:13312
    v_mfma_f32_32x32x16_bf16 a[32:47], a[164:167], a[128:131], a[32:47]
    v_mfma_f32_32x32x16_bf16 a[48:63], a[164:167], a[132:135], a[48:63]
    s_waitcnt lgkmcnt(4)
    v_mfma_f32_32x32x16_bf16 a[0:15], a[168:171], a[136:139], a[0:15]
    ds_read_b64_tr_b16 a[184:185], v8 offset:14336
    ds_read_b64_tr_b16 a[186:187], v8 offset:15360
    v_mfma_f32_32x32x16_bf16 a[16:31], a[168:171], a[140:143], a[16:31]
    ds_read_b64_tr_b16 a[188:189], v9 offset:14336
    ds_read_b64_tr_b16 a[190:191], v9 offset:15360
    v_mfma_f32_32x32x16_bf16 a[32:47], a[172:175], a[136:139], a[32:47]
    v_mfma_f32_32x32x16_bf16 a[48:63], a[172:175], a[140:143], a[48:63]
    s_waitcnt lgkmcnt(4)
    v_mfma_f32_32x32x16_bf16 a[0:15], a[176:179], a[144:147], a[0:15]
    s_waitcnt vmcnt(26)
    ds_read_b64_tr_b16 a[160:161], v10 offset:32768
    ds_read_b64_tr_b16 a[162:163], v10 offset:33280
    v_mfma_f32_32x32x16_bf16 a[16:31], a[176:179], a[148:151], a[16:31]
    ds_read_b64_tr_b16 a[164:165], v11 offset:32768
    ds_read_b64_tr_b16 a[166:167], v11 offset:33280
    v_mfma_f32_32x32x16_bf16 a[32:47], a[180:183], a[144:147], a[32:47]
    v_mfma_f32_32x32x16_bf16 a[48:63], a[180:183], a[148:151], a[48:63]
    s_waitcnt lgkmcnt(4)
    v_mfma_f32_32x32x16_bf16 a[0:15], a[184:187], a[152:155], a[0:15]
    ds_read_b64_tr_b16 a[168:169], v10 offset:34816
    ds_read_b64_tr_b16 a[170:171], v10 offset:35328
    v_mfma_f32_32x32x16_bf16 a[16:31], a[184:187], a[156:159], a[16:31]
    ds_read_b64_tr_b16 a[172:173], v11 offset:34816
    ds_read_b64_tr_b16 a[174:175], v11 offset:35328
    v_mfma_f32_32x32x16_bf16 a[32:47], a[188:191], a[152:155], a[32:47]
    v_mfma_f32_32x32x16_bf16 a[48:63], a[188:191], a[156:159], a[48:63]
    s_waitcnt vmcnt(0)
    v_perm_b32 v56, v67, v71, s96
    v_xor_b32 v60, v56, v13
    v_perm_b32 v57, v75, v79, s96
    v_xor_b32 v61, v57, v13
    v_perm_b32 v58, v83, v87, s96
    v_xor_b32 v62, v58, v13
    v_perm_b32 v59, v91, v95, s96
    v_xor_b32 v63, v59, v13
    v_perm_b32 v56, v99, v103, s96
    v_xor_b32 v56, v56, v13
    v_or_b32 v60, v60, v56
    v_perm_b32 v57, v107, v111, s96
    v_xor_b32 v57, v57, v13
    v_or_b32 v61, v61, v57
    v_perm_b32 v58, v115, v119, s96
    v_xor_b32 v58, v58, v13
    v_or_b32 v62, v62, v58
    v_perm_b32 v59, v123, v127, s96
    v_xor_b32 v59, v59, v13
    v_or_b32 v63, v63, v59
    v_or3_b32 v60, v60, v61, v62
    v_or_b32 v60, v60, v63
    v_cmp_ne_u32 vcc, 0, v60
    s_nop 0
    s_cbranch_vccz ook_17
    s_mov_b32 s5, 0
ospin_16:
    buffer_load_dwordx4 v[64:67], v2, s[48:51], s58 offen offset:0 sc1
    buffer_load_dwordx4 v[72:75], v2, s[48:51], s58 offen offset:1024 sc1
    buffer_load_dwordx4 v[80:83], v2, s[48:51], s58 offen offset:2048 sc1
    buffer_load_dwordx4 v[88:91], v2, s[48:51], s58 offen offset:3072 sc1
    s_add_u32 s4, s58, 4096
    buffer_load_dwordx4 v[96:99], v2, s[48:51], s4 offen offset:0 sc1
    buffer_load_dwordx4 v[104:107], v2, s[48:51], s4 offen offset:1024 sc1
    buffer_load_dwordx4 v[112:115], v2, s[48:51], s4 offen offset:2048 sc1
    buffer_load_dwordx4 v[120:123], v2, s[48:51], s4 offen offset:3072 sc1
    buffer_load_dwordx4 v[68:71], v2, s[48:51], s59 offen offset:0 sc1
    buffer_load_dwordx4 v[76:79], v2, s[48:51], s59 offen offset:1024 sc1
    buffer_load_dwordx4 v[84:87], v2, s[48:51], s59 offen offset:2048 sc1
    buffer_load_dwordx4 v[92:95], v2, s[48:51], s59 offen offset:3072 sc1
    s_add_u32 s4, s59, 4096
    buffer_load_dwordx4 v[100:103], v2, s[48:51], s4 offen offset:0 sc1
    buffer_load_dwordx4 v[108:111], v2, s[48:51], s4 offen offset:1024 sc1
    buffer_load_dwordx4 v[116:119], v2, s[48:51], s4 offen offset:2048 sc1
    buffer_load_dwordx4 v[124:127], v2, s[48:51], s4 offen offset:3072 sc1
    s_waitcnt vmcnt(0)
    v_perm_b32 v56, v67, v71, s96
    v_xor_b32 v60, v56, v13
    v_perm_b32 v57, v75, v79, s96
    v_xor_b32 v61, v57, v13
    v_perm_b32 v58, v83, v87, s96
    v_xor_b32 v62, v58, v13
    v_perm_b32 v59, v91, v95, s96
    v_xor_b32 v63, v59, v13
    v_perm_b32 v56, v99, v103, s96
    v_xor_b32 v56, v56, v13
    v_or_b32 v60, v60, v56
    v_perm_b32 v57, v107, v111, s96
    v_xor_b32 v57, v57, v13
    v_or_b32 v61, v61, v57
    v_perm_b32 v58, v115, v119, s96
    v_xor_b32 v58, v58, v13
    v_or_b32 v62, v62, v58
    v_perm_b32 v59, v123, v127, s96
    v_xor_b32 v59, v59, v13
    v_or_b32 v63, v63, v59
    v_or3_b32 v60, v60, v61, v62
    v_or_b32 v60, v60, v63
    v_cmp_ne_u32 vcc, 0, v60
    s_add_u32 s5, s5, 1
    s_cbranch_vccz ook_17
    s_cmp_lt_u32 s5, 40000
    s_cbranch_scc1 ospin_16
ook_17:
    s_waitcnt lgkmcnt(4)
    v_mfma_f32_32x32x16_bf16 a[0:15], a[160:163], v[64:67], a[0:15]
    ds_read_b64_tr_b16 a[176:177], v10 offset:36864
    ds_read_b64_tr_b16 a[178:179], v10 offset:37376
    v_mfma_f32_32x32x16_bf16 a[16:31], a[160:163], v[68:71], a[16:31]
    ds_read_b64_tr_b16 a[180:181], v11 offset:36864
    ds_read_b64_tr_b16 a[182:183], v11 offset:37376
    v_mfma_f32_32x32x16_bf16 a[32:47], a[164:167], v[64:67], a[32:47]
    v_mfma_f32_32x32x16_bf16 a[48:63], a[164:167], v[68:71], a[48:63]
    s_waitcnt lgkmcnt(4)
    v_mfma_f32_32x32x16_bf16 a[0:15], a[168:171], v[72:75], a[0:15]
    ds_read_b64_tr_b16 a[184:185], v10 offset:38912
    ds_read_b64_tr_b16 a[186:187], v10 offset:39424
    v_mfma_f32_32x32x16_bf16 a[16:31], a[168:171], v[76:79], a[16:31]
    ds_read_b64_tr_b16 a[188:189], v11 offset:38912
    ds_read_b64_tr_b16 a[190:191], v11 offset:39424
    v_mfma_f32_32x32x16_bf16 a[32:47], a[172:175], v[72:75], a[32:47]
    s_barrier
    v_mfma_f32_32x32x16_bf16 a[48:63], a[172:175], v[76:79], a[48:63]
    s_waitcnt lgkmcnt(4)
    v_mfma_f32_32x32x16_bf16 a[0:15], a[176:179], v[80:83], a[0:15]
    s_waitcnt vmcnt(18)
    ds_read_b64_tr_b16 a[160:161], v10 offset:16384
    ds_read_b64_tr_b16 a[162:163], v10 offset:16896
    v_mfma_f32_32x32x16_bf16 a[16:31], a[176:179], v[84:87], a[16:31]
    ds_read_b64_tr_b16 a[164:165], v11 offset:16384
    ds_read_b64_tr_b16 a[166:167], v11 offset:16896
    s_waitcnt vmcnt(13)
    v_permlane32_swap_b32 v48, v50
    v_permlane32_swap_b32 v49, v51
    v_permlane32_swap_b32 v52, v54
    v_mfma_f32_32x32x16_bf16 a[32:47], a[180:183], v[80:83], a[32:47]
    v_mfma_f32_32x32x16_bf16 a[48:63], a[180:183], v[84:87], a[48:63]
    v_permlane32_swap_b32 v53, v55
    s_nop 1
    v_lshlrev_b32 v144, 16, v48
    v_and_b32 v145, 0xffff0000, v48
    s_waitcnt lgkmcnt(4)
    v_mfma_f32_32x32x16_bf16 a[0:15], a[184:187], v[88:91], a[0:15]
    ds_read_b64_tr_b16 a[168:169], v10 offset:18432
    ds_read_b64_tr_b16 a[170:171], v10 offset:18944
    v_mfma_f32_32x32x16_bf16 a[16:31], a[184:187], v[92:95], a[16:31]
    ds_read_b64_tr_b16 a[172:173], v11 offset:18432
    ds_read_b64_tr_b16 a[174:175], v11 offset:18944
    v_lshlrev_b32 v146, 16, v49
    v_and_b32 v147, 0xffff0000, v49
    v_lshlrev_b32 v148, 16, v50
    v_and_b32 v149, 0xffff0000, v50
    v_mfma_f32_32x32x16_bf16 a[32:47], a[188:191], v[88:91], a[32:47]
    v_mfma_f32_32x32x16_bf16 a[48:63], a[188:191], v[92:95], a[48:63]
    v_lshlrev_b32 v150, 16, v51
    v_and_b32 v151, 0xffff0000, v51
    v_lshlrev_b32 v152, 16, v52
    v_and_b32 v153, 0xffff0000, v52
    s_waitcnt lgkmcnt(4)
    v_mfma_f32_32x32x16_bf16 a[0:15], a[160:163], v[96:99], a[0:15]
    ds_read_b64_tr_b16 a[176:177], v10 offset:20480
    ds_read_b64_tr_b16 a[178:179], v10 offset:20992
    v_mfma_f32_32x32x16_bf16 a[16:31], a[160:163], v[100:103], a[16:31]
    ds_read_b64_tr_b16 a[180:181], v11 offset:20480
    ds_read_b64_tr_b16 a[182:183], v11 offset:20992
    v_lshlrev_b32 v154, 16, v53
    v_and_b32 v155, 0xffff0000, v53
    v_lshlrev_b32 v156, 16, v54
    v_mfma_f32_32x32x16_bf16 a[32:47], a[164:167], v[96:99], a[32:47]
    v_mfma_f32_32x32x16_bf16 a[48:63], a[164:167], v[100:103], a[48:63]
    v_and_b32 v157, 0xffff0000, v54
    v_lshlrev_b32 v158, 16, v55
    v_and_b32 v159, 0xffff0000, v55
    s_waitcnt lgkmcnt(4)
    v_mfma_f32_32x32x16_bf16 a[0:15], a[168:171], v[104:107], a[0:15]
    ds_read_b64_tr_b16 a[184:185], v10 offset:22528
    ds_read_b64_tr_b16 a[186:187], v10 offset:23040
    v_mfma_f32_32x32x16_bf16 a[16:31], a[168:171], v[108:111], a[16:31]
    ds_read_b64_tr_b16 a[188:189], v11 offset:22528
    ds_read_b64_tr_b16 a[190:191], v11 offset:23040
    v_add_u32 v128, s61, v2
    s_xor_b32 s4, s36, 1
    s_mul_i32 s4, s4, 40960
    v_add_u32 v129, s4, v2
    s_xor_b32 s4, s36, 2
    v_mfma_f32_32x32x16_bf16 a[32:47], a[172:175], v[104:107], a[32:47]
    v_mfma_f32_32x32x16_bf16 a[48:63], a[172:175], v[108:111], a[48:63]
    s_mul_i32 s4, s4, 40960
    v_add_u32 v130, s4, v2
    s_xor_b32 s4, s36, 3
    s_mul_i32 s4, s4, 40960
    v_add_u32 v131, s4, v2
    s_waitcnt lgkmcnt(4)
    v_mfma_f32_32x32x16_bf16 a[0:15], a[176:179], v[112:115], a[0:15]
    v_mfma_f32_32x32x16_bf16 a[16:31], a[176:179], v[116:119], a[16:31]
    v_mfma_f32_32x32x16_bf16 a[32:47], a[180:183], v[112:115], a[32:47]
    v_mfma_f32_32x32x16_bf16 a[48:63], a[180:183], v[116:119], a[48:63]
    s_waitcnt lgkmcnt(0)
    v_mfma_f32_32x32x16_bf16 a[0:15], a[184:187], v[120:123], a[0:15]
    v_mfma_f32_32x32x16_bf16 a[16:31], a[184:187], v[124:127], a[16:31]
    v_mfma_f32_32x32x16_bf16 a[32:47], a[188:191], v[120:123], a[32:47]
    v_mfma_f32_32x32x16_bf16 a[48:63], a[188:191], v[124:127], a[48:63]
    s_nop 7
    s_nop 1
    ds_write_b128 v129, a[16:19] offset:0
    ds_write_b128 v129, a[20:23] offset:1024
    ds_write_b128 v129, a[24:27] offset:2048
    ds_write_b128 v129, a[28:31] offset:3072
    ds_write_b128 v130, a[32:35] offset:4096
    ds_write_b128 v130, a[36:39] offset:5120
    ds_write_b128 v130, a[40:43] offset:6144
    ds_write_b128 v130, a[44:47] offset:7168
    ds_write_b128 v131, a[48:51] offset:8192
    ds_write_b128 v131, a[52:55] offset:9216
    ds_write_b128 v131, a[56:59] offset:10240
    ds_write_b128 v131, a[60:63] offset:11264
    v_accvgpr_read_b32 v80, a0
    v_accvgpr_read_b32 v81, a1
    v_accvgpr_read_b32 v82, a2
    v_accvgpr_read_b32 v83, a3
    v_accvgpr_read_b32 v84, a4
    v_accvgpr_read_b32 v85, a5
    v_accvgpr_read_b32 v86, a6
    v_accvgpr_read_b32 v87, a7
    v_accvgpr_read_b32 v88, a8
    v_accvgpr_read_b32 v89, a9
    v_accvgpr_read_b32 v90, a10
    v_accvgpr_read_b32 v91, a11
    v_accvgpr_read_b32 v92, a12
    v_accvgpr_read_b32 v93, a13
    v_accvgpr_read_b32 v94, a14
    v_accvgpr_read_b32 v95, a15
    v_add_f32 v80, v80, v144
    v_add_f32 v81, v81, v145
    v_add_f32 v82, v82, v146
    v_add_f32 v83, v83, v147
    v_add_f32 v84, v84, v148
    v_add_f32 v85, v85, v149
    v_add_f32 v86, v86, v150
    v_add_f32 v87, v87, v151
    v_add_f32 v88, v88, v152
    v_add_f32 v89, v89, v153
    v_add_f32 v90, v90, v154
    v_add_f32 v91, v91, v155
    v_add_f32 v92, v92, v156
    v_add_f32 v93, v93, v157
    v_add_f32 v94, v94, v158
    v_add_f32 v95, v95, v159
    s_waitcnt lgkmcnt(0)
    s_barrier
    ds_read_b128 v[16:19], v128 offset:0
    ds_read_b128 v[20:23], v128 offset:1024
    ds_read_b128 v[24:27], v128 offset:2048
    ds_read_b128 v[28:31], v128 offset:3072
    ds_read_b128 v[32:35], v128 offset:4096
    ds_read_b128 v[36:39], v128 offset:5120
    ds_read_b128 v[40:43], v128 offset:6144
    ds_read_b128 v[44:47], v128 offset:7168
    ds_read_b128 v[64:67], v128 offset:8192
    ds_read_b128 v[68:71], v128 offset:9216
    ds_read_b128 v[72:75], v128 offset:10240
    ds_read_b128 v[76:79], v128 offset:11264
    s_waitcnt lgkmcnt(8)
    v_add_f32 v80, v80, v16
    v_add_f32 v81, v81, v17
    v_add_f32 v82, v82, v18
    v_add_f32 v83, v83, v19
    v_add_f32 v84, v84, v20
    v_add_f32 v85, v85, v21
    v_add_f32 v86, v86, v22
    v_add_f32 v87, v87, v23
    v_add_f32 v88, v88, v24
    v_add_f32 v89, v89, v25
    v_add_f32 v90, v90, v26
    v_add_f32 v91, v91, v27
    v_add_f32 v92, v92, v28
    v_add_f32 v93, v93, v29
    v_add_f32 v94, v94, v30
    v_add_f32 v95, v95, v31
    s_waitcnt lgkmcnt(4)
    v_add_f32 v80, v80, v32
    v_add_f32 v81, v81, v33
    v_add_f32 v82, v82, v34
    v_add_f32 v83, v83, v35
    v_add_f32 v84, v84, v36
    v_add_f32 v85, v85, v37
    v_add_f32 v86, v86, v38
    v_add_f32 v87, v87, v39
    v_add_f32 v88, v88, v40
    v_add_f32 v89, v89, v41
    v_add_f32 v90, v90, v42
    v_add_f32 v91, v91, v43
    v_add_f32 v92, v92, v44
    v_add_f32 v93, v93, v45
    v_add_f32 v94, v94, v46
    v_add_f32 v95, v95, v47
    s_waitcnt lgkmcnt(0)
    v_add_f32 v80, v80, v64
    v_add_f32 v81, v81, v65
    v_add_f32 v82, v82, v66
    v_add_f32 v83, v83, v67
    v_add_f32 v84, v84, v68
    v_add_f32 v85, v85, v69
    v_add_f32 v86, v86, v70
    v_add_f32 v87, v87, v71
    v_add_f32 v88, v88, v72
    v_add_f32 v89, v89, v73
    v_add_f32 v90, v90, v74
    v_add_f32 v91, v91, v75
    v_add_f32 v92, v92, v76
    v_add_f32 v93, v93, v77
    v_add_f32 v94, v94, v78
    v_add_f32 v95, v95, v79
    v_cvt_pk_bf16_f32 v100, v80, v81
    v_cvt_pk_bf16_f32 v101, v82, v83
    v_cvt_pk_bf16_f32 v102, v84, v85
    v_cvt_pk_bf16_f32 v103, v86, v87
    v_cvt_pk_bf16_f32 v104, v88, v89
    v_cvt_pk_bf16_f32 v105, v90, v91
    v_cvt_pk_bf16_f32 v106, v92, v93
    v_cvt_pk_bf16_f32 v107, v94, v95
    s_nop 1
    v_permlane32_swap_b32 v100, v102
    v_permlane32_swap_b32 v101, v103
    v_permlane32_swap_b32 v104, v106
    v_permlane32_swap_b32 v105, v107
    global_store_dwordx4 v6, v[100:103], s[30:31] nt
    global_store_dwordx4 v6, v[104:107], s[30:31] offset:32 nt
    s_endpgm
attn_slow:
    s_lshl_b32 s4, s10, 6
    s_lshl_b32 s5, s11, 2
    s_add_u32 s5, s5, s36
    s_add_u32 s5, s5, s4
    s_lshl_b32 s5, s5, 11
    s_add_u32 s6, s34, s5
    s_addc_u32 s7, s35, 0
    s_waitcnt vmcnt(0)
    global_load_dwordx4 a[160:163], v2, s[6:7] sc1
    global_load_dwordx4 a[164:167], v2, s[6:7] offset:1024 sc1
    s_lshl_b32 s4, s4, 12
    s_add_u32 s4, s4, 2097152
    s_add_u32 s54, s34, s4
    s_addc_u32 s55, s35, 0
    v_mov_b32 v56, 0xff800000
    v_mov_b32 v16, 0
    v_mov_b32 v17, 0
    v_mov_b32 v18, 0
    v_mov_b32 v19, 0
    v_mov_b32 v20, 0
    v_mov_b32 v21, 0
    v_mov_b32 v22, 0
    v_mov_b32 v23, 0
    v_mov_b32 v24, 0
    v_mov_b32 v25, 0
    v_mov_b32 v26, 0
    v_mov_b32 v27, 0
    v_mov_b32 v28, 0
    v_mov_b32 v29, 0
    v_mov_b32 v30, 0
    v_mov_b32 v31, 0
    s_mov_b32 s66, 64
attn_slow_loop:
    global_load_dwordx4 a[192:195], v2, s[54:55] offset:0 sc1
    global_load_dwordx4 a[196:199], v2, s[54:55] offset:1024 sc1
    global_load_dwordx4 a[200:203], v2, s[54:55] offset:2048 sc1
    global_load_dwordx4 a[204:207], v2, s[54:55] offset:3072 sc1
    s_add_u32 s54, s54, 4096
    s_addc_u32 s55, s55, 0
    s_waitcnt vmcnt(0)
    v_mfma_f32_32x32x16_bf16 v[32:47], a[192:195], a[160:163], 0
    v_mfma_f32_32x32x16_bf16 v[32:47], a[196:199], a[164:167], v[32:47]
    s_nop 7
    s_nop 3
    v_max3_f32 v58, v32, v33, v34
    v_max3_f32 v58, v58, v35, v36
    v_max3_f32 v58, v58, v37, v38
    v_max3_f32 v58, v58, v39, v40
    v_max3_f32 v58, v58, v41, v42
    v_max3_f32 v58, v58, v43, v44
    v_max3_f32 v58, v58, v45, v46
    v_max3_f32 v58, v58, v47, v56
    v_mov_b32 v59, v58
    s_nop 1
    v_permlane32_swap_b32 v58, v59
    s_nop 0
    v_max_f32 v58, v58, v59
    v_sub_f32 v57, v56, v58
    v_exp_f32 v57, v57
    v_mov_b32 v56, v58
    v_sub_f32 v32, v32, v56
    v_sub_f32 v33, v33, v56
    v_sub_f32 v34, v34, v56
    v_sub_f32 v35, v35, v56
    v_sub_f32 v36, v36, v56
    v_sub_f32 v37, v37, v56
    v_sub_f32 v38, v38, v56
    v_sub_f32 v39, v39, v56
    v_sub_f32 v40, v40, v56
    v_sub_f32 v41, v41, v56
    v_sub_f32 v42, v42, v56
    v_sub_f32 v43, v43, v56
    v_sub_f32 v44, v44, v56
    v_sub_f32 v45, v45, v56
    v_sub_f32 v46, v46, v56
    v_sub_f32 v47, v47, v56
    v_exp_f32 v32, v32
    v_exp_f32 v33, v33
    v_exp_f32 v34, v34
    v_exp_f32 v35, v35
    v_exp_f32 v36, v36
    v_exp_f32 v37, v37
    v_exp_f32 v38, v38
    v_exp_f32 v39, v39
    v_exp_f32 v40, v40
    v_exp_f32 v41, v41
    v_exp_f32 v42, v42
    v_exp_f32 v43, v43
    v_exp_f32 v44, v44
    v_exp_f32 v45, v45
    v_exp_f32 v46, v46
    v_exp_f32 v47, v47
    v_mul_f32 v16, v16, v57
    v_mul_f32 v17, v17, v57
    v_mul_f32 v18, v18, v57
    v_mul_f32 v19, v19, v57
    v_mul_f32 v20, v20, v57
    v_mul_f32 v21, v21, v57
    v_mul_f32 v22, v22, v57
    v_mul_f32 v23, v23, v57
    v_mul_f32 v24, v24, v57
    v_mul_f32 v25, v25, v57
    v_mul_f32 v26, v26, v57
    v_mul_f32 v27, v27, v57
    v_mul_f32 v28, v28, v57
    v_mul_f32 v29, v29, v57
    v_mul_f32 v30, v30, v57
    v_mul_f32 v31, v31, v57
    v_cvt_pk_bf16_f32 v48, v32, v33
    v_cvt_pk_bf16_f32 v49, v34, v35
    v_cvt_pk_bf16_f32 v50, v36, v37
    v_cvt_pk_bf16_f32 v51, v38, v39
    v_cvt_pk_bf16_f32 v52, v40, v41
    v_cvt_pk_bf16_f32 v53, v42, v43
    v_cvt_pk_bf16_f32 v54, v44, v45
    v_cvt_pk_bf16_f32 v55, v46, v47
    s_nop 1
    v_mfma_f32_32x32x16_bf16 v[16:31], a[200:203], v[48:51], v[16:31]
    v_mfma_f32_32x32x16_bf16 v[16:31], a[204:207], v[52:55], v[16:31]
    s_sub_u32 s66, s66, 1
    s_cmp_lg_u32 s66, 0
    s_nop 7
    s_nop 3
    s_cbranch_scc1 attn_slow_loop
    v_mov_b32 v32, v31
    v_mov_b32 v33, v31
    s_nop 1
    v_permlane32_swap_b32 v32, v33
    s_nop 1
    s_branch attn_norm
k_exit:
    s_endpgm
.section .rodata,"a"
.p2align 6
.amdhsa_kernel parallel_sum__softmax_full_mha__glu_gated_swiglu__prompt_kernel
.amdhsa_next_free_vgpr 512
.amdhsa_next_free_sgpr 102
.amdhsa_accum_offset 256
.amdhsa_group_segment_fixed_size 0
.amdhsa_kernarg_size 80
.amdhsa_user_sgpr_count 2
.amdhsa_user_sgpr_kernarg_segment_ptr 1
.amdhsa_system_sgpr_workgroup_id_x 1
.end_amdhsa_kernel
.text
```
